```python
import torch

def _softmax(x, axis=-1):
    return torch.softmax(x, dim=axis)
def _gelu(x):
    return torch.nn.functional.gelu(x, approximate="tanh")
def _silu(x):
    return torch.nn.functional.silu(x)
def _sigmoid(x):
    return torch.sigmoid(x)
def _layernorm(x, axis=-1, eps=1e-5):
    m = x.mean(dim=axis, keepdim=True)
    v = x.var(dim=axis, keepdim=True, unbiased=False)
    return (x - m) / torch.sqrt(v + eps)
def _scatter_add(tgt, idx, src, axis=0):
    return tgt.clone().index_add_(axis, idx, src)
def _segment_sum(src, seg, n):
    out = torch.zeros((n,) + src.shape[1:], dtype=src.dtype)
    return out.index_add_(0, seg, src)
def _pad(x, pw):
    flat = tuple(v for pair in reversed(pw) for v in pair)
    return torch.nn.functional.pad(x, flat)

kernel_name = 'parallel_sum__ssm_conv_s5__mixer_token_mlp__prompt'

def setup_inputs():

    _w = (lambda a: (lambda t: t.to(torch.bfloat16) if t.is_floating_point() else t)(torch.as_tensor(a)))
    def _A_setup():
        B, S, D = 1, 2048, 576
        P = D
        Lambda_re = -0.5 * (lambda _x: torch.exp(torch.as_tensor(_x)))((lambda *s: torch.randn(*s, dtype=torch.bfloat16) * 0.2)(P))
        Lambda_im = (lambda *s: torch.randn(*s, dtype=torch.bfloat16) * 0.8)(P) * 1.0
        B_re = (lambda *s: torch.randn(*s, dtype=torch.bfloat16) * 0.2)(P, D) * (D ** -0.5)
        B_im = (lambda *s: torch.randn(*s, dtype=torch.bfloat16) * 0.2)(P, D) * (D ** -0.5)
        C_re = (lambda *s: torch.randn(*s, dtype=torch.bfloat16) * 0.2)(D, P) * (P ** -0.5)
        C_im = (lambda *s: torch.randn(*s, dtype=torch.bfloat16) * 0.2)(D, P) * (P ** -0.5)
        log_dt = (lambda *s: torch.randn(*s, dtype=torch.bfloat16) * 0.2)(P) * 0.3 - 2.0
        Dskip = (lambda *s: torch.randn(*s, dtype=torch.bfloat16) * 0.05)(D)
        return {
            "x": _w((lambda *s: torch.randn(*s, dtype=torch.bfloat16) * 0.05)(B, S, D)),
            "Lambda_re": _w(Lambda_re),
            "Lambda_im": _w(Lambda_im),
            "B_re": _w(B_re),
            "B_im": _w(B_im),
            "C_re": _w(C_re),
            "C_im": _w(C_im),
            "log_dt": _w(log_dt),
            "Dskip": _w(Dskip),
        }
    _A_in = _A_setup()

    def _B_setup():
        B, S, D, F = 1, 2048, 576, 4608
        return {
            "x": _w((lambda *s: torch.randn(*s, dtype=torch.bfloat16) * 0.05)(B, S, D)),
            "w1": _w((lambda *s: torch.randn(*s, dtype=torch.bfloat16) * 0.8)(S, F) * (S ** -0.5)),
            "b1": _w((lambda *s: torch.randn(*s, dtype=torch.bfloat16) * 3.2)(F) * 0.02),
            "w2": _w((lambda *s: torch.randn(*s, dtype=torch.bfloat16) * 0.4)(F, S) * (F ** -0.5)),
            "b2": _w((lambda *s: torch.randn(*s, dtype=torch.bfloat16) * 3.2)(S) * 0.02),
        }
    _B_in = _B_setup()

    return {
        "A_x": _A_in["x"],
        "A_Lambda_re": _A_in["Lambda_re"],
        "A_Lambda_im": _A_in["Lambda_im"],
        "A_B_re": _A_in["B_re"],
        "A_B_im": _A_in["B_im"],
        "A_C_re": _A_in["C_re"],
        "A_C_im": _A_in["C_im"],
        "A_log_dt": _A_in["log_dt"],
        "A_Dskip": _A_in["Dskip"],
        "B_x": _B_in["x"],
        "B_w1": _B_in["w1"],
        "B_b1": _B_in["b1"],
        "B_w2": _B_in["w2"],
        "B_b2": _B_in["b2"],
    }

def reference(A_x, A_Lambda_re, A_Lambda_im, A_B_re, A_B_im, A_C_re, A_C_im, A_log_dt, A_Dskip, B_x, B_w1, B_b1, B_w2, B_b2):
    def _A_ref(x, Lambda_re, Lambda_im, B_re, B_im, C_re, C_im, log_dt, Dskip):
        Bsz, L, H = x.shape
        Lam = Lambda_re + 1j * Lambda_im
        Bmat = B_re + 1j * B_im
        Cmat = C_re + 1j * C_im
        dt = torch.exp(log_dt)
        Lam_bar = torch.exp(dt * Lam)
        B_bar = ((Lam_bar - 1.0) / Lam)[:, None] * Bmat
        Bu = torch.einsum("bld,pd->blp", x + 0j, B_bar)
        h = torch.zeros_like(Bu[:, 0, :])
        hs = []
        for t in range(L):
            h = Lam_bar[None, :] * h + Bu[:, t, :]
            hs.append(h)
        hseq = torch.stack(hs, 1)
        y = 2.0 * torch.einsum("blp,dp->bld", hseq, Cmat).real + x * Dskip[None, None, :]
        return y

    def _B_ref(x, w1, b1, w2, b2):
        B, S, D = x.shape
        h = _layernorm(x, axis=-1)
        u = torch.einsum("bsd,sf->bdf", h, w1) + b1
        u = _gelu(u)
        y = torch.einsum("bdf,fs->bds", u, w2) + b2
        return (lambda x, *d: x.permute(*d))(y, 0, 2, 1)

    x = A_x
    xn = _layernorm(x, axis=-1)
    return x + _A_ref(xn, A_Lambda_re, A_Lambda_im, A_B_re, A_B_im, A_C_re, A_C_im, A_log_dt, A_Dskip) + _B_ref(xn, B_w1, B_b1, B_w2, B_b2)
```

```asm
; @launch grid=(256,1,1) block=(512,1,1) lds=163840
.amdgcn_target "amdgcn-amd-amdhsa--gfx950"
.text
.p2align 8
.globl parallel_sum__ssm_conv_s5__mixer_token_mlp__prompt_kernel
.type parallel_sum__ssm_conv_s5__mixer_token_mlp__prompt_kernel,@function
parallel_sum__ssm_conv_s5__mixer_token_mlp__prompt_kernel:
    s_cmp_ge_u32 s2, 256
    s_cbranch_scc1 parallel_sum__ssm_conv_s5__mixer_token_mlp__prompt_kernel_done_1
    s_load_dwordx16 s[16:31], s[0:1], 0
    s_load_dwordx16 s[32:47], s[0:1], 64
    s_load_dwordx2 s[48:49], s[0:1], 128
    v_lshrrev_b32 v1, 6, v0
    v_and_b32 v2, 63, v0
    v_readfirstlane_b32 s3, v1
    v_and_b32 v3, 15, v2
    v_lshrrev_b32 v4, 4, v2
    s_mov_b32 s4, 0xffff0000
    s_and_b32 s8, s3, 1
    s_bfe_u32 s67, s3, 0x10001
    s_and_b32 s51, s2, 7
    s_lshr_b32 s66, s2, 3
    s_lshl_b32 s9, s8, 1
    s_add_u32 s9, s9, s67
    s_lshl_b32 s9, s9, 12
    s_and_b32 s65, s3, 3
    s_mul_i32 s65, s65, 6144
    s_add_u32 s65, s65, 139264
    v_lshlrev_b32 v5, 2, v2
    v_add_u32 v5, 144384, v5
    v_mov_b32 v6, 0
    ds_write_b32 v5, v6
    ds_write_b32 v5, v6 offset:512
    v_mov_b32 v30, 0
    s_mov_b32 s50, 1
    s_mov_b32 s64, 0
    s_cmp_ge_u32 s66, 27
    s_cbranch_scc1 parallel_sum__ssm_conv_s5__mixer_token_mlp__prompt_kernel_pk_4
    s_cmp_ge_u32 s66, 26
    s_cbranch_scc1 parallel_sum__ssm_conv_s5__mixer_token_mlp__prompt_kernel_misc_3
    s_cmp_ge_u32 s66, 18
    s_cbranch_scc1 parallel_sum__ssm_conv_s5__mixer_token_mlp__prompt_kernel_ln_2
    s_mov_b32 s50, 0
    s_cmp_ge_u32 s66, 9
    s_cselect_b32 s5, 1, 0
    s_mul_i32 s6, s5, 9
    s_sub_u32 s6, s66, s6
    s_lshl_b32 s64, s51, 1
    s_add_u32 s64, s64, s5
    s_cmp_ge_u32 s3, 4
    s_cbranch_scc1 parallel_sum__ssm_conv_s5__mixer_token_mlp__prompt_kernel_gbl_5
parallel_sum__ssm_conv_s5__mixer_token_mlp__prompt_kernel_gbc_16:
    s_lshl_b32 s63, s6, 2
    s_add_u32 s63, s63, s3
    s_lshl_b32 s15, s63, 5
    v_lshlrev_b32 v5, 1, v3
    s_waitcnt lgkmcnt(0)
    s_mov_b32 s52, s18
    s_mov_b32 s53, s19
    s_mov_b32 s54, 0x480
    s_mov_b32 s55, 0x00020000
    buffer_load_ushort v204, v5, s[52:55], s15 offen
    s_mov_b32 s52, s20
    s_mov_b32 s53, s21
    s_mov_b32 s54, 0x480
    s_mov_b32 s55, 0x00020000
    buffer_load_ushort v205, v5, s[52:55], s15 offen
    s_mov_b32 s52, s30
    s_mov_b32 s53, s31
    s_mov_b32 s54, 0x480
    s_mov_b32 s55, 0x00020000
    buffer_load_ushort v206, v5, s[52:55], s15 offen
    s_and_b32 s6, s51, 1
    s_mul_i32 s6, s6, 3
    s_add_u32 s6, s6, s66
    s_sub_u32 s6, s6, 18
    s_add_u32 s7, s66, 12
    s_cmp_ge_u32 s66, 18
    s_cselect_b32 s5, s6, s7
    s_mul_i32 s6, s5, 43
    s_lshr_b32 s6, s6, 8
    s_mul_i32 s7, s6, 6
    s_sub_u32 s7, s5, s7
    s_mov_b32 s5, 0x43201
    s_cmp_eq_u32 s51, 1
    s_cselect_b32 s5, 0x87650, s5
    s_cmp_eq_u32 s51, 2
    s_cselect_b32 s5, 0x32140, s5
    s_cmp_eq_u32 s51, 3
    s_cselect_b32 s5, 0x76584, s5
    s_cmp_eq_u32 s51, 4
    s_cselect_b32 s5, 0x42103, s5
    s_cmp_eq_u32 s51, 5
    s_cselect_b32 s5, 0x86570, s5
    s_cmp_eq_u32 s51, 6
    s_cselect_b32 s5, 0x43102, s5
    s_cmp_eq_u32 s51, 7
    s_cselect_b32 s5, 0x87560, s5
    s_lshl_b32 s6, s6, 2
    s_lshr_b32 s6, s5, s6
    s_and_b32 s6, s6, 15
    s_lshr_b32 s5, s51, 1
    s_mul_i32 s5, s5, 9
    s_add_u32 s6, s6, s5
    s_mov_b32 s56, s38
    s_mov_b32 s57, s39
    s_mov_b32 s58, 0x2400
    s_mov_b32 s59, 0x00020000
    s_lshl_b32 s14, s6, 8
    s_lshl_b32 s15, s3, 6
    s_add_u32 s14, s14, s15
    v_lshlrev_b32 v236, 3, v4
    buffer_load_dwordx2 v[232:233], v236, s[56:59], s14 offen
    buffer_load_dwordx2 v[234:235], v236, s[56:59], s14 offen offset:32
    v_lshrrev_b32 v8, 2, v3
    v_lshlrev_b32 v8, 5, v8
    v_and_b32 v9, 3, v3
    v_add_u32 v8, v8, v9
    v_lshlrev_b32 v8, 7, v8
    v_add_u32 v8, 65536, v8
    v_lshrrev_b32 v12, 1, v3
    v_xor_b32 v12, v12, v4
    v_xor_b32 v13, 4, v12
    v_lshl_add_u32 v9, v13, 4, v8
    v_lshl_add_u32 v8, v12, 4, v8
    s_lshl_b32 s15, s3, 11
    v_lshlrev_b32 v10, 7, v3
    v_add_u32 v10, s15, v10
    v_lshl_add_u32 v11, v13, 4, v10
    v_lshl_add_u32 v10, v12, 4, v10
    v_mov_b32 v7, 143360
    v_mov_b32 v200, 0x3f803f80
    v_mov_b32 v201, 0x3f803f80
    v_mov_b32 v202, 0x3f803f80
    v_mov_b32 v203, 0x3f803f80
    s_mov_b32 s85, 0x3fb8aa3b
    s_mov_b32 s86, 0x3e22f983
    s_waitcnt vmcnt(0)
    v_lshlrev_b32 v224, 16, v232
    v_and_b32 v225, s4, v232
    v_lshlrev_b32 v226, 16, v233
    v_and_b32 v227, s4, v233
    v_lshlrev_b32 v228, 16, v234
    v_and_b32 v229, s4, v234
    v_lshlrev_b32 v230, 16, v235
    v_and_b32 v231, s4, v235
    s_add_u32 s52, s48, 0x1520000
    s_addc_u32 s53, s49, 0
    s_mov_b32 s54, 0x12000
    s_mov_b32 s55, 0x00020000
    s_add_u32 s56, s48, 0x280000
    s_addc_u32 s57, s49, 0
    s_mov_b32 s58, 0x480000
    s_mov_b32 s59, 0x00020000
    v_lshlrev_b32 v204, 16, v204
    v_lshlrev_b32 v205, 16, v205
    v_lshlrev_b32 v206, 16, v206
    v_mul_f32 v206, s85, v206
    v_exp_f32 v206, v206
    s_nop 0
    v_cvt_pk_bf16_f32 v206, v206, v206
    v_lshlrev_b32 v206, 16, v206
    v_mul_f32 v218, v206, v204
    v_mul_f32 v219, v206, v205
    v_mul_f32 v218, s85, v218
    v_mul_f32 v219, s86, v219
    v_fract_f32 v220, v219
    v_exp_f32 v208, v218
    v_sin_f32 v209, v220
    v_cos_f32 v220, v220
    s_nop 0
    v_mul_f32 v209, v208, v209
    v_mul_f32 v208, v208, v220
    v_cvt_f32_u32 v16, v4
    v_mul_f32 v17, 0x42000000, v16
    v_sub_f32 v16, 0x40400000, v16
    v_mul_f32 v16, 0x44000000, v16
    v_mul_f32 v18, v16, v218
    v_mul_f32 v19, v16, v219
    v_fract_f32 v220, v19
    v_exp_f32 v204, v18
    v_sin_f32 v205, v220
    v_cos_f32 v220, v220
    s_nop 0
    v_mul_f32 v205, v204, v205
    v_mul_f32 v204, v204, v220
    v_mul_f32 v18, v17, v218
    v_mul_f32 v19, v17, v219
    v_fract_f32 v220, v19
    v_exp_f32 v206, v18
    v_sin_f32 v207, v220
    v_cos_f32 v220, v220
    s_nop 0
    v_mul_f32 v207, v206, v207
    v_mul_f32 v206, v206, v220
    v_mov_b32 v214, v208
    v_mov_b32 v215, v209
    v_mul_f32 v220, v215, v215
    v_mul_f32 v215, v214, v215
    v_fma_f32 v214, v214, v214, -v220
    v_add_f32 v215, v215, v215
    v_mul_f32 v220, v215, v215
    v_mul_f32 v215, v214, v215
    v_fma_f32 v214, v214, v214, -v220
    v_add_f32 v215, v215, v215
    v_mul_f32 v220, v215, v215
    v_mul_f32 v215, v214, v215
    v_fma_f32 v214, v214, v214, -v220
    v_add_f32 v215, v215, v215
    v_mov_b32 v218, v214
    v_mov_b32 v219, v215
    v_mul_f32 v220, v215, v215
    v_mul_f32 v215, v214, v215
    v_fma_f32 v214, v214, v214, -v220
    v_add_f32 v215, v215, v215
    v_mul_f32 v220, v215, v215
    v_mul_f32 v215, v214, v215
    v_fma_f32 v214, v214, v214, -v220
    v_add_f32 v215, v215, v215
    v_mov_b32 v216, v214
    v_mov_b32 v217, v215
    v_mul_f32 v220, v217, v217
    v_mul_f32 v217, v216, v217
    v_fma_f32 v216, v216, v216, -v220
    v_add_f32 v217, v217, v217
    v_mul_f32 v220, v217, v217
    v_mul_f32 v217, v216, v217
    v_fma_f32 v216, v216, v216, -v220
    v_add_f32 v217, v217, v217
    s_barrier
    ds_read_b128 v[24:27], v8 offset:0
    ds_read_b128 v[28:31], v8 offset:512
    ds_read_b128 v[32:35], v8 offset:1024
    ds_read_b128 v[36:39], v8 offset:1536
    ds_read_b128 v[40:43], v8 offset:2048
    ds_read_b128 v[44:47], v8 offset:2560
    ds_read_b128 v[48:51], v8 offset:3072
    ds_read_b128 v[16:19], v10 offset:0
    ds_read_b128 v[20:23], v10 offset:8192
    ds_read_b128 v[52:55], v8 offset:3584
    ds_read_b128 v[64:67], v9 offset:0
    ds_read_b128 v[68:71], v9 offset:512
    ds_read_b128 v[72:75], v9 offset:1024
    ds_read_b128 v[76:79], v9 offset:1536
    ds_read_b128 v[80:83], v9 offset:2048
    ds_read_b128 v[84:87], v9 offset:2560
    ds_read_b128 v[88:91], v9 offset:3072
    ds_read_b128 v[56:59], v11 offset:0
    ds_read_b128 v[60:63], v11 offset:8192
    ds_read_b128 v[92:95], v9 offset:3584
    s_waitcnt lgkmcnt(11)
    v_mfma_f32_16x16x32_bf16 v[192:195], v[200:203], v[16:19], 0
    v_mfma_f32_16x16x32_bf16 v[196:199], v[200:203], v[20:23], 0
    v_mfma_f32_16x16x32_bf16 v[128:131], v[24:27], v[16:19], 0
    v_mfma_f32_16x16x32_bf16 v[132:135], v[24:27], v[20:23], 0
    v_mfma_f32_16x16x32_bf16 v[136:139], v[28:31], v[16:19], 0
    v_mfma_f32_16x16x32_bf16 v[140:143], v[28:31], v[20:23], 0
    v_mfma_f32_16x16x32_bf16 v[144:147], v[32:35], v[16:19], 0
    v_mfma_f32_16x16x32_bf16 v[148:151], v[32:35], v[20:23], 0
    v_mfma_f32_16x16x32_bf16 v[152:155], v[36:39], v[16:19], 0
    v_mfma_f32_16x16x32_bf16 v[156:159], v[36:39], v[20:23], 0
    v_mfma_f32_16x16x32_bf16 v[160:163], v[40:43], v[16:19], 0
    v_mfma_f32_16x16x32_bf16 v[164:167], v[40:43], v[20:23], 0
    v_mfma_f32_16x16x32_bf16 v[168:171], v[44:47], v[16:19], 0
    v_mfma_f32_16x16x32_bf16 v[172:175], v[44:47], v[20:23], 0
    s_waitcnt lgkmcnt(0)
    s_barrier
    v_mfma_f32_16x16x32_bf16 v[176:179], v[48:51], v[16:19], 0
    ds_read_b128 v[24:27], v8 offset:18432
    v_mfma_f32_16x16x32_bf16 v[180:183], v[48:51], v[20:23], 0
    ds_read_b128 v[28:31], v8 offset:18944
    v_mfma_f32_16x16x32_bf16 v[184:187], v[52:55], v[16:19], 0
    ds_read_b128 v[32:35], v8 offset:19456
    v_mfma_f32_16x16x32_bf16 v[188:191], v[52:55], v[20:23], 0
    ds_read_b128 v[36:39], v8 offset:19968
    v_mfma_f32_16x16x32_bf16 v[192:195], v[200:203], v[56:59], v[192:195]
    ds_read_b128 v[40:43], v8 offset:20480
    v_mfma_f32_16x16x32_bf16 v[196:199], v[200:203], v[60:63], v[196:199]
    ds_read_b128 v[44:47], v8 offset:20992
    v_mfma_f32_16x16x32_bf16 v[128:131], v[64:67], v[56:59], v[128:131]
    ds_read_b128 v[48:51], v8 offset:21504
    v_mfma_f32_16x16x32_bf16 v[132:135], v[64:67], v[60:63], v[132:135]
    ds_read_b128 v[16:19], v10 offset:16384
    v_mfma_f32_16x16x32_bf16 v[136:139], v[68:71], v[56:59], v[136:139]
    ds_read_b128 v[20:23], v10 offset:24576
    v_mfma_f32_16x16x32_bf16 v[140:143], v[68:71], v[60:63], v[140:143]
    ds_read_b128 v[52:55], v8 offset:22016
    v_mfma_f32_16x16x32_bf16 v[144:147], v[72:75], v[56:59], v[144:147]
    ds_read_b128 v[64:67], v9 offset:18432
    v_mfma_f32_16x16x32_bf16 v[148:151], v[72:75], v[60:63], v[148:151]
    ds_read_b128 v[68:71], v9 offset:18944
    v_mfma_f32_16x16x32_bf16 v[152:155], v[76:79], v[56:59], v[152:155]
    ds_read_b128 v[72:75], v9 offset:19456
    v_mfma_f32_16x16x32_bf16 v[156:159], v[76:79], v[60:63], v[156:159]
    ds_read_b128 v[76:79], v9 offset:19968
    v_mfma_f32_16x16x32_bf16 v[160:163], v[80:83], v[56:59], v[160:163]
    v_mfma_f32_16x16x32_bf16 v[164:167], v[80:83], v[60:63], v[164:167]
    ds_read_b128 v[80:83], v9 offset:20480
    v_mfma_f32_16x16x32_bf16 v[168:171], v[84:87], v[56:59], v[168:171]
    v_mfma_f32_16x16x32_bf16 v[172:175], v[84:87], v[60:63], v[172:175]
    ds_read_b128 v[84:87], v9 offset:20992
    v_mfma_f32_16x16x32_bf16 v[176:179], v[88:91], v[56:59], v[176:179]
    v_mfma_f32_16x16x32_bf16 v[180:183], v[88:91], v[60:63], v[180:183]
    ds_read_b128 v[88:91], v9 offset:21504
    v_mfma_f32_16x16x32_bf16 v[184:187], v[92:95], v[56:59], v[184:187]
    v_mfma_f32_16x16x32_bf16 v[188:191], v[92:95], v[60:63], v[188:191]
    ds_read_b128 v[56:59], v11 offset:16384
    s_waitcnt lgkmcnt(9)
    v_mfma_f32_16x16x32_bf16 v[192:195], v[200:203], v[16:19], v[192:195]
    ds_read_b128 v[60:63], v11 offset:24576
    v_mfma_f32_16x16x32_bf16 v[196:199], v[200:203], v[20:23], v[196:199]
    ds_read_b128 v[92:95], v9 offset:22016
    v_mfma_f32_16x16x32_bf16 v[128:131], v[24:27], v[16:19], v[128:131]
    v_mfma_f32_16x16x32_bf16 v[132:135], v[24:27], v[20:23], v[132:135]
    v_mfma_f32_16x16x32_bf16 v[136:139], v[28:31], v[16:19], v[136:139]
    v_mfma_f32_16x16x32_bf16 v[140:143], v[28:31], v[20:23], v[140:143]
    v_mfma_f32_16x16x32_bf16 v[144:147], v[32:35], v[16:19], v[144:147]
    v_mfma_f32_16x16x32_bf16 v[148:151], v[32:35], v[20:23], v[148:151]
    v_mfma_f32_16x16x32_bf16 v[152:155], v[36:39], v[16:19], v[152:155]
    v_mfma_f32_16x16x32_bf16 v[156:159], v[36:39], v[20:23], v[156:159]
    v_mfma_f32_16x16x32_bf16 v[160:163], v[40:43], v[16:19], v[160:163]
    v_mfma_f32_16x16x32_bf16 v[164:167], v[40:43], v[20:23], v[164:167]
    v_mfma_f32_16x16x32_bf16 v[168:171], v[44:47], v[16:19], v[168:171]
    v_mfma_f32_16x16x32_bf16 v[172:175], v[44:47], v[20:23], v[172:175]
    s_waitcnt lgkmcnt(0)
    s_barrier
    v_mfma_f32_16x16x32_bf16 v[176:179], v[48:51], v[16:19], v[176:179]
    ds_read_b128 v[24:27], v8 offset:36864
    v_mfma_f32_16x16x32_bf16 v[180:183], v[48:51], v[20:23], v[180:183]
    ds_read_b128 v[28:31], v8 offset:37376
    v_mfma_f32_16x16x32_bf16 v[184:187], v[52:55], v[16:19], v[184:187]
    ds_read_b128 v[32:35], v8 offset:37888
    v_mfma_f32_16x16x32_bf16 v[188:191], v[52:55], v[20:23], v[188:191]
    ds_read_b128 v[36:39], v8 offset:38400
    v_mfma_f32_16x16x32_bf16 v[192:195], v[200:203], v[56:59], v[192:195]
    ds_read_b128 v[40:43], v8 offset:38912
    v_mfma_f32_16x16x32_bf16 v[196:199], v[200:203], v[60:63], v[196:199]
    ds_read_b128 v[44:47], v8 offset:39424
    v_mfma_f32_16x16x32_bf16 v[128:131], v[64:67], v[56:59], v[128:131]
    ds_read_b128 v[48:51], v8 offset:39936
    v_mfma_f32_16x16x32_bf16 v[132:135], v[64:67], v[60:63], v[132:135]
    ds_read_b128 v[16:19], v10 offset:32768
    v_mfma_f32_16x16x32_bf16 v[136:139], v[68:71], v[56:59], v[136:139]
    ds_read_b128 v[20:23], v10 offset:40960
    v_mfma_f32_16x16x32_bf16 v[140:143], v[68:71], v[60:63], v[140:143]
    ds_read_b128 v[52:55], v8 offset:40448
    v_mfma_f32_16x16x32_bf16 v[144:147], v[72:75], v[56:59], v[144:147]
    ds_read_b128 v[64:67], v9 offset:36864
    v_mfma_f32_16x16x32_bf16 v[148:151], v[72:75], v[60:63], v[148:151]
    ds_read_b128 v[68:71], v9 offset:37376
    v_mfma_f32_16x16x32_bf16 v[152:155], v[76:79], v[56:59], v[152:155]
    ds_read_b128 v[72:75], v9 offset:37888
    v_mfma_f32_16x16x32_bf16 v[156:159], v[76:79], v[60:63], v[156:159]
    ds_read_b128 v[76:79], v9 offset:38400
    v_mfma_f32_16x16x32_bf16 v[160:163], v[80:83], v[56:59], v[160:163]
    v_mfma_f32_16x16x32_bf16 v[164:167], v[80:83], v[60:63], v[164:167]
    ds_read_b128 v[80:83], v9 offset:38912
    v_mfma_f32_16x16x32_bf16 v[168:171], v[84:87], v[56:59], v[168:171]
    v_mfma_f32_16x16x32_bf16 v[172:175], v[84:87], v[60:63], v[172:175]
    ds_read_b128 v[84:87], v9 offset:39424
    v_mfma_f32_16x16x32_bf16 v[176:179], v[88:91], v[56:59], v[176:179]
    v_mfma_f32_16x16x32_bf16 v[180:183], v[88:91], v[60:63], v[180:183]
    ds_read_b128 v[88:91], v9 offset:39936
    v_mfma_f32_16x16x32_bf16 v[184:187], v[92:95], v[56:59], v[184:187]
    v_mfma_f32_16x16x32_bf16 v[188:191], v[92:95], v[60:63], v[188:191]
    ds_read_b128 v[56:59], v11 offset:32768
    s_waitcnt lgkmcnt(9)
    v_mfma_f32_16x16x32_bf16 v[192:195], v[200:203], v[16:19], v[192:195]
    ds_read_b128 v[60:63], v11 offset:40960
    v_mfma_f32_16x16x32_bf16 v[196:199], v[200:203], v[20:23], v[196:199]
    ds_read_b128 v[92:95], v9 offset:40448
    v_mfma_f32_16x16x32_bf16 v[128:131], v[24:27], v[16:19], v[128:131]
    v_mfma_f32_16x16x32_bf16 v[132:135], v[24:27], v[20:23], v[132:135]
    v_mfma_f32_16x16x32_bf16 v[136:139], v[28:31], v[16:19], v[136:139]
    v_mfma_f32_16x16x32_bf16 v[140:143], v[28:31], v[20:23], v[140:143]
    v_mfma_f32_16x16x32_bf16 v[144:147], v[32:35], v[16:19], v[144:147]
    v_mfma_f32_16x16x32_bf16 v[148:151], v[32:35], v[20:23], v[148:151]
    v_mfma_f32_16x16x32_bf16 v[152:155], v[36:39], v[16:19], v[152:155]
    v_mfma_f32_16x16x32_bf16 v[156:159], v[36:39], v[20:23], v[156:159]
    v_mfma_f32_16x16x32_bf16 v[160:163], v[40:43], v[16:19], v[160:163]
    v_mfma_f32_16x16x32_bf16 v[164:167], v[40:43], v[20:23], v[164:167]
    v_mfma_f32_16x16x32_bf16 v[168:171], v[44:47], v[16:19], v[168:171]
    v_mfma_f32_16x16x32_bf16 v[172:175], v[44:47], v[20:23], v[172:175]
    s_waitcnt lgkmcnt(0)
    s_barrier
    v_mfma_f32_16x16x32_bf16 v[176:179], v[48:51], v[16:19], v[176:179]
    ds_read_b128 v[24:27], v8 offset:55296
    v_mfma_f32_16x16x32_bf16 v[180:183], v[48:51], v[20:23], v[180:183]
    ds_read_b128 v[28:31], v8 offset:55808
    v_mfma_f32_16x16x32_bf16 v[184:187], v[52:55], v[16:19], v[184:187]
    ds_read_b128 v[32:35], v8 offset:56320
    v_mfma_f32_16x16x32_bf16 v[188:191], v[52:55], v[20:23], v[188:191]
    ds_read_b128 v[36:39], v8 offset:56832
    v_mfma_f32_16x16x32_bf16 v[192:195], v[200:203], v[56:59], v[192:195]
    ds_read_b128 v[40:43], v8 offset:57344
    v_mfma_f32_16x16x32_bf16 v[196:199], v[200:203], v[60:63], v[196:199]
    ds_read_b128 v[44:47], v8 offset:57856
    v_mfma_f32_16x16x32_bf16 v[128:131], v[64:67], v[56:59], v[128:131]
    ds_read_b128 v[48:51], v8 offset:58368
    v_mfma_f32_16x16x32_bf16 v[132:135], v[64:67], v[60:63], v[132:135]
    ds_read_b128 v[16:19], v10 offset:49152
    v_mfma_f32_16x16x32_bf16 v[136:139], v[68:71], v[56:59], v[136:139]
    ds_read_b128 v[20:23], v10 offset:57344
    v_mfma_f32_16x16x32_bf16 v[140:143], v[68:71], v[60:63], v[140:143]
    ds_read_b128 v[52:55], v8 offset:58880
    v_mfma_f32_16x16x32_bf16 v[144:147], v[72:75], v[56:59], v[144:147]
    ds_read_b128 v[64:67], v9 offset:55296
    v_mfma_f32_16x16x32_bf16 v[148:151], v[72:75], v[60:63], v[148:151]
    ds_read_b128 v[68:71], v9 offset:55808
    v_mfma_f32_16x16x32_bf16 v[152:155], v[76:79], v[56:59], v[152:155]
    ds_read_b128 v[72:75], v9 offset:56320
    v_mfma_f32_16x16x32_bf16 v[156:159], v[76:79], v[60:63], v[156:159]
    ds_read_b128 v[76:79], v9 offset:56832
    v_mfma_f32_16x16x32_bf16 v[160:163], v[80:83], v[56:59], v[160:163]
    v_mfma_f32_16x16x32_bf16 v[164:167], v[80:83], v[60:63], v[164:167]
    ds_read_b128 v[80:83], v9 offset:57344
    v_mfma_f32_16x16x32_bf16 v[168:171], v[84:87], v[56:59], v[168:171]
    v_mfma_f32_16x16x32_bf16 v[172:175], v[84:87], v[60:63], v[172:175]
    ds_read_b128 v[84:87], v9 offset:57856
    v_mfma_f32_16x16x32_bf16 v[176:179], v[88:91], v[56:59], v[176:179]
    v_mfma_f32_16x16x32_bf16 v[180:183], v[88:91], v[60:63], v[180:183]
    ds_read_b128 v[88:91], v9 offset:58368
    v_mfma_f32_16x16x32_bf16 v[184:187], v[92:95], v[56:59], v[184:187]
    v_mfma_f32_16x16x32_bf16 v[188:191], v[92:95], v[60:63], v[188:191]
    ds_read_b128 v[56:59], v11 offset:49152
    s_waitcnt lgkmcnt(9)
    v_mfma_f32_16x16x32_bf16 v[192:195], v[200:203], v[16:19], v[192:195]
    ds_read_b128 v[60:63], v11 offset:57344
    v_mfma_f32_16x16x32_bf16 v[196:199], v[200:203], v[20:23], v[196:199]
    ds_read_b128 v[92:95], v9 offset:58880
    v_mfma_f32_16x16x32_bf16 v[128:131], v[24:27], v[16:19], v[128:131]
    v_mfma_f32_16x16x32_bf16 v[132:135], v[24:27], v[20:23], v[132:135]
    v_mfma_f32_16x16x32_bf16 v[136:139], v[28:31], v[16:19], v[136:139]
    v_mfma_f32_16x16x32_bf16 v[140:143], v[28:31], v[20:23], v[140:143]
    v_mfma_f32_16x16x32_bf16 v[144:147], v[32:35], v[16:19], v[144:147]
    v_mfma_f32_16x16x32_bf16 v[148:151], v[32:35], v[20:23], v[148:151]
    v_mfma_f32_16x16x32_bf16 v[152:155], v[36:39], v[16:19], v[152:155]
    v_mfma_f32_16x16x32_bf16 v[156:159], v[36:39], v[20:23], v[156:159]
    v_mfma_f32_16x16x32_bf16 v[160:163], v[40:43], v[16:19], v[160:163]
    v_mfma_f32_16x16x32_bf16 v[164:167], v[40:43], v[20:23], v[164:167]
    v_mfma_f32_16x16x32_bf16 v[168:171], v[44:47], v[16:19], v[168:171]
    v_mfma_f32_16x16x32_bf16 v[172:175], v[44:47], v[20:23], v[172:175]
    s_waitcnt lgkmcnt(0)
    s_barrier
    v_mfma_f32_16x16x32_bf16 v[176:179], v[48:51], v[16:19], v[176:179]
    ds_read_b128 v[24:27], v8 offset:0
    v_mfma_f32_16x16x32_bf16 v[180:183], v[48:51], v[20:23], v[180:183]
    ds_read_b128 v[28:31], v8 offset:512
    v_mfma_f32_16x16x32_bf16 v[184:187], v[52:55], v[16:19], v[184:187]
    ds_read_b128 v[32:35], v8 offset:1024
    v_mfma_f32_16x16x32_bf16 v[188:191], v[52:55], v[20:23], v[188:191]
    ds_read_b128 v[36:39], v8 offset:1536
    v_mfma_f32_16x16x32_bf16 v[192:195], v[200:203], v[56:59], v[192:195]
    ds_read_b128 v[40:43], v8 offset:2048
    v_mfma_f32_16x16x32_bf16 v[196:199], v[200:203], v[60:63], v[196:199]
    ds_read_b128 v[44:47], v8 offset:2560
    v_mfma_f32_16x16x32_bf16 v[128:131], v[64:67], v[56:59], v[128:131]
    ds_read_b128 v[48:51], v8 offset:3072
    v_mfma_f32_16x16x32_bf16 v[132:135], v[64:67], v[60:63], v[132:135]
    ds_read_b128 v[16:19], v10 offset:0
    v_mfma_f32_16x16x32_bf16 v[136:139], v[68:71], v[56:59], v[136:139]
    ds_read_b128 v[20:23], v10 offset:8192
    v_mfma_f32_16x16x32_bf16 v[140:143], v[68:71], v[60:63], v[140:143]
    ds_read_b128 v[52:55], v8 offset:3584
    v_mfma_f32_16x16x32_bf16 v[144:147], v[72:75], v[56:59], v[144:147]
    ds_read_b128 v[64:67], v9 offset:0
    v_mfma_f32_16x16x32_bf16 v[148:151], v[72:75], v[60:63], v[148:151]
    ds_read_b128 v[68:71], v9 offset:512
    v_mfma_f32_16x16x32_bf16 v[152:155], v[76:79], v[56:59], v[152:155]
    ds_read_b128 v[72:75], v9 offset:1024
    v_mfma_f32_16x16x32_bf16 v[156:159], v[76:79], v[60:63], v[156:159]
    ds_read_b128 v[76:79], v9 offset:1536
    v_mfma_f32_16x16x32_bf16 v[160:163], v[80:83], v[56:59], v[160:163]
    v_mfma_f32_16x16x32_bf16 v[164:167], v[80:83], v[60:63], v[164:167]
    ds_read_b128 v[80:83], v9 offset:2048
    v_mfma_f32_16x16x32_bf16 v[168:171], v[84:87], v[56:59], v[168:171]
    v_mfma_f32_16x16x32_bf16 v[172:175], v[84:87], v[60:63], v[172:175]
    ds_read_b128 v[84:87], v9 offset:2560
    v_mfma_f32_16x16x32_bf16 v[176:179], v[88:91], v[56:59], v[176:179]
    v_mfma_f32_16x16x32_bf16 v[180:183], v[88:91], v[60:63], v[180:183]
    ds_read_b128 v[88:91], v9 offset:3072
    v_mfma_f32_16x16x32_bf16 v[184:187], v[92:95], v[56:59], v[184:187]
    v_mfma_f32_16x16x32_bf16 v[188:191], v[92:95], v[60:63], v[188:191]
    ds_read_b128 v[56:59], v11 offset:0
    s_waitcnt lgkmcnt(9)
    v_mfma_f32_16x16x32_bf16 v[192:195], v[200:203], v[16:19], v[192:195]
    ds_read_b128 v[60:63], v11 offset:8192
    v_mfma_f32_16x16x32_bf16 v[196:199], v[200:203], v[20:23], v[196:199]
    ds_read_b128 v[92:95], v9 offset:3584
    v_mfma_f32_16x16x32_bf16 v[128:131], v[24:27], v[16:19], v[128:131]
    v_mfma_f32_16x16x32_bf16 v[132:135], v[24:27], v[20:23], v[132:135]
    v_mfma_f32_16x16x32_bf16 v[136:139], v[28:31], v[16:19], v[136:139]
    v_mfma_f32_16x16x32_bf16 v[140:143], v[28:31], v[20:23], v[140:143]
    v_mfma_f32_16x16x32_bf16 v[144:147], v[32:35], v[16:19], v[144:147]
    v_mfma_f32_16x16x32_bf16 v[148:151], v[32:35], v[20:23], v[148:151]
    v_mfma_f32_16x16x32_bf16 v[152:155], v[36:39], v[16:19], v[152:155]
    v_mfma_f32_16x16x32_bf16 v[156:159], v[36:39], v[20:23], v[156:159]
    v_mfma_f32_16x16x32_bf16 v[160:163], v[40:43], v[16:19], v[160:163]
    v_mfma_f32_16x16x32_bf16 v[164:167], v[40:43], v[20:23], v[164:167]
    v_mfma_f32_16x16x32_bf16 v[168:171], v[44:47], v[16:19], v[168:171]
    v_mfma_f32_16x16x32_bf16 v[172:175], v[44:47], v[20:23], v[172:175]
    s_waitcnt lgkmcnt(0)
    s_barrier
    v_mfma_f32_16x16x32_bf16 v[176:179], v[48:51], v[16:19], v[176:179]
    ds_read_b128 v[24:27], v8 offset:18432
    v_mfma_f32_16x16x32_bf16 v[180:183], v[48:51], v[20:23], v[180:183]
    ds_read_b128 v[28:31], v8 offset:18944
    v_mfma_f32_16x16x32_bf16 v[184:187], v[52:55], v[16:19], v[184:187]
    ds_read_b128 v[32:35], v8 offset:19456
    v_mfma_f32_16x16x32_bf16 v[188:191], v[52:55], v[20:23], v[188:191]
    ds_read_b128 v[36:39], v8 offset:19968
    v_mfma_f32_16x16x32_bf16 v[192:195], v[200:203], v[56:59], v[192:195]
    ds_read_b128 v[40:43], v8 offset:20480
    v_mfma_f32_16x16x32_bf16 v[196:199], v[200:203], v[60:63], v[196:199]
    ds_read_b128 v[44:47], v8 offset:20992
    v_mfma_f32_16x16x32_bf16 v[128:131], v[64:67], v[56:59], v[128:131]
    ds_read_b128 v[48:51], v8 offset:21504
    v_mfma_f32_16x16x32_bf16 v[132:135], v[64:67], v[60:63], v[132:135]
    ds_read_b128 v[16:19], v10 offset:16384
    v_mfma_f32_16x16x32_bf16 v[136:139], v[68:71], v[56:59], v[136:139]
    ds_read_b128 v[20:23], v10 offset:24576
    v_mfma_f32_16x16x32_bf16 v[140:143], v[68:71], v[60:63], v[140:143]
    ds_read_b128 v[52:55], v8 offset:22016
    v_mfma_f32_16x16x32_bf16 v[144:147], v[72:75], v[56:59], v[144:147]
    ds_read_b128 v[64:67], v9 offset:18432
    v_mfma_f32_16x16x32_bf16 v[148:151], v[72:75], v[60:63], v[148:151]
    ds_read_b128 v[68:71], v9 offset:18944
    v_mfma_f32_16x16x32_bf16 v[152:155], v[76:79], v[56:59], v[152:155]
    ds_read_b128 v[72:75], v9 offset:19456
    v_mfma_f32_16x16x32_bf16 v[156:159], v[76:79], v[60:63], v[156:159]
    ds_read_b128 v[76:79], v9 offset:19968
    v_mfma_f32_16x16x32_bf16 v[160:163], v[80:83], v[56:59], v[160:163]
    v_mfma_f32_16x16x32_bf16 v[164:167], v[80:83], v[60:63], v[164:167]
    ds_read_b128 v[80:83], v9 offset:20480
    v_mfma_f32_16x16x32_bf16 v[168:171], v[84:87], v[56:59], v[168:171]
    v_mfma_f32_16x16x32_bf16 v[172:175], v[84:87], v[60:63], v[172:175]
    ds_read_b128 v[84:87], v9 offset:20992
    v_mfma_f32_16x16x32_bf16 v[176:179], v[88:91], v[56:59], v[176:179]
    v_mfma_f32_16x16x32_bf16 v[180:183], v[88:91], v[60:63], v[180:183]
    ds_read_b128 v[88:91], v9 offset:21504
    v_mfma_f32_16x16x32_bf16 v[184:187], v[92:95], v[56:59], v[184:187]
    v_mfma_f32_16x16x32_bf16 v[188:191], v[92:95], v[60:63], v[188:191]
    ds_read_b128 v[56:59], v11 offset:16384
    s_waitcnt lgkmcnt(9)
    v_mfma_f32_16x16x32_bf16 v[192:195], v[200:203], v[16:19], v[192:195]
    ds_read_b128 v[60:63], v11 offset:24576
    v_mfma_f32_16x16x32_bf16 v[196:199], v[200:203], v[20:23], v[196:199]
    ds_read_b128 v[92:95], v9 offset:22016
    v_mfma_f32_16x16x32_bf16 v[128:131], v[24:27], v[16:19], v[128:131]
    v_mfma_f32_16x16x32_bf16 v[132:135], v[24:27], v[20:23], v[132:135]
    v_mfma_f32_16x16x32_bf16 v[136:139], v[28:31], v[16:19], v[136:139]
    v_mfma_f32_16x16x32_bf16 v[140:143], v[28:31], v[20:23], v[140:143]
    v_mfma_f32_16x16x32_bf16 v[144:147], v[32:35], v[16:19], v[144:147]
    v_mfma_f32_16x16x32_bf16 v[148:151], v[32:35], v[20:23], v[148:151]
    v_mfma_f32_16x16x32_bf16 v[152:155], v[36:39], v[16:19], v[152:155]
    v_mfma_f32_16x16x32_bf16 v[156:159], v[36:39], v[20:23], v[156:159]
    v_mfma_f32_16x16x32_bf16 v[160:163], v[40:43], v[16:19], v[160:163]
    v_mfma_f32_16x16x32_bf16 v[164:167], v[40:43], v[20:23], v[164:167]
    v_mfma_f32_16x16x32_bf16 v[168:171], v[44:47], v[16:19], v[168:171]
    v_mfma_f32_16x16x32_bf16 v[172:175], v[44:47], v[20:23], v[172:175]
    s_waitcnt lgkmcnt(0)
    s_barrier
    v_mfma_f32_16x16x32_bf16 v[176:179], v[48:51], v[16:19], v[176:179]
    ds_read_b128 v[24:27], v8 offset:36864
    v_mfma_f32_16x16x32_bf16 v[180:183], v[48:51], v[20:23], v[180:183]
    ds_read_b128 v[28:31], v8 offset:37376
    v_mfma_f32_16x16x32_bf16 v[184:187], v[52:55], v[16:19], v[184:187]
    ds_read_b128 v[32:35], v8 offset:37888
    v_mfma_f32_16x16x32_bf16 v[188:191], v[52:55], v[20:23], v[188:191]
    ds_read_b128 v[36:39], v8 offset:38400
    v_mfma_f32_16x16x32_bf16 v[192:195], v[200:203], v[56:59], v[192:195]
    ds_read_b128 v[40:43], v8 offset:38912
    v_mfma_f32_16x16x32_bf16 v[196:199], v[200:203], v[60:63], v[196:199]
    ds_read_b128 v[44:47], v8 offset:39424
    v_mfma_f32_16x16x32_bf16 v[128:131], v[64:67], v[56:59], v[128:131]
    ds_read_b128 v[48:51], v8 offset:39936
    v_mfma_f32_16x16x32_bf16 v[132:135], v[64:67], v[60:63], v[132:135]
    ds_read_b128 v[16:19], v10 offset:32768
    v_mfma_f32_16x16x32_bf16 v[136:139], v[68:71], v[56:59], v[136:139]
    ds_read_b128 v[20:23], v10 offset:40960
    v_mfma_f32_16x16x32_bf16 v[140:143], v[68:71], v[60:63], v[140:143]
    ds_read_b128 v[52:55], v8 offset:40448
    v_mfma_f32_16x16x32_bf16 v[144:147], v[72:75], v[56:59], v[144:147]
    ds_read_b128 v[64:67], v9 offset:36864
    v_mfma_f32_16x16x32_bf16 v[148:151], v[72:75], v[60:63], v[148:151]
    ds_read_b128 v[68:71], v9 offset:37376
    v_mfma_f32_16x16x32_bf16 v[152:155], v[76:79], v[56:59], v[152:155]
    ds_read_b128 v[72:75], v9 offset:37888
    v_mfma_f32_16x16x32_bf16 v[156:159], v[76:79], v[60:63], v[156:159]
    ds_read_b128 v[76:79], v9 offset:38400
    v_mfma_f32_16x16x32_bf16 v[160:163], v[80:83], v[56:59], v[160:163]
    v_mfma_f32_16x16x32_bf16 v[164:167], v[80:83], v[60:63], v[164:167]
    ds_read_b128 v[80:83], v9 offset:38912
    v_mfma_f32_16x16x32_bf16 v[168:171], v[84:87], v[56:59], v[168:171]
    v_mfma_f32_16x16x32_bf16 v[172:175], v[84:87], v[60:63], v[172:175]
    ds_read_b128 v[84:87], v9 offset:39424
    v_mfma_f32_16x16x32_bf16 v[176:179], v[88:91], v[56:59], v[176:179]
    v_mfma_f32_16x16x32_bf16 v[180:183], v[88:91], v[60:63], v[180:183]
    ds_read_b128 v[88:91], v9 offset:39936
    v_mfma_f32_16x16x32_bf16 v[184:187], v[92:95], v[56:59], v[184:187]
    v_mfma_f32_16x16x32_bf16 v[188:191], v[92:95], v[60:63], v[188:191]
    ds_read_b128 v[56:59], v11 offset:32768
    s_waitcnt lgkmcnt(9)
    v_mfma_f32_16x16x32_bf16 v[192:195], v[200:203], v[16:19], v[192:195]
    ds_read_b128 v[60:63], v11 offset:40960
    v_mfma_f32_16x16x32_bf16 v[196:199], v[200:203], v[20:23], v[196:199]
    ds_read_b128 v[92:95], v9 offset:40448
    v_mfma_f32_16x16x32_bf16 v[128:131], v[24:27], v[16:19], v[128:131]
    v_mfma_f32_16x16x32_bf16 v[132:135], v[24:27], v[20:23], v[132:135]
    v_mfma_f32_16x16x32_bf16 v[136:139], v[28:31], v[16:19], v[136:139]
    v_mfma_f32_16x16x32_bf16 v[140:143], v[28:31], v[20:23], v[140:143]
    v_mfma_f32_16x16x32_bf16 v[144:147], v[32:35], v[16:19], v[144:147]
    v_mfma_f32_16x16x32_bf16 v[148:151], v[32:35], v[20:23], v[148:151]
    v_mfma_f32_16x16x32_bf16 v[152:155], v[36:39], v[16:19], v[152:155]
    v_mfma_f32_16x16x32_bf16 v[156:159], v[36:39], v[20:23], v[156:159]
    v_mfma_f32_16x16x32_bf16 v[160:163], v[40:43], v[16:19], v[160:163]
    v_mfma_f32_16x16x32_bf16 v[164:167], v[40:43], v[20:23], v[164:167]
    v_mfma_f32_16x16x32_bf16 v[168:171], v[44:47], v[16:19], v[168:171]
    v_mfma_f32_16x16x32_bf16 v[172:175], v[44:47], v[20:23], v[172:175]
    s_waitcnt lgkmcnt(0)
    s_barrier
    v_mfma_f32_16x16x32_bf16 v[176:179], v[48:51], v[16:19], v[176:179]
    ds_read_b128 v[24:27], v8 offset:55296
    v_mfma_f32_16x16x32_bf16 v[180:183], v[48:51], v[20:23], v[180:183]
    ds_read_b128 v[28:31], v8 offset:55808
    v_mfma_f32_16x16x32_bf16 v[184:187], v[52:55], v[16:19], v[184:187]
    ds_read_b128 v[32:35], v8 offset:56320
    v_mfma_f32_16x16x32_bf16 v[188:191], v[52:55], v[20:23], v[188:191]
    ds_read_b128 v[36:39], v8 offset:56832
    v_mfma_f32_16x16x32_bf16 v[192:195], v[200:203], v[56:59], v[192:195]
    ds_read_b128 v[40:43], v8 offset:57344
    v_mfma_f32_16x16x32_bf16 v[196:199], v[200:203], v[60:63], v[196:199]
    ds_read_b128 v[44:47], v8 offset:57856
    v_mfma_f32_16x16x32_bf16 v[128:131], v[64:67], v[56:59], v[128:131]
    ds_read_b128 v[48:51], v8 offset:58368
    v_mfma_f32_16x16x32_bf16 v[132:135], v[64:67], v[60:63], v[132:135]
    ds_read_b128 v[16:19], v10 offset:49152
    v_mfma_f32_16x16x32_bf16 v[136:139], v[68:71], v[56:59], v[136:139]
    ds_read_b128 v[20:23], v10 offset:57344
    v_mfma_f32_16x16x32_bf16 v[140:143], v[68:71], v[60:63], v[140:143]
    ds_read_b128 v[52:55], v8 offset:58880
    v_mfma_f32_16x16x32_bf16 v[144:147], v[72:75], v[56:59], v[144:147]
    ds_read_b128 v[64:67], v9 offset:55296
    v_mfma_f32_16x16x32_bf16 v[148:151], v[72:75], v[60:63], v[148:151]
    ds_read_b128 v[68:71], v9 offset:55808
    v_mfma_f32_16x16x32_bf16 v[152:155], v[76:79], v[56:59], v[152:155]
    ds_read_b128 v[72:75], v9 offset:56320
    v_mfma_f32_16x16x32_bf16 v[156:159], v[76:79], v[60:63], v[156:159]
    ds_read_b128 v[76:79], v9 offset:56832
    v_mfma_f32_16x16x32_bf16 v[160:163], v[80:83], v[56:59], v[160:163]
    v_mfma_f32_16x16x32_bf16 v[164:167], v[80:83], v[60:63], v[164:167]
    ds_read_b128 v[80:83], v9 offset:57344
    v_mfma_f32_16x16x32_bf16 v[168:171], v[84:87], v[56:59], v[168:171]
    v_mfma_f32_16x16x32_bf16 v[172:175], v[84:87], v[60:63], v[172:175]
    ds_read_b128 v[84:87], v9 offset:57856
    v_mfma_f32_16x16x32_bf16 v[176:179], v[88:91], v[56:59], v[176:179]
    v_mfma_f32_16x16x32_bf16 v[180:183], v[88:91], v[60:63], v[180:183]
    ds_read_b128 v[88:91], v9 offset:58368
    v_mfma_f32_16x16x32_bf16 v[184:187], v[92:95], v[56:59], v[184:187]
    v_mfma_f32_16x16x32_bf16 v[188:191], v[92:95], v[60:63], v[188:191]
    ds_read_b128 v[56:59], v11 offset:49152
    s_waitcnt lgkmcnt(9)
    v_mfma_f32_16x16x32_bf16 v[192:195], v[200:203], v[16:19], v[192:195]
    ds_read_b128 v[60:63], v11 offset:57344
    v_mfma_f32_16x16x32_bf16 v[196:199], v[200:203], v[20:23], v[196:199]
    ds_read_b128 v[92:95], v9 offset:58880
    v_mfma_f32_16x16x32_bf16 v[128:131], v[24:27], v[16:19], v[128:131]
    v_mfma_f32_16x16x32_bf16 v[132:135], v[24:27], v[20:23], v[132:135]
    v_mfma_f32_16x16x32_bf16 v[136:139], v[28:31], v[16:19], v[136:139]
    v_mfma_f32_16x16x32_bf16 v[140:143], v[28:31], v[20:23], v[140:143]
    v_mfma_f32_16x16x32_bf16 v[144:147], v[32:35], v[16:19], v[144:147]
    v_mfma_f32_16x16x32_bf16 v[148:151], v[32:35], v[20:23], v[148:151]
    v_mfma_f32_16x16x32_bf16 v[152:155], v[36:39], v[16:19], v[152:155]
    v_mfma_f32_16x16x32_bf16 v[156:159], v[36:39], v[20:23], v[156:159]
    v_mfma_f32_16x16x32_bf16 v[160:163], v[40:43], v[16:19], v[160:163]
    v_mfma_f32_16x16x32_bf16 v[164:167], v[40:43], v[20:23], v[164:167]
    v_mfma_f32_16x16x32_bf16 v[168:171], v[44:47], v[16:19], v[168:171]
    v_mfma_f32_16x16x32_bf16 v[172:175], v[44:47], v[20:23], v[172:175]
    s_waitcnt lgkmcnt(0)
    s_barrier
    v_mfma_f32_16x16x32_bf16 v[176:179], v[48:51], v[16:19], v[176:179]
    ds_read_b128 v[24:27], v8 offset:0
    v_mfma_f32_16x16x32_bf16 v[180:183], v[48:51], v[20:23], v[180:183]
    ds_read_b128 v[28:31], v8 offset:512
    v_mfma_f32_16x16x32_bf16 v[184:187], v[52:55], v[16:19], v[184:187]
    ds_read_b128 v[32:35], v8 offset:1024
    v_mfma_f32_16x16x32_bf16 v[188:191], v[52:55], v[20:23], v[188:191]
    ds_read_b128 v[36:39], v8 offset:1536
    v_mfma_f32_16x16x32_bf16 v[192:195], v[200:203], v[56:59], v[192:195]
    ds_read_b128 v[40:43], v8 offset:2048
    v_mfma_f32_16x16x32_bf16 v[196:199], v[200:203], v[60:63], v[196:199]
    ds_read_b128 v[44:47], v8 offset:2560
    v_mfma_f32_16x16x32_bf16 v[128:131], v[64:67], v[56:59], v[128:131]
    ds_read_b128 v[48:51], v8 offset:3072
    v_mfma_f32_16x16x32_bf16 v[132:135], v[64:67], v[60:63], v[132:135]
    ds_read_b128 v[16:19], v10 offset:0
    v_mfma_f32_16x16x32_bf16 v[136:139], v[68:71], v[56:59], v[136:139]
    ds_read_b128 v[20:23], v10 offset:8192
    v_mfma_f32_16x16x32_bf16 v[140:143], v[68:71], v[60:63], v[140:143]
    ds_read_b128 v[52:55], v8 offset:3584
    v_mfma_f32_16x16x32_bf16 v[144:147], v[72:75], v[56:59], v[144:147]
    ds_read_b128 v[64:67], v9 offset:0
    v_mfma_f32_16x16x32_bf16 v[148:151], v[72:75], v[60:63], v[148:151]
    ds_read_b128 v[68:71], v9 offset:512
    v_mfma_f32_16x16x32_bf16 v[152:155], v[76:79], v[56:59], v[152:155]
    ds_read_b128 v[72:75], v9 offset:1024
    v_mfma_f32_16x16x32_bf16 v[156:159], v[76:79], v[60:63], v[156:159]
    ds_read_b128 v[76:79], v9 offset:1536
    v_mfma_f32_16x16x32_bf16 v[160:163], v[80:83], v[56:59], v[160:163]
    v_mfma_f32_16x16x32_bf16 v[164:167], v[80:83], v[60:63], v[164:167]
    ds_read_b128 v[80:83], v9 offset:2048
    v_mfma_f32_16x16x32_bf16 v[168:171], v[84:87], v[56:59], v[168:171]
    v_mfma_f32_16x16x32_bf16 v[172:175], v[84:87], v[60:63], v[172:175]
    ds_read_b128 v[84:87], v9 offset:2560
    v_mfma_f32_16x16x32_bf16 v[176:179], v[88:91], v[56:59], v[176:179]
    v_mfma_f32_16x16x32_bf16 v[180:183], v[88:91], v[60:63], v[180:183]
    ds_read_b128 v[88:91], v9 offset:3072
    v_mfma_f32_16x16x32_bf16 v[184:187], v[92:95], v[56:59], v[184:187]
    v_mfma_f32_16x16x32_bf16 v[188:191], v[92:95], v[60:63], v[188:191]
    ds_read_b128 v[56:59], v11 offset:0
    s_waitcnt lgkmcnt(9)
    v_mfma_f32_16x16x32_bf16 v[192:195], v[200:203], v[16:19], v[192:195]
    ds_read_b128 v[60:63], v11 offset:8192
    v_mfma_f32_16x16x32_bf16 v[196:199], v[200:203], v[20:23], v[196:199]
    ds_read_b128 v[92:95], v9 offset:3584
    v_mfma_f32_16x16x32_bf16 v[128:131], v[24:27], v[16:19], v[128:131]
    v_mfma_f32_16x16x32_bf16 v[132:135], v[24:27], v[20:23], v[132:135]
    v_mfma_f32_16x16x32_bf16 v[136:139], v[28:31], v[16:19], v[136:139]
    v_mfma_f32_16x16x32_bf16 v[140:143], v[28:31], v[20:23], v[140:143]
    v_mfma_f32_16x16x32_bf16 v[144:147], v[32:35], v[16:19], v[144:147]
    v_mfma_f32_16x16x32_bf16 v[148:151], v[32:35], v[20:23], v[148:151]
    v_mfma_f32_16x16x32_bf16 v[152:155], v[36:39], v[16:19], v[152:155]
    v_mfma_f32_16x16x32_bf16 v[156:159], v[36:39], v[20:23], v[156:159]
    v_mfma_f32_16x16x32_bf16 v[160:163], v[40:43], v[16:19], v[160:163]
    v_mfma_f32_16x16x32_bf16 v[164:167], v[40:43], v[20:23], v[164:167]
    v_mfma_f32_16x16x32_bf16 v[168:171], v[44:47], v[16:19], v[168:171]
    v_mfma_f32_16x16x32_bf16 v[172:175], v[44:47], v[20:23], v[172:175]
    v_mfma_f32_16x16x32_bf16 v[176:179], v[48:51], v[16:19], v[176:179]
    v_mfma_f32_16x16x32_bf16 v[180:183], v[48:51], v[20:23], v[180:183]
    s_waitcnt lgkmcnt(10)
    v_mfma_f32_16x16x32_bf16 v[184:187], v[52:55], v[16:19], v[184:187]
    v_mfma_f32_16x16x32_bf16 v[188:191], v[52:55], v[20:23], v[188:191]
    s_waitcnt lgkmcnt(1)
    v_mfma_f32_16x16x32_bf16 v[192:195], v[200:203], v[56:59], v[192:195]
    v_mfma_f32_16x16x32_bf16 v[196:199], v[200:203], v[60:63], v[196:199]
    v_mfma_f32_16x16x32_bf16 v[128:131], v[64:67], v[56:59], v[128:131]
    v_mfma_f32_16x16x32_bf16 v[132:135], v[64:67], v[60:63], v[132:135]
    v_mfma_f32_16x16x32_bf16 v[136:139], v[68:71], v[56:59], v[136:139]
    v_mfma_f32_16x16x32_bf16 v[140:143], v[68:71], v[60:63], v[140:143]
    v_mfma_f32_16x16x32_bf16 v[144:147], v[72:75], v[56:59], v[144:147]
    v_mfma_f32_16x16x32_bf16 v[148:151], v[72:75], v[60:63], v[148:151]
    v_mfma_f32_16x16x32_bf16 v[152:155], v[76:79], v[56:59], v[152:155]
    v_mfma_f32_16x16x32_bf16 v[156:159], v[76:79], v[60:63], v[156:159]
    v_mfma_f32_16x16x32_bf16 v[160:163], v[80:83], v[56:59], v[160:163]
    v_mfma_f32_16x16x32_bf16 v[164:167], v[80:83], v[60:63], v[164:167]
    v_mfma_f32_16x16x32_bf16 v[168:171], v[84:87], v[56:59], v[168:171]
    v_mfma_f32_16x16x32_bf16 v[172:175], v[84:87], v[60:63], v[172:175]
    v_mfma_f32_16x16x32_bf16 v[176:179], v[88:91], v[56:59], v[176:179]
    v_mfma_f32_16x16x32_bf16 v[180:183], v[88:91], v[60:63], v[180:183]
    s_waitcnt lgkmcnt(0)
    v_mfma_f32_16x16x32_bf16 v[184:187], v[92:95], v[56:59], v[184:187]
    v_mfma_f32_16x16x32_bf16 v[188:191], v[92:95], v[60:63], v[188:191]
    v_lshlrev_b32 v12, 7, v4
    v_add_u32 v12, 143360, v12
parallel_sum__ssm_conv_s5__mixer_token_mlp__prompt_kernel_wl_19:
    ds_read_b32 v13, v7 offset:1552
    s_waitcnt lgkmcnt(0)
    v_readfirstlane_b32 s15, v13
    s_cmp_eq_u32 s15, 1
    s_cbranch_scc0 parallel_sum__ssm_conv_s5__mixer_token_mlp__prompt_kernel_wl_19
    ds_read_b128 v[16:19], v12 offset:0
    ds_read_b128 v[48:51], v12 offset:512
    ds_read_b128 v[20:23], v12 offset:16
    ds_read_b128 v[52:55], v12 offset:528
    ds_read_b128 v[24:27], v12 offset:32
    ds_read_b128 v[56:59], v12 offset:544
    ds_read_b128 v[28:31], v12 offset:48
    ds_read_b128 v[60:63], v12 offset:560
    ds_read_b128 v[32:35], v12 offset:64
    ds_read_b128 v[64:67], v12 offset:576
    ds_read_b128 v[36:39], v12 offset:80
    ds_read_b128 v[68:71], v12 offset:592
    ds_read_b128 v[40:43], v12 offset:96
    ds_read_b128 v[72:75], v12 offset:608
    ds_read_b128 v[44:47], v12 offset:112
    ds_read_b128 v[76:79], v12 offset:624
    s_waitcnt lgkmcnt(14)
    v_pk_mul_f32 v[128:129], v[128:129], v[16:17]
    v_pk_mul_f32 v[132:133], v[132:133], v[16:17]
    v_pk_mul_f32 v[130:131], v[130:131], v[18:19]
    v_pk_mul_f32 v[134:135], v[134:135], v[18:19]
    v_pk_fma_f32 v[128:129], v[48:49], v[192:193], v[128:129] op_sel_hi:[1,0,1]
    v_pk_fma_f32 v[132:133], v[48:49], v[196:197], v[132:133] op_sel_hi:[1,0,1]
    v_pk_fma_f32 v[130:131], v[50:51], v[192:193], v[130:131] op_sel_hi:[1,0,1]
    v_pk_fma_f32 v[134:135], v[50:51], v[196:197], v[134:135] op_sel_hi:[1,0,1]
    s_waitcnt lgkmcnt(12)
    v_pk_mul_f32 v[136:137], v[136:137], v[20:21]
    v_pk_mul_f32 v[140:141], v[140:141], v[20:21]
    v_pk_mul_f32 v[138:139], v[138:139], v[22:23]
    v_pk_mul_f32 v[142:143], v[142:143], v[22:23]
    v_pk_fma_f32 v[136:137], v[52:53], v[192:193], v[136:137] op_sel_hi:[1,0,1]
    v_pk_fma_f32 v[140:141], v[52:53], v[196:197], v[140:141] op_sel_hi:[1,0,1]
    v_pk_fma_f32 v[138:139], v[54:55], v[192:193], v[138:139] op_sel_hi:[1,0,1]
    v_pk_fma_f32 v[142:143], v[54:55], v[196:197], v[142:143] op_sel_hi:[1,0,1]
    s_waitcnt lgkmcnt(10)
    v_pk_mul_f32 v[144:145], v[144:145], v[24:25]
    v_pk_mul_f32 v[148:149], v[148:149], v[24:25]
    v_pk_mul_f32 v[146:147], v[146:147], v[26:27]
    v_pk_mul_f32 v[150:151], v[150:151], v[26:27]
    v_pk_fma_f32 v[144:145], v[56:57], v[192:193], v[144:145] op_sel_hi:[1,0,1]
    v_pk_fma_f32 v[148:149], v[56:57], v[196:197], v[148:149] op_sel_hi:[1,0,1]
    v_pk_fma_f32 v[146:147], v[58:59], v[192:193], v[146:147] op_sel_hi:[1,0,1]
    v_pk_fma_f32 v[150:151], v[58:59], v[196:197], v[150:151] op_sel_hi:[1,0,1]
    s_waitcnt lgkmcnt(8)
    v_pk_mul_f32 v[152:153], v[152:153], v[28:29]
    v_pk_mul_f32 v[156:157], v[156:157], v[28:29]
    v_pk_mul_f32 v[154:155], v[154:155], v[30:31]
    v_pk_mul_f32 v[158:159], v[158:159], v[30:31]
    v_pk_fma_f32 v[152:153], v[60:61], v[192:193], v[152:153] op_sel_hi:[1,0,1]
    v_pk_fma_f32 v[156:157], v[60:61], v[196:197], v[156:157] op_sel_hi:[1,0,1]
    v_pk_fma_f32 v[154:155], v[62:63], v[192:193], v[154:155] op_sel_hi:[1,0,1]
    v_pk_fma_f32 v[158:159], v[62:63], v[196:197], v[158:159] op_sel_hi:[1,0,1]
    s_waitcnt lgkmcnt(6)
    v_pk_mul_f32 v[160:161], v[160:161], v[32:33]
    v_pk_mul_f32 v[164:165], v[164:165], v[32:33]
    v_pk_mul_f32 v[162:163], v[162:163], v[34:35]
    v_pk_mul_f32 v[166:167], v[166:167], v[34:35]
    v_pk_fma_f32 v[160:161], v[64:65], v[192:193], v[160:161] op_sel_hi:[1,0,1]
    v_pk_fma_f32 v[164:165], v[64:65], v[196:197], v[164:165] op_sel_hi:[1,0,1]
    v_pk_fma_f32 v[162:163], v[66:67], v[192:193], v[162:163] op_sel_hi:[1,0,1]
    v_pk_fma_f32 v[166:167], v[66:67], v[196:197], v[166:167] op_sel_hi:[1,0,1]
    s_waitcnt lgkmcnt(4)
    v_pk_mul_f32 v[168:169], v[168:169], v[36:37]
    v_pk_mul_f32 v[172:173], v[172:173], v[36:37]
    v_pk_mul_f32 v[170:171], v[170:171], v[38:39]
    v_pk_mul_f32 v[174:175], v[174:175], v[38:39]
    v_pk_fma_f32 v[168:169], v[68:69], v[192:193], v[168:169] op_sel_hi:[1,0,1]
    v_pk_fma_f32 v[172:173], v[68:69], v[196:197], v[172:173] op_sel_hi:[1,0,1]
    v_pk_fma_f32 v[170:171], v[70:71], v[192:193], v[170:171] op_sel_hi:[1,0,1]
    v_pk_fma_f32 v[174:175], v[70:71], v[196:197], v[174:175] op_sel_hi:[1,0,1]
    s_waitcnt lgkmcnt(2)
    v_pk_mul_f32 v[176:177], v[176:177], v[40:41]
    v_pk_mul_f32 v[180:181], v[180:181], v[40:41]
    v_pk_mul_f32 v[178:179], v[178:179], v[42:43]
    v_pk_mul_f32 v[182:183], v[182:183], v[42:43]
    v_pk_fma_f32 v[176:177], v[72:73], v[192:193], v[176:177] op_sel_hi:[1,0,1]
    v_pk_fma_f32 v[180:181], v[72:73], v[196:197], v[180:181] op_sel_hi:[1,0,1]
    v_pk_fma_f32 v[178:179], v[74:75], v[192:193], v[178:179] op_sel_hi:[1,0,1]
    v_pk_fma_f32 v[182:183], v[74:75], v[196:197], v[182:183] op_sel_hi:[1,0,1]
    s_waitcnt lgkmcnt(0)
    v_pk_mul_f32 v[184:185], v[184:185], v[44:45]
    v_pk_mul_f32 v[188:189], v[188:189], v[44:45]
    v_pk_mul_f32 v[186:187], v[186:187], v[46:47]
    v_pk_mul_f32 v[190:191], v[190:191], v[46:47]
    v_pk_fma_f32 v[184:185], v[76:77], v[192:193], v[184:185] op_sel_hi:[1,0,1]
    v_pk_fma_f32 v[188:189], v[76:77], v[196:197], v[188:189] op_sel_hi:[1,0,1]
    v_pk_fma_f32 v[186:187], v[78:79], v[192:193], v[186:187] op_sel_hi:[1,0,1]
    v_pk_fma_f32 v[190:191], v[78:79], v[196:197], v[190:191] op_sel_hi:[1,0,1]
    v_pk_fma_f32 v[192:193], v[208:209], v[132:133], v[136:137] op_sel:[1,0,0] op_sel_hi:[1,1,1] neg_lo:[1,0,0] neg_hi:[1,0,0]
    v_pk_fma_f32 v[194:195], v[208:209], v[134:135], v[138:139] op_sel:[1,0,0] op_sel_hi:[1,1,1] neg_lo:[1,0,0] neg_hi:[1,0,0]
    v_pk_fma_f32 v[196:197], v[208:209], v[128:129], v[140:141] op_sel:[1,0,0] op_sel_hi:[1,1,1]
    v_pk_fma_f32 v[198:199], v[208:209], v[130:131], v[142:143] op_sel:[1,0,0] op_sel_hi:[1,1,1]
    v_pk_fma_f32 v[192:193], v[208:209], v[128:129], v[192:193] op_sel_hi:[0,1,1]
    v_pk_fma_f32 v[194:195], v[208:209], v[130:131], v[194:195] op_sel_hi:[0,1,1]
    v_pk_fma_f32 v[196:197], v[208:209], v[132:133], v[196:197] op_sel_hi:[0,1,1]
    v_pk_fma_f32 v[198:199], v[208:209], v[134:135], v[198:199] op_sel_hi:[0,1,1]
    v_pk_fma_f32 v[96:97], v[208:209], v[196:197], v[144:145] op_sel:[1,0,0] op_sel_hi:[1,1,1] neg_lo:[1,0,0] neg_hi:[1,0,0]
    v_pk_fma_f32 v[98:99], v[208:209], v[198:199], v[146:147] op_sel:[1,0,0] op_sel_hi:[1,1,1] neg_lo:[1,0,0] neg_hi:[1,0,0]
    v_pk_fma_f32 v[100:101], v[208:209], v[192:193], v[148:149] op_sel:[1,0,0] op_sel_hi:[1,1,1]
    v_pk_fma_f32 v[102:103], v[208:209], v[194:195], v[150:151] op_sel:[1,0,0] op_sel_hi:[1,1,1]
    v_pk_fma_f32 v[96:97], v[208:209], v[192:193], v[96:97] op_sel_hi:[0,1,1]
    v_pk_fma_f32 v[98:99], v[208:209], v[194:195], v[98:99] op_sel_hi:[0,1,1]
    v_pk_fma_f32 v[100:101], v[208:209], v[196:197], v[100:101] op_sel_hi:[0,1,1]
    v_pk_fma_f32 v[102:103], v[208:209], v[198:199], v[102:103] op_sel_hi:[0,1,1]
    v_pk_fma_f32 v[192:193], v[208:209], v[100:101], v[152:153] op_sel:[1,0,0] op_sel_hi:[1,1,1] neg_lo:[1,0,0] neg_hi:[1,0,0]
    v_pk_fma_f32 v[194:195], v[208:209], v[102:103], v[154:155] op_sel:[1,0,0] op_sel_hi:[1,1,1] neg_lo:[1,0,0] neg_hi:[1,0,0]
    v_pk_fma_f32 v[196:197], v[208:209], v[96:97], v[156:157] op_sel:[1,0,0] op_sel_hi:[1,1,1]
    v_pk_fma_f32 v[198:199], v[208:209], v[98:99], v[158:159] op_sel:[1,0,0] op_sel_hi:[1,1,1]
    v_pk_fma_f32 v[192:193], v[208:209], v[96:97], v[192:193] op_sel_hi:[0,1,1]
    v_pk_fma_f32 v[194:195], v[208:209], v[98:99], v[194:195] op_sel_hi:[0,1,1]
    v_pk_fma_f32 v[196:197], v[208:209], v[100:101], v[196:197] op_sel_hi:[0,1,1]
    v_pk_fma_f32 v[198:199], v[208:209], v[102:103], v[198:199] op_sel_hi:[0,1,1]
    v_pk_fma_f32 v[96:97], v[208:209], v[196:197], v[160:161] op_sel:[1,0,0] op_sel_hi:[1,1,1] neg_lo:[1,0,0] neg_hi:[1,0,0]
    v_pk_fma_f32 v[98:99], v[208:209], v[198:199], v[162:163] op_sel:[1,0,0] op_sel_hi:[1,1,1] neg_lo:[1,0,0] neg_hi:[1,0,0]
    v_pk_fma_f32 v[100:101], v[208:209], v[192:193], v[164:165] op_sel:[1,0,0] op_sel_hi:[1,1,1]
    v_pk_fma_f32 v[102:103], v[208:209], v[194:195], v[166:167] op_sel:[1,0,0] op_sel_hi:[1,1,1]
    v_pk_fma_f32 v[96:97], v[208:209], v[192:193], v[96:97] op_sel_hi:[0,1,1]
    v_pk_fma_f32 v[98:99], v[208:209], v[194:195], v[98:99] op_sel_hi:[0,1,1]
    v_pk_fma_f32 v[100:101], v[208:209], v[196:197], v[100:101] op_sel_hi:[0,1,1]
    v_pk_fma_f32 v[102:103], v[208:209], v[198:199], v[102:103] op_sel_hi:[0,1,1]
    v_pk_fma_f32 v[192:193], v[208:209], v[100:101], v[168:169] op_sel:[1,0,0] op_sel_hi:[1,1,1] neg_lo:[1,0,0] neg_hi:[1,0,0]
    v_pk_fma_f32 v[194:195], v[208:209], v[102:103], v[170:171] op_sel:[1,0,0] op_sel_hi:[1,1,1] neg_lo:[1,0,0] neg_hi:[1,0,0]
    v_pk_fma_f32 v[196:197], v[208:209], v[96:97], v[172:173] op_sel:[1,0,0] op_sel_hi:[1,1,1]
    v_pk_fma_f32 v[198:199], v[208:209], v[98:99], v[174:175] op_sel:[1,0,0] op_sel_hi:[1,1,1]
    v_pk_fma_f32 v[192:193], v[208:209], v[96:97], v[192:193] op_sel_hi:[0,1,1]
    v_pk_fma_f32 v[194:195], v[208:209], v[98:99], v[194:195] op_sel_hi:[0,1,1]
    v_pk_fma_f32 v[196:197], v[208:209], v[100:101], v[196:197] op_sel_hi:[0,1,1]
    v_pk_fma_f32 v[198:199], v[208:209], v[102:103], v[198:199] op_sel_hi:[0,1,1]
    v_pk_fma_f32 v[96:97], v[208:209], v[196:197], v[176:177] op_sel:[1,0,0] op_sel_hi:[1,1,1] neg_lo:[1,0,0] neg_hi:[1,0,0]
    v_pk_fma_f32 v[98:99], v[208:209], v[198:199], v[178:179] op_sel:[1,0,0] op_sel_hi:[1,1,1] neg_lo:[1,0,0] neg_hi:[1,0,0]
    v_pk_fma_f32 v[100:101], v[208:209], v[192:193], v[180:181] op_sel:[1,0,0] op_sel_hi:[1,1,1]
    v_pk_fma_f32 v[102:103], v[208:209], v[194:195], v[182:183] op_sel:[1,0,0] op_sel_hi:[1,1,1]
    v_pk_fma_f32 v[96:97], v[208:209], v[192:193], v[96:97] op_sel_hi:[0,1,1]
    v_pk_fma_f32 v[98:99], v[208:209], v[194:195], v[98:99] op_sel_hi:[0,1,1]
    v_pk_fma_f32 v[100:101], v[208:209], v[196:197], v[100:101] op_sel_hi:[0,1,1]
    v_pk_fma_f32 v[102:103], v[208:209], v[198:199], v[102:103] op_sel_hi:[0,1,1]
    v_pk_fma_f32 v[192:193], v[208:209], v[100:101], v[184:185] op_sel:[1,0,0] op_sel_hi:[1,1,1] neg_lo:[1,0,0] neg_hi:[1,0,0]
    v_pk_fma_f32 v[194:195], v[208:209], v[102:103], v[186:187] op_sel:[1,0,0] op_sel_hi:[1,1,1] neg_lo:[1,0,0] neg_hi:[1,0,0]
    v_pk_fma_f32 v[196:197], v[208:209], v[96:97], v[188:189] op_sel:[1,0,0] op_sel_hi:[1,1,1]
    v_pk_fma_f32 v[198:199], v[208:209], v[98:99], v[190:191] op_sel:[1,0,0] op_sel_hi:[1,1,1]
    v_pk_fma_f32 v[192:193], v[208:209], v[96:97], v[192:193] op_sel_hi:[0,1,1]
    v_pk_fma_f32 v[194:195], v[208:209], v[98:99], v[194:195] op_sel_hi:[0,1,1]
    v_pk_fma_f32 v[196:197], v[208:209], v[100:101], v[196:197] op_sel_hi:[0,1,1]
    v_pk_fma_f32 v[198:199], v[208:209], v[102:103], v[198:199] op_sel_hi:[0,1,1]
    v_fma_f32 v102, -v219, v196, v193
    v_fma_f32 v103, v219, v192, v197
    v_fma_f32 v102, v218, v192, v102
    v_fma_f32 v103, v218, v196, v103
    v_fma_f32 v104, -v219, v103, v194
    v_fma_f32 v105, v219, v102, v198
    v_fma_f32 v104, v218, v102, v104
    v_fma_f32 v105, v218, v103, v105
    v_fma_f32 v102, -v219, v105, v195
    v_fma_f32 v103, v219, v104, v199
    v_fma_f32 v102, v218, v104, v102
    v_fma_f32 v103, v218, v105, v103
    v_lshlrev_b32 v8, 3, v2
    v_add_u32 v9, s65, v8
    v_lshl_add_u32 v10, v3, 3, s65
    ds_write_b64 v9, v[102:103]
    ds_read_b64 v[108:109], v10 offset:0
    ds_read_b64 v[110:111], v10 offset:128
    ds_read_b64 v[112:113], v10 offset:256
    ds_read_b64 v[114:115], v10 offset:384
    s_lshl_b32 s12, s63, 4
    s_add_u32 s12, s12, s64
    s_lshl_b32 s12, s12, 7
    s_waitcnt lgkmcnt(0)
    v_cmp_eq_u32 s[74:75], 1, v4
    v_cmp_eq_u32 s[76:77], 2, v4
    v_cmp_eq_u32 s[78:79], 3, v4
    v_mov_b32 v200, 0
    v_mov_b32 v201, 0
    v_cndmask_b32 v200, v200, v108, s[74:75]
    v_cndmask_b32 v201, v201, v109, s[74:75]
    v_fma_f32 v102, -v215, v109, v110
    v_fma_f32 v103, v215, v108, v111
    v_fma_f32 v102, v214, v108, v102
    v_fma_f32 v103, v214, v109, v103
    v_cndmask_b32 v200, v200, v102, s[76:77]
    v_cndmask_b32 v201, v201, v103, s[76:77]
    v_fma_f32 v100, -v215, v103, v112
    v_fma_f32 v101, v215, v102, v113
    v_fma_f32 v100, v214, v102, v100
    v_fma_f32 v101, v214, v103, v101
    v_cndmask_b32 v200, v200, v100, s[78:79]
    v_cndmask_b32 v201, v201, v101, s[78:79]
    v_fma_f32 v102, -v215, v101, v114
    v_fma_f32 v103, v215, v100, v115
    v_fma_f32 v102, v214, v100, v102
    v_fma_f32 v103, v214, v101, v103
    v_min_u32 v102, -2, v102
    v_min_u32 v103, -2, v103
    s_mov_b64 exec, 0xffff
    buffer_store_dwordx2 v[102:103], v8, s[52:55], s12 offen sc1
    s_mov_b64 exec, -1
    s_branch parallel_sum__ssm_conv_s5__mixer_token_mlp__prompt_kernel_gbc2_18
parallel_sum__ssm_conv_s5__mixer_token_mlp__prompt_kernel_gbl_5:
    s_and_b32 s14, s3, 3
    s_mul_i32 s11, s5, 3
    s_mul_i32 s12, s6, 3
    s_add_u32 s11, s11, s12
    s_mul_i32 s12, s51, 3
    s_add_u32 s11, s11, s12
    s_mul_i32 s12, s11, 57
    s_lshr_b32 s12, s12, 9
    s_mul_i32 s12, s12, 9
    s_sub_u32 s11, s11, s12
    s_lshl_b32 s11, s11, 7
    v_lshrrev_b32 v5, 3, v2
    v_and_b32 v7, 7, v2
    s_lshl_b32 s12, s64, 7
    s_lshl_b32 s13, s14, 5
    s_add_u32 s12, s12, s13
    v_and_b32 v8, 3, v5
    v_lshlrev_b32 v8, 3, v8
    v_lshrrev_b32 v6, 5, v2
    v_add3_u32 v8, v8, v6, s12
    v_mul_u32_u24 v8, 1152, v8
    v_and_b32 v6, 1, v4
    s_lshl_b32 s13, s14, 1
    v_or_b32 v6, s13, v6
    v_xor_b32 v6, v6, v7
    v_lshl_add_u32 v8, v6, 4, v8
    v_add_u32 v9, 1280, v8
    v_add_u32 v10, 2560, v8
    v_add_u32 v11, 3840, v8
    s_lshl_b32 s12, s6, 6
    s_lshl_b32 s13, s8, 5
    s_add_u32 s12, s12, s13
    v_add_u32 v16, s12, v5
    v_mul_u32_u24 v16, 1152, v16
    v_xor_b32 v6, v7, v4
    v_xor_b32 v7, 4, v6
    v_lshl_add_u32 v17, v7, 4, v16
    v_lshl_add_u32 v16, v6, 4, v16
    v_add_u32 v17, 8192, v17
    v_add_u32 v18, 16384, v16
    v_add_u32 v19, 16384, v17
    s_lshl_b32 s12, s14, 12
    s_waitcnt lgkmcnt(0)
    s_mov_b32 s56, s16
    s_mov_b32 s57, s17
    s_mov_b32 s58, 0x240000
    s_mov_b32 s59, 0x00020000
    s_cmp_eq_u32 s67, 0
    s_cselect_b32 s52, s22, s24
    s_cselect_b32 s53, s23, s25
    s_mov_b32 s54, 663552
    s_mov_b32 s55, 0x00020000
    s_add_u32 m0, s12, 0
    s_nop 0
    buffer_load_dwordx4 v16, s[52:55], s11 offen offset:0 lds
    buffer_load_dwordx4 v17, s[52:55], s11 offen offset:1024 lds
    buffer_load_dwordx4 v18, s[52:55], s11 offen offset:2048 lds
    buffer_load_dwordx4 v19, s[52:55], s11 offen offset:3072 lds
    s_add_u32 m0, s12, 65536
    s_nop 0
    buffer_load_dwordx4 v8, s[56:59], s11 offen offset:0 lds
    buffer_load_dwordx4 v9, s[56:59], s11 offen offset:1024 lds
    buffer_load_dwordx4 v10, s[56:59], s11 offen offset:2048 lds
    buffer_load_dwordx4 v11, s[56:59], s11 offen offset:3072 lds
    s_add_u32 s11, s11, 128
    s_cmp_ge_u32 s11, 1152
    s_cselect_b32 s11, 0, s11
    s_add_u32 m0, s12, 16384
    s_nop 0
    buffer_load_dwordx4 v16, s[52:55], s11 offen offset:0 lds
    buffer_load_dwordx4 v17, s[52:55], s11 offen offset:1024 lds
    buffer_load_dwordx4 v18, s[52:55], s11 offen offset:2048 lds
    buffer_load_dwordx4 v19, s[52:55], s11 offen offset:3072 lds
    s_add_u32 m0, s12, 83968
    s_nop 0
    buffer_load_dwordx4 v8, s[56:59], s11 offen offset:0 lds
    buffer_load_dwordx4 v9, s[56:59], s11 offen offset:1024 lds
    buffer_load_dwordx4 v10, s[56:59], s11 offen offset:2048 lds
    buffer_load_dwordx4 v11, s[56:59], s11 offen offset:3072 lds
    s_add_u32 s11, s11, 128
    s_cmp_ge_u32 s11, 1152
    s_cselect_b32 s11, 0, s11
    s_waitcnt vmcnt(8)
    s_barrier
    s_add_u32 m0, s12, 32768
    s_nop 0
    buffer_load_dwordx4 v16, s[52:55], s11 offen offset:0 lds
    buffer_load_dwordx4 v17, s[52:55], s11 offen offset:1024 lds
    buffer_load_dwordx4 v18, s[52:55], s11 offen offset:2048 lds
    buffer_load_dwordx4 v19, s[52:55], s11 offen offset:3072 lds
    s_add_u32 m0, s12, 102400
    s_nop 0
    buffer_load_dwordx4 v8, s[56:59], s11 offen offset:0 lds
    buffer_load_dwordx4 v9, s[56:59], s11 offen offset:1024 lds
    buffer_load_dwordx4 v10, s[56:59], s11 offen offset:2048 lds
    buffer_load_dwordx4 v11, s[56:59], s11 offen offset:3072 lds
    s_add_u32 s11, s11, 128
    s_cmp_ge_u32 s11, 1152
    s_cselect_b32 s11, 0, s11
    s_add_u32 m0, s12, 49152
    s_nop 0
    buffer_load_dwordx4 v16, s[52:55], s11 offen offset:0 lds
    buffer_load_dwordx4 v17, s[52:55], s11 offen offset:1024 lds
    buffer_load_dwordx4 v18, s[52:55], s11 offen offset:2048 lds
    buffer_load_dwordx4 v19, s[52:55], s11 offen offset:3072 lds
    s_add_u32 m0, s12, 120832
    s_nop 0
    buffer_load_dwordx4 v8, s[56:59], s11 offen offset:0 lds
    buffer_load_dwordx4 v9, s[56:59], s11 offen offset:1024 lds
    buffer_load_dwordx4 v10, s[56:59], s11 offen offset:2048 lds
    buffer_load_dwordx4 v11, s[56:59], s11 offen offset:3072 lds
    s_add_u32 s11, s11, 128
    s_cmp_ge_u32 s11, 1152
    s_cselect_b32 s11, 0, s11
    s_waitcnt vmcnt(16)
    s_barrier
    s_add_u32 m0, s12, 0
    s_nop 0
    buffer_load_dwordx4 v16, s[52:55], s11 offen offset:0 lds
    buffer_load_dwordx4 v17, s[52:55], s11 offen offset:1024 lds
    buffer_load_dwordx4 v18, s[52:55], s11 offen offset:2048 lds
    buffer_load_dwordx4 v19, s[52:55], s11 offen offset:3072 lds
    s_add_u32 m0, s12, 65536
    s_nop 0
    buffer_load_dwordx4 v8, s[56:59], s11 offen offset:0 lds
    buffer_load_dwordx4 v9, s[56:59], s11 offen offset:1024 lds
    buffer_load_dwordx4 v10, s[56:59], s11 offen offset:2048 lds
    buffer_load_dwordx4 v11, s[56:59], s11 offen offset:3072 lds
    s_add_u32 s11, s11, 128
    s_cmp_ge_u32 s11, 1152
    s_cselect_b32 s11, 0, s11
    s_cmp_lg_u32 s3, 4
    s_cbranch_scc1 parallel_sum__ssm_conv_s5__mixer_token_mlp__prompt_kernel_gi_20
    s_mov_b32 s68, s46
    s_mov_b32 s69, s47
    s_mov_b32 s70, 0x100
    s_mov_b32 s71, 0x00020000
    v_mov_b32 v31, 128
    buffer_load_dword v30, v31, s[68:71], 0 offen sc1
    v_mov_b32 v22, 0
parallel_sum__ssm_conv_s5__mixer_token_mlp__prompt_kernel_gi_20:
    s_waitcnt vmcnt(16)
    s_barrier
    s_add_u32 m0, s12, 16384
    s_nop 0
    buffer_load_dwordx4 v16, s[52:55], s11 offen offset:0 lds
    buffer_load_dwordx4 v17, s[52:55], s11 offen offset:1024 lds
    buffer_load_dwordx4 v18, s[52:55], s11 offen offset:2048 lds
    buffer_load_dwordx4 v19, s[52:55], s11 offen offset:3072 lds
    s_add_u32 m0, s12, 83968
    s_nop 0
    buffer_load_dwordx4 v8, s[56:59], s11 offen offset:0 lds
    buffer_load_dwordx4 v9, s[56:59], s11 offen offset:1024 lds
    buffer_load_dwordx4 v10, s[56:59], s11 offen offset:2048 lds
    buffer_load_dwordx4 v11, s[56:59], s11 offen offset:3072 lds
    s_add_u32 s11, s11, 128
    s_cmp_ge_u32 s11, 1152
    s_cselect_b32 s11, 0, s11
    s_waitcnt vmcnt(16)
    s_barrier
    s_add_u32 m0, s12, 32768
    s_nop 0
    buffer_load_dwordx4 v16, s[52:55], s11 offen offset:0 lds
    buffer_load_dwordx4 v17, s[52:55], s11 offen offset:1024 lds
    buffer_load_dwordx4 v18, s[52:55], s11 offen offset:2048 lds
    buffer_load_dwordx4 v19, s[52:55], s11 offen offset:3072 lds
    s_add_u32 m0, s12, 102400
    s_nop 0
    buffer_load_dwordx4 v8, s[56:59], s11 offen offset:0 lds
    buffer_load_dwordx4 v9, s[56:59], s11 offen offset:1024 lds
    buffer_load_dwordx4 v10, s[56:59], s11 offen offset:2048 lds
    buffer_load_dwordx4 v11, s[56:59], s11 offen offset:3072 lds
    s_add_u32 s11, s11, 128
    s_cmp_ge_u32 s11, 1152
    s_cselect_b32 s11, 0, s11
    s_waitcnt vmcnt(16)
    s_barrier
    s_add_u32 m0, s12, 49152
    s_nop 0
    buffer_load_dwordx4 v16, s[52:55], s11 offen offset:0 lds
    buffer_load_dwordx4 v17, s[52:55], s11 offen offset:1024 lds
    buffer_load_dwordx4 v18, s[52:55], s11 offen offset:2048 lds
    buffer_load_dwordx4 v19, s[52:55], s11 offen offset:3072 lds
    s_add_u32 m0, s12, 120832
    s_nop 0
    buffer_load_dwordx4 v8, s[56:59], s11 offen offset:0 lds
    buffer_load_dwordx4 v9, s[56:59], s11 offen offset:1024 lds
    buffer_load_dwordx4 v10, s[56:59], s11 offen offset:2048 lds
    buffer_load_dwordx4 v11, s[56:59], s11 offen offset:3072 lds
    s_add_u32 s11, s11, 128
    s_cmp_ge_u32 s11, 1152
    s_cselect_b32 s11, 0, s11
    s_waitcnt vmcnt(16)
    s_barrier
    s_add_u32 m0, s12, 0
    s_nop 0
    buffer_load_dwordx4 v16, s[52:55], s11 offen offset:0 lds
    buffer_load_dwordx4 v17, s[52:55], s11 offen offset:1024 lds
    buffer_load_dwordx4 v18, s[52:55], s11 offen offset:2048 lds
    buffer_load_dwordx4 v19, s[52:55], s11 offen offset:3072 lds
    s_add_u32 m0, s12, 65536
    s_nop 0
    buffer_load_dwordx4 v8, s[56:59], s11 offen offset:0 lds
    buffer_load_dwordx4 v9, s[56:59], s11 offen offset:1024 lds
    buffer_load_dwordx4 v10, s[56:59], s11 offen offset:2048 lds
    buffer_load_dwordx4 v11, s[56:59], s11 offen offset:3072 lds
    s_add_u32 s11, s11, 128
    s_cmp_ge_u32 s11, 1152
    s_cselect_b32 s11, 0, s11
    s_cmp_lg_u32 s3, 4
    s_cbranch_scc1 parallel_sum__ssm_conv_s5__mixer_token_mlp__prompt_kernel_gi_21
    s_mov_b32 s88, 0
parallel_sum__ssm_conv_s5__mixer_token_mlp__prompt_kernel_il_22:
    v_readfirstlane_b32 s89, v30
    s_cmp_ge_u32 s89, 8
    s_cbranch_scc1 parallel_sum__ssm_conv_s5__mixer_token_mlp__prompt_kernel_ie_23
    s_add_u32 s88, s88, 1
    s_cmp_ge_u32 s88, 0x8000
    s_cbranch_scc1 parallel_sum__ssm_conv_s5__mixer_token_mlp__prompt_kernel_ie_23
    s_mov_b32 s68, s46
    s_mov_b32 s69, s47
    s_mov_b32 s70, 0x100
    s_mov_b32 s71, 0x00020000
    v_mov_b32 v31, 128
    buffer_load_dword v30, v31, s[68:71], 0 offen sc1
    s_waitcnt vmcnt(0)
    s_branch parallel_sum__ssm_conv_s5__mixer_token_mlp__prompt_kernel_il_22
parallel_sum__ssm_conv_s5__mixer_token_mlp__prompt_kernel_ie_23:
    s_add_u32 s68, s48, 0x1500000
    s_addc_u32 s69, s49, 0
    s_mov_b32 s70, 0x16c00
    s_mov_b32 s71, 0x00020000
    v_min_u32 v20, 3, v2
    v_lshlrev_b32 v20, 7, v20
    s_lshl_b32 s13, s64, 9
    s_add_u32 s13, s13, 78852
    buffer_load_dword v22, v20, s[68:71], s13 offen sc1
parallel_sum__ssm_conv_s5__mixer_token_mlp__prompt_kernel_gi_21:
    s_waitcnt vmcnt(16)
    s_barrier
    s_waitcnt vmcnt(8)
    s_barrier
    s_cmp_lg_u32 s3, 4
    s_cbranch_scc1 parallel_sum__ssm_conv_s5__mixer_token_mlp__prompt_kernel_gi_24
    s_add_u32 s68, s48, 0x1500000
    s_addc_u32 s69, s49, 0
    s_mov_b32 s70, 0x16c00
    s_mov_b32 s71, 0x00020000
    v_min_u32 v20, 3, v2
    v_lshlrev_b32 v20, 7, v20
    s_lshl_b32 s13, s64, 9
    s_add_u32 s13, s13, 78852
    s_mov_b64 s[72:73], 15
    s_mov_b32 s88, 0
    s_branch parallel_sum__ssm_conv_s5__mixer_token_mlp__prompt_kernel_pollck_27
parallel_sum__ssm_conv_s5__mixer_token_mlp__prompt_kernel_poll_25:
    buffer_load_dword v22, v20, s[68:71], s13 offen offset:0 sc1
parallel_sum__ssm_conv_s5__mixer_token_mlp__prompt_kernel_pollck_27:
    s_waitcnt vmcnt(0)
    s_add_u32 s88, s88, 1
    s_mov_b64 s[78:79], 0
    v_cmp_gt_u32 vcc, 1, v22
    s_and_b64 vcc, vcc, s[72:73]
    s_or_b64 s[78:79], s[78:79], vcc
    s_cbranch_scc0 parallel_sum__ssm_conv_s5__mixer_token_mlp__prompt_kernel_pollend_26
    s_sleep 2
    s_cmp_lt_u32 s88, 0x8000
    s_cbranch_scc1 parallel_sum__ssm_conv_s5__mixer_token_mlp__prompt_kernel_poll_25
parallel_sum__ssm_conv_s5__mixer_token_mlp__prompt_kernel_pollend_26:
    s_add_u32 s68, s48, 0x248000
    s_addc_u32 s69, s49, 0
    s_mov_b32 s70, 0x4000
    s_mov_b32 s71, 0x00020000
    s_mov_b32 m0, 143360
    v_lshlrev_b32 v20, 4, v2
    s_lshl_b32 s13, s64, 10
    buffer_load_dwordx4 v20, s[68:71], s13 offen sc1 lds
parallel_sum__ssm_conv_s5__mixer_token_mlp__prompt_kernel_gi_24:
    s_waitcnt vmcnt(0)
    s_barrier
    s_cmp_lg_u32 s3, 4
    s_cbranch_scc1 parallel_sum__ssm_conv_s5__mixer_token_mlp__prompt_kernel_gi_28
    v_mov_b32 v24, 144896
    v_mov_b32 v25, 1
    s_waitcnt vmcnt(0)
    ds_write_b32 v24, v25 offset:16
parallel_sum__ssm_conv_s5__mixer_token_mlp__prompt_kernel_gi_28:
    s_branch parallel_sum__ssm_conv_s5__mixer_token_mlp__prompt_kernel_g1l_7
parallel_sum__ssm_conv_s5__mixer_token_mlp__prompt_kernel_ln_2:
    s_mov_b32 s5, 0x3ae38e39
    s_mov_b32 s6, 0x3727c5ac
    s_lshl_b32 s7, s51, 3
    s_add_u32 s7, s7, s66
    s_sub_u32 s7, s7, 18
    s_lshl_b32 s10, s3, 2
    v_add_u32 v5, s10, v4
    s_lshl_b32 s10, s7, 5
    v_add_u32 v6, s10, v5
    v_mul_u32_u24 v7, 1152, v6
    v_lshl_add_u32 v7, v3, 3, v7
    s_waitcnt lgkmcnt(0)
    s_mov_b32 s52, s16
    s_mov_b32 s53, s17
    s_mov_b32 s54, 0x240000
    s_mov_b32 s55, 0x00020000
    s_mul_i32 s14, s3, 5120
    s_add_u32 s14, s14, 40960
    s_mov_b32 m0, s14
    s_lshl_b32 s11, s3, 2
    s_add_u32 s11, s11, s10
    s_mul_i32 s11, s11, 1152
    v_lshlrev_b32 v7, 4, v2
    buffer_load_dwordx4 v7, s[52:55], s11 offen offset:0 lds
    buffer_load_dwordx4 v7, s[52:55], s11 offen offset:1024 lds
    buffer_load_dwordx4 v7, s[52:55], s11 offen offset:2048 lds
    buffer_load_dwordx4 v7, s[52:55], s11 offen offset:3072 lds
    s_add_u32 m0, s14, 4096
    s_add_u32 s11, s11, 4096
    s_mov_b32 exec_hi, 0
    buffer_load_dwordx4 v7, s[52:55], s11 offen lds
    s_mov_b32 exec_hi, -1
    v_mul_u32_u24 v7, 1152, v4
    v_lshl_add_u32 v7, v3, 3, v7
    v_add_u32 v7, s14, v7
    s_mov_b32 s56, s48
    s_mov_b32 s57, s49
    s_mov_b32 s58, 0x240000
    s_mov_b32 s59, 0x00020000
    s_add_u32 s60, s48, 0x240000
    s_addc_u32 s61, s49, 0
    s_mov_b32 s62, 0x4000
    s_mov_b32 s63, 0x00020000
    s_add_u32 s72, s48, 0x248000
    s_addc_u32 s73, s49, 0
    s_mov_b32 s74, 0x4000
    s_mov_b32 s75, 0x00020000
    v_lshrrev_b32 v81, 7, v6
    v_lshlrev_b32 v81, 9, v81
    v_and_b32 v82, 7, v5
    v_lshlrev_b32 v82, 2, v82
    v_lshrrev_b32 v83, 3, v5
    v_add3_u32 v82, v82, v83, s10
    v_lshl_add_u32 v81, v82, 2, v81
    v_mul_u32_u24 v80, 1184, v5
    v_lshl_add_u32 v80, v3, 3, v80
    s_waitcnt vmcnt(0)
    ds_read_b64 v[16:17], v7 offset:0
    ds_read_b64 v[18:19], v7 offset:128
    ds_read_b64 v[20:21], v7 offset:256
    ds_read_b64 v[22:23], v7 offset:384
    ds_read_b64 v[24:25], v7 offset:512
    ds_read_b64 v[26:27], v7 offset:640
    ds_read_b64 v[28:29], v7 offset:768
    ds_read_b64 v[30:31], v7 offset:896
    ds_read_b64 v[32:33], v7 offset:1024
    s_waitcnt lgkmcnt(0)
    s_cmp_lg_u32 s3, 7
    s_cbranch_scc1 parallel_sum__ssm_conv_s5__mixer_token_mlp__prompt_kernel_li_29
    s_mov_b32 s68, s46
    s_mov_b32 s69, s47
    s_mov_b32 s70, 0x100
    s_mov_b32 s71, 0x00020000
    v_mov_b32 v85, 128
    buffer_load_dword v84, v85, s[68:71], 0 offen sc1
parallel_sum__ssm_conv_s5__mixer_token_mlp__prompt_kernel_li_29:
    v_lshlrev_b32 v40, 16, v16
    v_and_b32 v41, s4, v16
    v_lshlrev_b32 v42, 16, v17
    v_and_b32 v43, s4, v17
    v_lshlrev_b32 v44, 16, v18
    v_and_b32 v45, s4, v18
    v_lshlrev_b32 v46, 16, v19
    v_and_b32 v47, s4, v19
    v_lshlrev_b32 v48, 16, v20
    v_and_b32 v49, s4, v20
    v_lshlrev_b32 v50, 16, v21
    v_and_b32 v51, s4, v21
    v_lshlrev_b32 v52, 16, v22
    v_and_b32 v53, s4, v22
    v_lshlrev_b32 v54, 16, v23
    v_and_b32 v55, s4, v23
    v_lshlrev_b32 v56, 16, v24
    v_and_b32 v57, s4, v24
    v_lshlrev_b32 v58, 16, v25
    v_and_b32 v59, s4, v25
    v_lshlrev_b32 v60, 16, v26
    v_and_b32 v61, s4, v26
    v_lshlrev_b32 v62, 16, v27
    v_and_b32 v63, s4, v27
    v_lshlrev_b32 v64, 16, v28
    v_and_b32 v65, s4, v28
    v_lshlrev_b32 v66, 16, v29
    v_and_b32 v67, s4, v29
    v_lshlrev_b32 v68, 16, v30
    v_and_b32 v69, s4, v30
    v_lshlrev_b32 v70, 16, v31
    v_and_b32 v71, s4, v31
    v_lshlrev_b32 v72, 16, v32
    v_and_b32 v73, s4, v32
    v_lshlrev_b32 v74, 16, v33
    v_and_b32 v75, s4, v33
    v_pk_add_f32 v[8:9], v[40:41], v[44:45]
    v_pk_add_f32 v[10:11], v[42:43], v[46:47]
    v_pk_add_f32 v[8:9], v[8:9], v[48:49]
    v_pk_add_f32 v[10:11], v[10:11], v[50:51]
    v_pk_add_f32 v[8:9], v[8:9], v[52:53]
    v_pk_add_f32 v[10:11], v[10:11], v[54:55]
    v_pk_add_f32 v[8:9], v[8:9], v[56:57]
    v_pk_add_f32 v[10:11], v[10:11], v[58:59]
    v_pk_add_f32 v[8:9], v[8:9], v[60:61]
    v_pk_add_f32 v[10:11], v[10:11], v[62:63]
    v_pk_add_f32 v[8:9], v[8:9], v[64:65]
    v_pk_add_f32 v[10:11], v[10:11], v[66:67]
    v_pk_add_f32 v[8:9], v[8:9], v[68:69]
    v_pk_add_f32 v[10:11], v[10:11], v[70:71]
    v_pk_add_f32 v[8:9], v[8:9], v[72:73]
    v_pk_add_f32 v[10:11], v[10:11], v[74:75]
    v_pk_add_f32 v[8:9], v[8:9], v[10:11]
    v_add_f32 v8, v8, v9
    s_nop 1
    v_add_f32_dpp v8, v8, v8 row_ror:8 row_mask:0xf bank_mask:0xf
    s_nop 1
    v_add_f32_dpp v8, v8, v8 row_ror:4 row_mask:0xf bank_mask:0xf
    s_nop 1
    v_add_f32_dpp v8, v8, v8 row_ror:2 row_mask:0xf bank_mask:0xf
    s_nop 1
    v_add_f32_dpp v8, v8, v8 row_ror:1 row_mask:0xf bank_mask:0xf
    v_mul_f32 v8, s5, v8
    v_pk_add_f32 v[12:13], v[40:41], v[8:9] op_sel_hi:[1,0] neg_lo:[0,1] neg_hi:[0,1]
    v_pk_mul_f32 v[34:35], v[12:13], v[12:13]
    v_pk_add_f32 v[14:15], v[42:43], v[8:9] op_sel_hi:[1,0] neg_lo:[0,1] neg_hi:[0,1]
    v_pk_mul_f32 v[36:37], v[14:15], v[14:15]
    v_pk_add_f32 v[12:13], v[44:45], v[8:9] op_sel_hi:[1,0] neg_lo:[0,1] neg_hi:[0,1]
    v_pk_fma_f32 v[34:35], v[12:13], v[12:13], v[34:35]
    v_pk_add_f32 v[14:15], v[46:47], v[8:9] op_sel_hi:[1,0] neg_lo:[0,1] neg_hi:[0,1]
    v_pk_fma_f32 v[36:37], v[14:15], v[14:15], v[36:37]
    v_pk_add_f32 v[12:13], v[48:49], v[8:9] op_sel_hi:[1,0] neg_lo:[0,1] neg_hi:[0,1]
    v_pk_fma_f32 v[34:35], v[12:13], v[12:13], v[34:35]
    v_pk_add_f32 v[14:15], v[50:51], v[8:9] op_sel_hi:[1,0] neg_lo:[0,1] neg_hi:[0,1]
    v_pk_fma_f32 v[36:37], v[14:15], v[14:15], v[36:37]
    v_pk_add_f32 v[12:13], v[52:53], v[8:9] op_sel_hi:[1,0] neg_lo:[0,1] neg_hi:[0,1]
    v_pk_fma_f32 v[34:35], v[12:13], v[12:13], v[34:35]
    v_pk_add_f32 v[14:15], v[54:55], v[8:9] op_sel_hi:[1,0] neg_lo:[0,1] neg_hi:[0,1]
    v_pk_fma_f32 v[36:37], v[14:15], v[14:15], v[36:37]
    v_pk_add_f32 v[12:13], v[56:57], v[8:9] op_sel_hi:[1,0] neg_lo:[0,1] neg_hi:[0,1]
    v_pk_fma_f32 v[34:35], v[12:13], v[12:13], v[34:35]
    v_pk_add_f32 v[14:15], v[58:59], v[8:9] op_sel_hi:[1,0] neg_lo:[0,1] neg_hi:[0,1]
    v_pk_fma_f32 v[36:37], v[14:15], v[14:15], v[36:37]
    v_pk_add_f32 v[12:13], v[60:61], v[8:9] op_sel_hi:[1,0] neg_lo:[0,1] neg_hi:[0,1]
    v_pk_fma_f32 v[34:35], v[12:13], v[12:13], v[34:35]
    v_pk_add_f32 v[14:15], v[62:63], v[8:9] op_sel_hi:[1,0] neg_lo:[0,1] neg_hi:[0,1]
    v_pk_fma_f32 v[36:37], v[14:15], v[14:15], v[36:37]
    v_pk_add_f32 v[12:13], v[64:65], v[8:9] op_sel_hi:[1,0] neg_lo:[0,1] neg_hi:[0,1]
    v_pk_fma_f32 v[34:35], v[12:13], v[12:13], v[34:35]
    v_pk_add_f32 v[14:15], v[66:67], v[8:9] op_sel_hi:[1,0] neg_lo:[0,1] neg_hi:[0,1]
    v_pk_fma_f32 v[36:37], v[14:15], v[14:15], v[36:37]
    v_pk_add_f32 v[12:13], v[68:69], v[8:9] op_sel_hi:[1,0] neg_lo:[0,1] neg_hi:[0,1]
    v_pk_fma_f32 v[34:35], v[12:13], v[12:13], v[34:35]
    v_pk_add_f32 v[14:15], v[70:71], v[8:9] op_sel_hi:[1,0] neg_lo:[0,1] neg_hi:[0,1]
    v_pk_fma_f32 v[36:37], v[14:15], v[14:15], v[36:37]
    v_pk_add_f32 v[12:13], v[72:73], v[8:9] op_sel_hi:[1,0] neg_lo:[0,1] neg_hi:[0,1]
    v_pk_fma_f32 v[34:35], v[12:13], v[12:13], v[34:35]
    v_pk_add_f32 v[14:15], v[74:75], v[8:9] op_sel_hi:[1,0] neg_lo:[0,1] neg_hi:[0,1]
    v_pk_fma_f32 v[36:37], v[14:15], v[14:15], v[36:37]
    v_pk_add_f32 v[34:35], v[34:35], v[36:37]
    v_add_f32 v34, v34, v35
    s_nop 1
    v_add_f32_dpp v34, v34, v34 row_ror:8 row_mask:0xf bank_mask:0xf
    s_nop 1
    v_add_f32_dpp v34, v34, v34 row_ror:4 row_mask:0xf bank_mask:0xf
    s_nop 1
    v_add_f32_dpp v34, v34, v34 row_ror:2 row_mask:0xf bank_mask:0xf
    s_nop 1
    v_add_f32_dpp v34, v34, v34 row_ror:1 row_mask:0xf bank_mask:0xf
    v_mul_f32 v34, s5, v34
    v_cvt_pk_bf16_f32 v10, v8, v8
    v_lshlrev_b32 v10, 16, v10
    v_cvt_pk_bf16_f32 v12, v34, v34
    v_lshlrev_b32 v12, 16, v12
    v_add_f32 v12, s6, v12
    v_cvt_pk_bf16_f32 v12, v12, v12
    v_lshlrev_b32 v12, 16, v12
    v_sqrt_f32 v12, v12
    s_nop 0
    v_cvt_pk_bf16_f32 v12, v12, v12
    v_lshlrev_b32 v12, 16, v12
    v_rcp_f32 v11, v12
    s_nop 0
    v_mov_b32 v34, v11
    v_mul_f32 v36, -v10, v11
    v_lshlrev_b32 v12, 3, v6
    v_cmp_eq_u32 vcc, 0, v3
    s_and_saveexec_b64 s[90:91], vcc
    buffer_store_dwordx2 v[10:11], v12, s[60:63], 0 offen sc1
    buffer_store_dword v11, v81, s[72:75], 0 offen sc1
    buffer_store_dword v36, v81, s[72:75], 0 offen offset:512 sc1
    s_mov_b64 exec, s[90:91]
    v_pk_add_f32 v[40:41], v[40:41], v[10:11] op_sel_hi:[1,0] neg_lo:[0,1] neg_hi:[0,1]
    v_cvt_pk_bf16_f32 v16, v40, v41
    v_lshlrev_b32 v40, 16, v16
    v_and_b32 v41, s4, v16
    v_pk_mul_f32 v[40:41], v[40:41], v[34:35] op_sel_hi:[1,0]
    v_pk_add_f32 v[42:43], v[42:43], v[10:11] op_sel_hi:[1,0] neg_lo:[0,1] neg_hi:[0,1]
    v_cvt_pk_bf16_f32 v17, v42, v43
    v_lshlrev_b32 v42, 16, v17
    v_and_b32 v43, s4, v17
    v_pk_mul_f32 v[42:43], v[42:43], v[34:35] op_sel_hi:[1,0]
    v_pk_add_f32 v[44:45], v[44:45], v[10:11] op_sel_hi:[1,0] neg_lo:[0,1] neg_hi:[0,1]
    v_cvt_pk_bf16_f32 v18, v44, v45
    v_lshlrev_b32 v44, 16, v18
    v_and_b32 v45, s4, v18
    v_pk_mul_f32 v[44:45], v[44:45], v[34:35] op_sel_hi:[1,0]
    v_pk_add_f32 v[46:47], v[46:47], v[10:11] op_sel_hi:[1,0] neg_lo:[0,1] neg_hi:[0,1]
    v_cvt_pk_bf16_f32 v19, v46, v47
    v_lshlrev_b32 v46, 16, v19
    v_and_b32 v47, s4, v19
    v_pk_mul_f32 v[46:47], v[46:47], v[34:35] op_sel_hi:[1,0]
    v_pk_add_f32 v[48:49], v[48:49], v[10:11] op_sel_hi:[1,0] neg_lo:[0,1] neg_hi:[0,1]
    v_cvt_pk_bf16_f32 v20, v48, v49
    v_lshlrev_b32 v48, 16, v20
    v_and_b32 v49, s4, v20
    v_pk_mul_f32 v[48:49], v[48:49], v[34:35] op_sel_hi:[1,0]
    v_pk_add_f32 v[50:51], v[50:51], v[10:11] op_sel_hi:[1,0] neg_lo:[0,1] neg_hi:[0,1]
    v_cvt_pk_bf16_f32 v21, v50, v51
    v_lshlrev_b32 v50, 16, v21
    v_and_b32 v51, s4, v21
    v_pk_mul_f32 v[50:51], v[50:51], v[34:35] op_sel_hi:[1,0]
    v_pk_add_f32 v[52:53], v[52:53], v[10:11] op_sel_hi:[1,0] neg_lo:[0,1] neg_hi:[0,1]
    v_cvt_pk_bf16_f32 v22, v52, v53
    v_lshlrev_b32 v52, 16, v22
    v_and_b32 v53, s4, v22
    v_pk_mul_f32 v[52:53], v[52:53], v[34:35] op_sel_hi:[1,0]
    v_pk_add_f32 v[54:55], v[54:55], v[10:11] op_sel_hi:[1,0] neg_lo:[0,1] neg_hi:[0,1]
    v_cvt_pk_bf16_f32 v23, v54, v55
    v_lshlrev_b32 v54, 16, v23
    v_and_b32 v55, s4, v23
    v_pk_mul_f32 v[54:55], v[54:55], v[34:35] op_sel_hi:[1,0]
    v_pk_add_f32 v[56:57], v[56:57], v[10:11] op_sel_hi:[1,0] neg_lo:[0,1] neg_hi:[0,1]
    v_cvt_pk_bf16_f32 v24, v56, v57
    v_lshlrev_b32 v56, 16, v24
    v_and_b32 v57, s4, v24
    v_pk_mul_f32 v[56:57], v[56:57], v[34:35] op_sel_hi:[1,0]
    v_pk_add_f32 v[58:59], v[58:59], v[10:11] op_sel_hi:[1,0] neg_lo:[0,1] neg_hi:[0,1]
    v_cvt_pk_bf16_f32 v25, v58, v59
    v_lshlrev_b32 v58, 16, v25
    v_and_b32 v59, s4, v25
    v_pk_mul_f32 v[58:59], v[58:59], v[34:35] op_sel_hi:[1,0]
    v_pk_add_f32 v[60:61], v[60:61], v[10:11] op_sel_hi:[1,0] neg_lo:[0,1] neg_hi:[0,1]
    v_cvt_pk_bf16_f32 v26, v60, v61
    v_lshlrev_b32 v60, 16, v26
    v_and_b32 v61, s4, v26
    v_pk_mul_f32 v[60:61], v[60:61], v[34:35] op_sel_hi:[1,0]
    v_pk_add_f32 v[62:63], v[62:63], v[10:11] op_sel_hi:[1,0] neg_lo:[0,1] neg_hi:[0,1]
    v_cvt_pk_bf16_f32 v27, v62, v63
    v_lshlrev_b32 v62, 16, v27
    v_and_b32 v63, s4, v27
    v_pk_mul_f32 v[62:63], v[62:63], v[34:35] op_sel_hi:[1,0]
    v_pk_add_f32 v[64:65], v[64:65], v[10:11] op_sel_hi:[1,0] neg_lo:[0,1] neg_hi:[0,1]
    v_cvt_pk_bf16_f32 v28, v64, v65
    v_lshlrev_b32 v64, 16, v28
    v_and_b32 v65, s4, v28
    v_pk_mul_f32 v[64:65], v[64:65], v[34:35] op_sel_hi:[1,0]
    v_pk_add_f32 v[66:67], v[66:67], v[10:11] op_sel_hi:[1,0] neg_lo:[0,1] neg_hi:[0,1]
    v_cvt_pk_bf16_f32 v29, v66, v67
    v_lshlrev_b32 v66, 16, v29
    v_and_b32 v67, s4, v29
    v_pk_mul_f32 v[66:67], v[66:67], v[34:35] op_sel_hi:[1,0]
    v_pk_add_f32 v[68:69], v[68:69], v[10:11] op_sel_hi:[1,0] neg_lo:[0,1] neg_hi:[0,1]
    v_cvt_pk_bf16_f32 v30, v68, v69
    v_lshlrev_b32 v68, 16, v30
    v_and_b32 v69, s4, v30
    v_pk_mul_f32 v[68:69], v[68:69], v[34:35] op_sel_hi:[1,0]
    v_pk_add_f32 v[70:71], v[70:71], v[10:11] op_sel_hi:[1,0] neg_lo:[0,1] neg_hi:[0,1]
    v_cvt_pk_bf16_f32 v31, v70, v71
    v_lshlrev_b32 v70, 16, v31
    v_and_b32 v71, s4, v31
    v_pk_mul_f32 v[70:71], v[70:71], v[34:35] op_sel_hi:[1,0]
    v_pk_add_f32 v[72:73], v[72:73], v[10:11] op_sel_hi:[1,0] neg_lo:[0,1] neg_hi:[0,1]
    v_cvt_pk_bf16_f32 v32, v72, v73
    v_lshlrev_b32 v72, 16, v32
    v_and_b32 v73, s4, v32
    v_pk_mul_f32 v[72:73], v[72:73], v[34:35] op_sel_hi:[1,0]
    v_pk_add_f32 v[74:75], v[74:75], v[10:11] op_sel_hi:[1,0] neg_lo:[0,1] neg_hi:[0,1]
    v_cvt_pk_bf16_f32 v33, v74, v75
    v_lshlrev_b32 v74, 16, v33
    v_and_b32 v75, s4, v33
    v_pk_mul_f32 v[74:75], v[74:75], v[34:35] op_sel_hi:[1,0]
    v_cvt_pk_bf16_f32 v16, v40, v41
    v_cvt_pk_bf16_f32 v17, v42, v43
    v_cvt_pk_bf16_f32 v18, v44, v45
    v_cvt_pk_bf16_f32 v19, v46, v47
    v_cvt_pk_bf16_f32 v20, v48, v49
    v_cvt_pk_bf16_f32 v21, v50, v51
    v_cvt_pk_bf16_f32 v22, v52, v53
    v_cvt_pk_bf16_f32 v23, v54, v55
    v_cvt_pk_bf16_f32 v24, v56, v57
    v_cvt_pk_bf16_f32 v25, v58, v59
    v_cvt_pk_bf16_f32 v26, v60, v61
    v_cvt_pk_bf16_f32 v27, v62, v63
    v_cvt_pk_bf16_f32 v28, v64, v65
    v_cvt_pk_bf16_f32 v29, v66, v67
    v_cvt_pk_bf16_f32 v30, v68, v69
    v_cvt_pk_bf16_f32 v31, v70, v71
    v_cvt_pk_bf16_f32 v32, v72, v73
    v_cvt_pk_bf16_f32 v33, v74, v75
    v_lshlrev_b32 v40, 16, v16
    v_and_b32 v41, s4, v16
    v_lshlrev_b32 v42, 16, v17
    v_and_b32 v43, s4, v17
    v_lshlrev_b32 v44, 16, v18
    v_and_b32 v45, s4, v18
    v_lshlrev_b32 v46, 16, v19
    v_and_b32 v47, s4, v19
    v_lshlrev_b32 v48, 16, v20
    v_and_b32 v49, s4, v20
    v_lshlrev_b32 v50, 16, v21
    v_and_b32 v51, s4, v21
    v_lshlrev_b32 v52, 16, v22
    v_and_b32 v53, s4, v22
    v_lshlrev_b32 v54, 16, v23
    v_and_b32 v55, s4, v23
    v_lshlrev_b32 v56, 16, v24
    v_and_b32 v57, s4, v24
    v_lshlrev_b32 v58, 16, v25
    v_and_b32 v59, s4, v25
    v_lshlrev_b32 v60, 16, v26
    v_and_b32 v61, s4, v26
    v_lshlrev_b32 v62, 16, v27
    v_and_b32 v63, s4, v27
    v_lshlrev_b32 v64, 16, v28
    v_and_b32 v65, s4, v28
    v_lshlrev_b32 v66, 16, v29
    v_and_b32 v67, s4, v29
    v_lshlrev_b32 v68, 16, v30
    v_and_b32 v69, s4, v30
    v_lshlrev_b32 v70, 16, v31
    v_and_b32 v71, s4, v31
    v_lshlrev_b32 v72, 16, v32
    v_and_b32 v73, s4, v32
    v_lshlrev_b32 v74, 16, v33
    v_and_b32 v75, s4, v33
    v_pk_add_f32 v[8:9], v[40:41], v[44:45]
    v_pk_add_f32 v[10:11], v[42:43], v[46:47]
    v_pk_add_f32 v[8:9], v[8:9], v[48:49]
    v_pk_add_f32 v[10:11], v[10:11], v[50:51]
    v_pk_add_f32 v[8:9], v[8:9], v[52:53]
    v_pk_add_f32 v[10:11], v[10:11], v[54:55]
    v_pk_add_f32 v[8:9], v[8:9], v[56:57]
    v_pk_add_f32 v[10:11], v[10:11], v[58:59]
    v_pk_add_f32 v[8:9], v[8:9], v[60:61]
    v_pk_add_f32 v[10:11], v[10:11], v[62:63]
    v_pk_add_f32 v[8:9], v[8:9], v[64:65]
    v_pk_add_f32 v[10:11], v[10:11], v[66:67]
    v_pk_add_f32 v[8:9], v[8:9], v[68:69]
    v_pk_add_f32 v[10:11], v[10:11], v[70:71]
    v_pk_add_f32 v[8:9], v[8:9], v[72:73]
    v_pk_add_f32 v[10:11], v[10:11], v[74:75]
    v_pk_add_f32 v[8:9], v[8:9], v[10:11]
    v_add_f32 v8, v8, v9
    v_pk_mul_f32 v[34:35], v[40:41], v[40:41]
    v_pk_mul_f32 v[36:37], v[42:43], v[42:43]
    v_pk_fma_f32 v[34:35], v[44:45], v[44:45], v[34:35]
    v_pk_fma_f32 v[36:37], v[46:47], v[46:47], v[36:37]
    v_pk_fma_f32 v[34:35], v[48:49], v[48:49], v[34:35]
    v_pk_fma_f32 v[36:37], v[50:51], v[50:51], v[36:37]
    v_pk_fma_f32 v[34:35], v[52:53], v[52:53], v[34:35]
    v_pk_fma_f32 v[36:37], v[54:55], v[54:55], v[36:37]
    v_pk_fma_f32 v[34:35], v[56:57], v[56:57], v[34:35]
    v_pk_fma_f32 v[36:37], v[58:59], v[58:59], v[36:37]
    v_pk_fma_f32 v[34:35], v[60:61], v[60:61], v[34:35]
    v_pk_fma_f32 v[36:37], v[62:63], v[62:63], v[36:37]
    v_pk_fma_f32 v[34:35], v[64:65], v[64:65], v[34:35]
    v_pk_fma_f32 v[36:37], v[66:67], v[66:67], v[36:37]
    v_pk_fma_f32 v[34:35], v[68:69], v[68:69], v[34:35]
    v_pk_fma_f32 v[36:37], v[70:71], v[70:71], v[36:37]
    v_pk_fma_f32 v[34:35], v[72:73], v[72:73], v[34:35]
    v_pk_fma_f32 v[36:37], v[74:75], v[74:75], v[36:37]
    v_pk_add_f32 v[34:35], v[34:35], v[36:37]
    v_add_f32 v34, v34, v35
    s_nop 0
    v_add_f32_dpp v8, v8, v8 row_ror:8 row_mask:0xf bank_mask:0xf
    v_add_f32_dpp v34, v34, v34 row_ror:8 row_mask:0xf bank_mask:0xf
    s_nop 0
    v_add_f32_dpp v8, v8, v8 row_ror:4 row_mask:0xf bank_mask:0xf
    v_add_f32_dpp v34, v34, v34 row_ror:4 row_mask:0xf bank_mask:0xf
    s_nop 0
    v_add_f32_dpp v8, v8, v8 row_ror:2 row_mask:0xf bank_mask:0xf
    v_add_f32_dpp v34, v34, v34 row_ror:2 row_mask:0xf bank_mask:0xf
    s_nop 0
    v_add_f32_dpp v8, v8, v8 row_ror:1 row_mask:0xf bank_mask:0xf
    v_add_f32_dpp v34, v34, v34 row_ror:1 row_mask:0xf bank_mask:0xf
    v_mul_f32 v8, s5, v8
    v_mul_f32 v34, s5, v34
    v_fma_f32 v34, -v8, v8, v34
    v_max_f32 v34, 0, v34
    v_cvt_pk_bf16_f32 v10, v8, v8
    v_lshlrev_b32 v10, 16, v10
    v_cvt_pk_bf16_f32 v12, v34, v34
    v_lshlrev_b32 v12, 16, v12
    v_add_f32 v12, s6, v12
    v_cvt_pk_bf16_f32 v12, v12, v12
    v_lshlrev_b32 v12, 16, v12
    v_sqrt_f32 v12, v12
    s_nop 0
    v_cvt_pk_bf16_f32 v12, v12, v12
    v_lshlrev_b32 v12, 16, v12
    v_rcp_f32 v11, v12
    s_nop 0
    v_mov_b32 v34, v11
    v_mul_f32 v36, -v10, v11
    v_pk_add_f32 v[40:41], v[40:41], v[10:11] op_sel_hi:[1,0] neg_lo:[0,1] neg_hi:[0,1]
    v_cvt_pk_bf16_f32 v16, v40, v41
    v_lshlrev_b32 v40, 16, v16
    v_and_b32 v41, s4, v16
    v_pk_mul_f32 v[40:41], v[40:41], v[34:35] op_sel_hi:[1,0]
    v_pk_add_f32 v[42:43], v[42:43], v[10:11] op_sel_hi:[1,0] neg_lo:[0,1] neg_hi:[0,1]
    v_cvt_pk_bf16_f32 v17, v42, v43
    v_lshlrev_b32 v42, 16, v17
    v_and_b32 v43, s4, v17
    v_pk_mul_f32 v[42:43], v[42:43], v[34:35] op_sel_hi:[1,0]
    v_pk_add_f32 v[44:45], v[44:45], v[10:11] op_sel_hi:[1,0] neg_lo:[0,1] neg_hi:[0,1]
    v_cvt_pk_bf16_f32 v18, v44, v45
    v_lshlrev_b32 v44, 16, v18
    v_and_b32 v45, s4, v18
    v_pk_mul_f32 v[44:45], v[44:45], v[34:35] op_sel_hi:[1,0]
    v_pk_add_f32 v[46:47], v[46:47], v[10:11] op_sel_hi:[1,0] neg_lo:[0,1] neg_hi:[0,1]
    v_cvt_pk_bf16_f32 v19, v46, v47
    v_lshlrev_b32 v46, 16, v19
    v_and_b32 v47, s4, v19
    v_pk_mul_f32 v[46:47], v[46:47], v[34:35] op_sel_hi:[1,0]
    v_pk_add_f32 v[48:49], v[48:49], v[10:11] op_sel_hi:[1,0] neg_lo:[0,1] neg_hi:[0,1]
    v_cvt_pk_bf16_f32 v20, v48, v49
    v_lshlrev_b32 v48, 16, v20
    v_and_b32 v49, s4, v20
    v_pk_mul_f32 v[48:49], v[48:49], v[34:35] op_sel_hi:[1,0]
    v_pk_add_f32 v[50:51], v[50:51], v[10:11] op_sel_hi:[1,0] neg_lo:[0,1] neg_hi:[0,1]
    v_cvt_pk_bf16_f32 v21, v50, v51
    v_lshlrev_b32 v50, 16, v21
    v_and_b32 v51, s4, v21
    v_pk_mul_f32 v[50:51], v[50:51], v[34:35] op_sel_hi:[1,0]
    v_pk_add_f32 v[52:53], v[52:53], v[10:11] op_sel_hi:[1,0] neg_lo:[0,1] neg_hi:[0,1]
    v_cvt_pk_bf16_f32 v22, v52, v53
    v_lshlrev_b32 v52, 16, v22
    v_and_b32 v53, s4, v22
    v_pk_mul_f32 v[52:53], v[52:53], v[34:35] op_sel_hi:[1,0]
    v_pk_add_f32 v[54:55], v[54:55], v[10:11] op_sel_hi:[1,0] neg_lo:[0,1] neg_hi:[0,1]
    v_cvt_pk_bf16_f32 v23, v54, v55
    v_lshlrev_b32 v54, 16, v23
    v_and_b32 v55, s4, v23
    v_pk_mul_f32 v[54:55], v[54:55], v[34:35] op_sel_hi:[1,0]
    v_pk_add_f32 v[56:57], v[56:57], v[10:11] op_sel_hi:[1,0] neg_lo:[0,1] neg_hi:[0,1]
    v_cvt_pk_bf16_f32 v24, v56, v57
    v_lshlrev_b32 v56, 16, v24
    v_and_b32 v57, s4, v24
    v_pk_mul_f32 v[56:57], v[56:57], v[34:35] op_sel_hi:[1,0]
    v_pk_add_f32 v[58:59], v[58:59], v[10:11] op_sel_hi:[1,0] neg_lo:[0,1] neg_hi:[0,1]
    v_cvt_pk_bf16_f32 v25, v58, v59
    v_lshlrev_b32 v58, 16, v25
    v_and_b32 v59, s4, v25
    v_pk_mul_f32 v[58:59], v[58:59], v[34:35] op_sel_hi:[1,0]
    v_pk_add_f32 v[60:61], v[60:61], v[10:11] op_sel_hi:[1,0] neg_lo:[0,1] neg_hi:[0,1]
    v_cvt_pk_bf16_f32 v26, v60, v61
    v_lshlrev_b32 v60, 16, v26
    v_and_b32 v61, s4, v26
    v_pk_mul_f32 v[60:61], v[60:61], v[34:35] op_sel_hi:[1,0]
    v_pk_add_f32 v[62:63], v[62:63], v[10:11] op_sel_hi:[1,0] neg_lo:[0,1] neg_hi:[0,1]
    v_cvt_pk_bf16_f32 v27, v62, v63
    v_lshlrev_b32 v62, 16, v27
    v_and_b32 v63, s4, v27
    v_pk_mul_f32 v[62:63], v[62:63], v[34:35] op_sel_hi:[1,0]
    v_pk_add_f32 v[64:65], v[64:65], v[10:11] op_sel_hi:[1,0] neg_lo:[0,1] neg_hi:[0,1]
    v_cvt_pk_bf16_f32 v28, v64, v65
    v_lshlrev_b32 v64, 16, v28
    v_and_b32 v65, s4, v28
    v_pk_mul_f32 v[64:65], v[64:65], v[34:35] op_sel_hi:[1,0]
    v_pk_add_f32 v[66:67], v[66:67], v[10:11] op_sel_hi:[1,0] neg_lo:[0,1] neg_hi:[0,1]
    v_cvt_pk_bf16_f32 v29, v66, v67
    v_lshlrev_b32 v66, 16, v29
    v_and_b32 v67, s4, v29
    v_pk_mul_f32 v[66:67], v[66:67], v[34:35] op_sel_hi:[1,0]
    v_pk_add_f32 v[68:69], v[68:69], v[10:11] op_sel_hi:[1,0] neg_lo:[0,1] neg_hi:[0,1]
    v_cvt_pk_bf16_f32 v30, v68, v69
    v_lshlrev_b32 v68, 16, v30
    v_and_b32 v69, s4, v30
    v_pk_mul_f32 v[68:69], v[68:69], v[34:35] op_sel_hi:[1,0]
    v_pk_add_f32 v[70:71], v[70:71], v[10:11] op_sel_hi:[1,0] neg_lo:[0,1] neg_hi:[0,1]
    v_cvt_pk_bf16_f32 v31, v70, v71
    v_lshlrev_b32 v70, 16, v31
    v_and_b32 v71, s4, v31
    v_pk_mul_f32 v[70:71], v[70:71], v[34:35] op_sel_hi:[1,0]
    v_pk_add_f32 v[72:73], v[72:73], v[10:11] op_sel_hi:[1,0] neg_lo:[0,1] neg_hi:[0,1]
    v_cvt_pk_bf16_f32 v32, v72, v73
    v_lshlrev_b32 v72, 16, v32
    v_and_b32 v73, s4, v32
    v_pk_mul_f32 v[72:73], v[72:73], v[34:35] op_sel_hi:[1,0]
    v_pk_add_f32 v[74:75], v[74:75], v[10:11] op_sel_hi:[1,0] neg_lo:[0,1] neg_hi:[0,1]
    v_cvt_pk_bf16_f32 v33, v74, v75
    v_lshlrev_b32 v74, 16, v33
    v_and_b32 v75, s4, v33
    v_pk_mul_f32 v[74:75], v[74:75], v[34:35] op_sel_hi:[1,0]
    v_cvt_pk_bf16_f32 v16, v40, v41
    v_cvt_pk_bf16_f32 v17, v42, v43
    v_cvt_pk_bf16_f32 v18, v44, v45
    v_cvt_pk_bf16_f32 v19, v46, v47
    v_cvt_pk_bf16_f32 v20, v48, v49
    v_cvt_pk_bf16_f32 v21, v50, v51
    v_cvt_pk_bf16_f32 v22, v52, v53
    v_cvt_pk_bf16_f32 v23, v54, v55
    v_cvt_pk_bf16_f32 v24, v56, v57
    v_cvt_pk_bf16_f32 v25, v58, v59
    v_cvt_pk_bf16_f32 v26, v60, v61
    v_cvt_pk_bf16_f32 v27, v62, v63
    v_cvt_pk_bf16_f32 v28, v64, v65
    v_cvt_pk_bf16_f32 v29, v66, v67
    v_cvt_pk_bf16_f32 v30, v68, v69
    v_cvt_pk_bf16_f32 v31, v70, v71
    v_cvt_pk_bf16_f32 v32, v72, v73
    v_cvt_pk_bf16_f32 v33, v74, v75
    ds_write_b64 v80, v[16:17] offset:0
    ds_write_b64 v80, v[18:19] offset:128
    ds_write_b64 v80, v[20:21] offset:256
    ds_write_b64 v80, v[22:23] offset:384
    ds_write_b64 v80, v[24:25] offset:512
    ds_write_b64 v80, v[26:27] offset:640
    ds_write_b64 v80, v[28:29] offset:768
    ds_write_b64 v80, v[30:31] offset:896
    ds_write_b64 v80, v[32:33] offset:1024
    v_lshrrev_b32 v9, 2, v3
    v_lshl_add_u32 v9, v4, 2, v9
    v_mul_u32_u24 v9, 1184, v9
    v_and_b32 v10, 3, v3
    v_lshl_add_u32 v9, v10, 3, v9
    s_lshl_b32 s10, s3, 5
    v_add_u32 v9, s10, v9
    s_mul_i32 s11, s7, 36
    s_add_u32 s11, s11, s3
    s_lshl_b32 s11, s11, 10
    v_lshlrev_b32 v10, 4, v2
    s_waitcnt vmcnt(0) lgkmcnt(0)
    s_cmp_lg_u32 s3, 7
    s_cbranch_scc1 parallel_sum__ssm_conv_s5__mixer_token_mlp__prompt_kernel_l1_30
    s_mov_b32 s88, 0
parallel_sum__ssm_conv_s5__mixer_token_mlp__prompt_kernel_il_32:
    v_readfirstlane_b32 s89, v84
    s_cmp_ge_u32 s89, 8
    s_cbranch_scc1 parallel_sum__ssm_conv_s5__mixer_token_mlp__prompt_kernel_ie_33
    s_add_u32 s88, s88, 1
    s_cmp_ge_u32 s88, 0x8000
    s_cbranch_scc1 parallel_sum__ssm_conv_s5__mixer_token_mlp__prompt_kernel_ie_33
    s_mov_b32 s68, s46
    s_mov_b32 s69, s47
    s_mov_b32 s70, 0x100
    s_mov_b32 s71, 0x00020000
    v_mov_b32 v85, 128
    buffer_load_dword v84, v85, s[68:71], 0 offen sc1
    s_waitcnt vmcnt(0)
    s_branch parallel_sum__ssm_conv_s5__mixer_token_mlp__prompt_kernel_il_32
parallel_sum__ssm_conv_s5__mixer_token_mlp__prompt_kernel_ie_33:
parallel_sum__ssm_conv_s5__mixer_token_mlp__prompt_kernel_l1_30:
    s_barrier
    ds_read_b64_tr_b16 v[40:41], v9 offset:0
    ds_read_b64_tr_b16 v[42:43], v9 offset:18944
    ds_read_b64_tr_b16 v[44:45], v9 offset:256
    ds_read_b64_tr_b16 v[46:47], v9 offset:19200
    ds_read_b64_tr_b16 v[48:49], v9 offset:512
    ds_read_b64_tr_b16 v[50:51], v9 offset:19456
    ds_read_b64_tr_b16 v[52:53], v9 offset:768
    ds_read_b64_tr_b16 v[54:55], v9 offset:19712
    ds_read_b64_tr_b16 v[56:57], v9 offset:1024
    ds_read_b64_tr_b16 v[58:59], v9 offset:19968
    s_add_u32 s68, s48, 0x1500000
    s_addc_u32 s69, s49, 0
    s_mov_b32 s70, 0x16c00
    s_mov_b32 s71, 0x00020000
    v_mov_b32 v20, 0
    v_mov_b32 v21, 1
    s_lshl_b32 s15, s7, 7
    s_add_u32 s15, s15, 78848
    s_cmp_lg_u32 s3, 7
    s_cbranch_scc1 parallel_sum__ssm_conv_s5__mixer_token_mlp__prompt_kernel_l3_31
    s_mov_b64 exec, 1
    buffer_store_dword v21, v20, s[68:71], s15 offen offset:4 sc1
    s_mov_b64 exec, -1
parallel_sum__ssm_conv_s5__mixer_token_mlp__prompt_kernel_l3_31:
    s_waitcnt lgkmcnt(8)
    buffer_store_dwordx4 v[40:43], v10, s[56:59], s11 offen sc1
    s_add_u32 s11, s11, 8192
    s_waitcnt lgkmcnt(6)
    buffer_store_dwordx4 v[44:47], v10, s[56:59], s11 offen sc1
    s_add_u32 s11, s11, 8192
    s_waitcnt lgkmcnt(4)
    buffer_store_dwordx4 v[48:51], v10, s[56:59], s11 offen sc1
    s_add_u32 s11, s11, 8192
    s_waitcnt lgkmcnt(2)
    buffer_store_dwordx4 v[52:55], v10, s[56:59], s11 offen sc1
    s_add_u32 s11, s11, 8192
    s_waitcnt lgkmcnt(0)
    s_cmp_ge_u32 s3, 4
    s_cbranch_scc1 parallel_sum__ssm_conv_s5__mixer_token_mlp__prompt_kernel_skip_34
    buffer_store_dwordx4 v[56:59], v10, s[56:59], s11 offen sc1
    s_add_u32 s11, s11, 8192
parallel_sum__ssm_conv_s5__mixer_token_mlp__prompt_kernel_skip_34:
    s_waitcnt vmcnt(0)
    s_barrier
    v_mov_b32 v30, 40
    s_cmp_lg_u32 s3, 0
    s_cbranch_scc1 parallel_sum__ssm_conv_s5__mixer_token_mlp__prompt_kernel_l2_35
    s_mov_b64 exec, 1
    buffer_store_dword v21, v20, s[68:71], s15 offen sc1
    s_mov_b64 exec, -1
parallel_sum__ssm_conv_s5__mixer_token_mlp__prompt_kernel_l2_35:
    s_branch parallel_sum__ssm_conv_s5__mixer_token_mlp__prompt_kernel_ab_10
parallel_sum__ssm_conv_s5__mixer_token_mlp__prompt_kernel_misc_3:
    v_lshlrev_b32 v44, 4, v2
    v_mov_b32 v24, 0
    v_mov_b32 v32, -1
    v_mov_b32 v25, 0
    v_mov_b32 v33, -1
    v_mov_b32 v26, 0
    v_mov_b32 v34, -1
    v_mov_b32 v27, 0
    v_mov_b32 v35, -1
    s_lshl_b32 s13, s51, 3
    s_add_u32 s13, s13, s3
    s_lshl_b32 s13, s13, 10
    s_add_u32 s14, s13, 65536
    s_waitcnt lgkmcnt(0)
    s_add_u32 s52, s48, 0x1500000
    s_addc_u32 s53, s49, 0
    s_mov_b32 s54, 0x16c00
    s_mov_b32 s55, 0x00020000
    s_add_u32 s56, s48, 0x1520000
    s_addc_u32 s57, s49, 0
    s_mov_b32 s58, 0x12000
    s_mov_b32 s59, 0x00020000
    buffer_store_dwordx4 v[24:27], v44, s[52:55], s13 offen sc1
    buffer_store_dwordx4 v[32:35], v44, s[56:59], s13 offen sc1
    buffer_store_dwordx4 v[24:27], v44, s[52:55], s14 offen sc1
    buffer_store_dwordx4 v[32:35], v44, s[56:59], s14 offen sc1
    s_waitcnt vmcnt(0)
    s_barrier
    s_cmp_lg_u32 s3, 0
    s_cbranch_scc1 parallel_sum__ssm_conv_s5__mixer_token_mlp__prompt_kernel_mi_36
    s_mov_b32 s68, s46
    s_mov_b32 s69, s47
    s_mov_b32 s70, 0x100
    s_mov_b32 s71, 0x00020000
    v_mov_b32 v20, 128
    v_mov_b32 v21, 1
    s_mov_b64 exec, 1
    buffer_atomic_add v21, v20, s[68:71], 0 offen sc1
    s_mov_b64 exec, -1
parallel_sum__ssm_conv_s5__mixer_token_mlp__prompt_kernel_mi_36:
    s_mov_b32 s80, s36
    s_mov_b32 s81, s37
    s_mov_b32 s82, 0x1200000
    s_mov_b32 s83, 0x00020000
    s_mov_b32 s84, s40
    s_mov_b32 s85, s41
    s_mov_b32 s86, 0x1200000
    s_mov_b32 s87, 0x00020000
    v_lshrrev_b32 v16, 1, v2
    v_mul_u32_u24 v16, 9216, v16
    v_and_b32 v17, 1, v2
    v_lshl_add_u32 v16, v17, 7, v16
    v_lshlrev_b32 v17, 12, v4
    v_lshl_add_u32 v17, v3, 7, v17
    s_mov_b32 s78, 0x43201
    s_cmp_eq_u32 s51, 1
    s_cselect_b32 s78, 0x87650, s78
    s_cmp_eq_u32 s51, 2
    s_cselect_b32 s78, 0x32140, s78
    s_cmp_eq_u32 s51, 3
    s_cselect_b32 s78, 0x76584, s78
    s_cmp_eq_u32 s51, 4
    s_cselect_b32 s78, 0x42103, s78
    s_cmp_eq_u32 s51, 5
    s_cselect_b32 s78, 0x86570, s78
    s_cmp_eq_u32 s51, 6
    s_cselect_b32 s78, 0x43102, s78
    s_cmp_eq_u32 s51, 7
    s_cselect_b32 s78, 0x87560, s78
    s_bitcmp1_b32 s51, 0
    s_cselect_b32 s77, 2048, 0
    s_lshr_b32 s79, s51, 1
    s_mul_i32 s88, s79, 4718592
    s_add_u32 s77, s77, s88
    s_mul_i32 s79, s79, 9
    s_add_u32 s12, s3, 296
    s_cmp_ge_u32 s12, 320
    s_cbranch_scc1 parallel_sum__ssm_conv_s5__mixer_token_mlp__prompt_kernel_w2l_37
    s_mul_i32 s89, s12, 52429
    s_lshr_b32 s89, s89, 18
    s_mul_i32 s90, s89, 5
    s_sub_u32 s90, s12, s90
    s_lshl_b32 s90, s90, 2
    s_lshr_b32 s90, s78, s90
    s_and_b32 s90, s90, 15
    s_add_u32 s90, s90, s79
    s_lshl_b32 s90, s90, 8
    s_mul_i32 s88, s89, 294912
    s_add_u32 s88, s88, s90
    buffer_load_dword v1, v16, s[80:83], s88 offen
    s_branch parallel_sum__ssm_conv_s5__mixer_token_mlp__prompt_kernel_go_38
parallel_sum__ssm_conv_s5__mixer_token_mlp__prompt_kernel_w2l_37:
    s_sub_u32 s88, s12, 320
    s_min_u32 s88, s88, 287
    s_lshl_b32 s88, s88, 14
    s_add_u32 s88, s88, s77
    buffer_load_dword v1, v17, s[84:87], s88 offen
parallel_sum__ssm_conv_s5__mixer_token_mlp__prompt_kernel_go_38:
    s_add_u32 s12, s12, 8
    s_cmp_ge_u32 s12, 320
    s_cbranch_scc1 parallel_sum__ssm_conv_s5__mixer_token_mlp__prompt_kernel_w2l_39
    s_mul_i32 s89, s12, 52429
    s_lshr_b32 s89, s89, 18
    s_mul_i32 s90, s89, 5
    s_sub_u32 s90, s12, s90
    s_lshl_b32 s90, s90, 2
    s_lshr_b32 s90, s78, s90
    s_and_b32 s90, s90, 15
    s_add_u32 s90, s90, s79
    s_lshl_b32 s90, s90, 8
    s_mul_i32 s88, s89, 294912
    s_add_u32 s88, s88, s90
    buffer_load_dword v1, v16, s[80:83], s88 offen
    s_branch parallel_sum__ssm_conv_s5__mixer_token_mlp__prompt_kernel_go_40
parallel_sum__ssm_conv_s5__mixer_token_mlp__prompt_kernel_w2l_39:
    s_sub_u32 s88, s12, 320
    s_min_u32 s88, s88, 287
    s_lshl_b32 s88, s88, 14
    s_add_u32 s88, s88, s77
    buffer_load_dword v1, v17, s[84:87], s88 offen
parallel_sum__ssm_conv_s5__mixer_token_mlp__prompt_kernel_go_40:
    s_add_u32 s12, s12, 8
    s_cmp_ge_u32 s12, 320
    s_cbranch_scc1 parallel_sum__ssm_conv_s5__mixer_token_mlp__prompt_kernel_w2l_41
    s_mul_i32 s89, s12, 52429
    s_lshr_b32 s89, s89, 18
    s_mul_i32 s90, s89, 5
    s_sub_u32 s90, s12, s90
    s_lshl_b32 s90, s90, 2
    s_lshr_b32 s90, s78, s90
    s_and_b32 s90, s90, 15
    s_add_u32 s90, s90, s79
    s_lshl_b32 s90, s90, 8
    s_mul_i32 s88, s89, 294912
    s_add_u32 s88, s88, s90
    buffer_load_dword v1, v16, s[80:83], s88 offen
    s_branch parallel_sum__ssm_conv_s5__mixer_token_mlp__prompt_kernel_go_42
parallel_sum__ssm_conv_s5__mixer_token_mlp__prompt_kernel_w2l_41:
    s_sub_u32 s88, s12, 320
    s_min_u32 s88, s88, 287
    s_lshl_b32 s88, s88, 14
    s_add_u32 s88, s88, s77
    buffer_load_dword v1, v17, s[84:87], s88 offen
parallel_sum__ssm_conv_s5__mixer_token_mlp__prompt_kernel_go_42:
    s_add_u32 s12, s12, 8
parallel_sum__ssm_conv_s5__mixer_token_mlp__prompt_kernel_ab_10:
    s_cmp_ge_u32 s3, 4
    s_cbranch_scc1 parallel_sum__ssm_conv_s5__mixer_token_mlp__prompt_kernel_g1l_7
parallel_sum__ssm_conv_s5__mixer_token_mlp__prompt_kernel_g1c_6:
    s_setprio 2
    s_and_b32 s6, s51, 1
    s_mul_i32 s6, s6, 3
    s_add_u32 s6, s6, s66
    s_sub_u32 s6, s6, 18
    s_add_u32 s7, s66, 12
    s_cmp_ge_u32 s66, 18
    s_cselect_b32 s5, s6, s7
    s_mul_i32 s6, s5, 43
    s_lshr_b32 s6, s6, 8
    s_mul_i32 s7, s6, 6
    s_sub_u32 s7, s5, s7
    s_mov_b32 s5, 0x43201
    s_cmp_eq_u32 s51, 1
    s_cselect_b32 s5, 0x87650, s5
    s_cmp_eq_u32 s51, 2
    s_cselect_b32 s5, 0x32140, s5
    s_cmp_eq_u32 s51, 3
    s_cselect_b32 s5, 0x76584, s5
    s_cmp_eq_u32 s51, 4
    s_cselect_b32 s5, 0x42103, s5
    s_cmp_eq_u32 s51, 5
    s_cselect_b32 s5, 0x86570, s5
    s_cmp_eq_u32 s51, 6
    s_cselect_b32 s5, 0x43102, s5
    s_cmp_eq_u32 s51, 7
    s_cselect_b32 s5, 0x87560, s5
    s_lshl_b32 s6, s6, 2
    s_lshr_b32 s6, s5, s6
    s_and_b32 s6, s6, 15
    s_lshr_b32 s5, s51, 1
    s_mul_i32 s5, s5, 9
    s_add_u32 s6, s6, s5
    s_mov_b32 s56, s38
    s_mov_b32 s57, s39
    s_mov_b32 s58, 0x2400
    s_mov_b32 s59, 0x00020000
    s_lshl_b32 s14, s6, 8
    s_lshl_b32 s15, s3, 6
    s_add_u32 s14, s14, s15
    v_lshlrev_b32 v236, 3, v4
    buffer_load_dwordx2 v[232:233], v236, s[56:59], s14 offen
    buffer_load_dwordx2 v[234:235], v236, s[56:59], s14 offen offset:32
    s_waitcnt vmcnt(0)
    v_lshlrev_b32 v224, 16, v232
    v_and_b32 v225, s4, v232
    v_lshlrev_b32 v226, 16, v233
    v_and_b32 v227, s4, v233
    v_lshlrev_b32 v228, 16, v234
    v_and_b32 v229, s4, v234
    v_lshlrev_b32 v230, 16, v235
    v_and_b32 v231, s4, v235
    s_add_u32 s52, s48, 0x1520000
    s_addc_u32 s53, s49, 0
    s_mov_b32 s54, 0x12000
    s_mov_b32 s55, 0x00020000
    s_add_u32 s56, s48, 0x280000
    s_addc_u32 s57, s49, 0
    s_mov_b32 s58, 0x480000
    s_mov_b32 s59, 0x00020000
parallel_sum__ssm_conv_s5__mixer_token_mlp__prompt_kernel_gbc2_18:
    s_setprio 2
    v_lshrrev_b32 v10, 2, v3
    v_lshl_add_u32 v10, v4, 2, v10
    v_lshlrev_b32 v10, 7, v10
    v_and_b32 v11, 3, v3
    v_lshl_add_u32 v10, v11, 3, v10
    s_lshr_b32 s90, s3, 1
    s_lshl_b32 s90, s90, 12
    v_add_u32 v10, s90, v10
    v_and_b32 v11, 1, v4
    v_lshlrev_b32 v11, 1, v11
    v_lshrrev_b32 v8, 3, v3
    v_or_b32 v11, v11, v8
    s_and_b32 s90, s3, 1
    s_lshl_b32 s90, s90, 1
    v_xor_b32 v8, s90, v11
    v_xor_b32 v9, 1, v8
    v_lshl_add_u32 v8, v8, 5, v10
    v_lshl_add_u32 v9, v9, 5, v10
    v_lshlrev_b32 v13, 4, v2
    v_lshrrev_b32 v10, 3, v3
    v_lshl_add_u32 v10, v4, 2, v10
    v_lshlrev_b32 v10, 4, v10
    s_lshl_b32 s90, s3, 8
    v_add_u32 v10, s90, v10
    v_bfe_u32 v11, v3, 2, 1
    v_mul_u32_u24 v11, 4224, v11
    v_bfe_u32 v12, v3, 1, 1
    v_mul_u32_u24 v12, 1056, v12
    v_xor_b32 v11, v11, v12
    v_and_b32 v12, 1, v3
    v_lshl_add_u32 v11, v12, 3, v11
    v_xor_b32 v10, v10, v11
    v_xor_b32 v14, 32, v10
    v_add_u32 v11, 65536, v13
    v_add_u32 v12, 102400, v13
    s_add_u32 s68, s48, 0x1500000
    s_addc_u32 s69, s49, 0
    s_mov_b32 s70, 0x16c00
    s_mov_b32 s71, 0x00020000
    s_mov_b32 s60, 0
    s_cmp_eq_u32 s50, 0
    s_cselect_b32 s61, 0, 99
    s_barrier
    ds_read_b128 v[72:75], v11 offset:18432
    ds_read_b128 v[76:79], v11 offset:19456
    ds_read_b128 v[80:83], v11 offset:20480
    ds_read_b128 v[84:87], v11 offset:21504
    ds_read_b128 v[88:91], v11 offset:22528
    ds_read_b64_tr_b16 v[64:65], v8 offset:16384
    ds_read_b64_tr_b16 v[66:67], v8 offset:18432
    ds_read_b64_tr_b16 v[68:69], v9 offset:16384
    ds_read_b64_tr_b16 v[70:71], v9 offset:18432
    ds_read_b128 v[92:95], v11 offset:23552
    ds_read_b128 v[104:107], v11 offset:24576
    ds_read_b128 v[108:111], v11 offset:25600
    ds_read_b128 v[112:115], v11 offset:26624
    ds_read_b128 v[116:119], v11 offset:27648
    ds_read_b128 v[120:123], v11 offset:28672
    ds_read_b64_tr_b16 v[96:97], v8 offset:24576
    ds_read_b64_tr_b16 v[98:99], v8 offset:26624
    ds_read_b64_tr_b16 v[100:101], v9 offset:24576
    ds_read_b64_tr_b16 v[102:103], v9 offset:26624
    ds_read_b128 v[124:127], v11 offset:29696
    s_waitcnt lgkmcnt(11)
    v_mfma_f32_16x16x32_bf16 v[16:19], v[64:67], v[72:75], v[224:227]
    v_mfma_f32_16x16x32_bf16 v[20:23], v[68:71], v[72:75], v[228:231]
    v_mfma_f32_16x16x32_bf16 v[24:27], v[64:67], v[76:79], v[224:227]
    v_mfma_f32_16x16x32_bf16 v[28:31], v[68:71], v[76:79], v[228:231]
    v_mfma_f32_16x16x32_bf16 v[32:35], v[64:67], v[80:83], v[224:227]
    v_mfma_f32_16x16x32_bf16 v[36:39], v[68:71], v[80:83], v[228:231]
    v_mfma_f32_16x16x32_bf16 v[40:43], v[64:67], v[84:87], v[224:227]
    v_mfma_f32_16x16x32_bf16 v[44:47], v[68:71], v[84:87], v[228:231]
    s_waitcnt lgkmcnt(0)
    s_barrier
    v_mfma_f32_16x16x32_bf16 v[48:51], v[64:67], v[88:91], v[224:227]
    ds_read_b128 v[72:75], v12 offset:0
    v_mfma_f32_16x16x32_bf16 v[52:55], v[68:71], v[88:91], v[228:231]
    ds_read_b128 v[76:79], v12 offset:1024
    v_mfma_f32_16x16x32_bf16 v[56:59], v[64:67], v[92:95], v[224:227]
    ds_read_b128 v[80:83], v12 offset:2048
    v_mfma_f32_16x16x32_bf16 v[60:63], v[68:71], v[92:95], v[228:231]
    ds_read_b128 v[84:87], v12 offset:3072
    v_mfma_f32_16x16x32_bf16 v[16:19], v[96:99], v[104:107], v[16:19]
    ds_read_b128 v[88:91], v12 offset:4096
    v_mfma_f32_16x16x32_bf16 v[20:23], v[100:103], v[104:107], v[20:23]
    ds_read_b64_tr_b16 v[64:65], v8 offset:32768
    v_mfma_f32_16x16x32_bf16 v[24:27], v[96:99], v[108:111], v[24:27]
    ds_read_b64_tr_b16 v[66:67], v8 offset:34816
    v_mfma_f32_16x16x32_bf16 v[28:31], v[100:103], v[108:111], v[28:31]
    ds_read_b64_tr_b16 v[68:69], v9 offset:32768
    v_mfma_f32_16x16x32_bf16 v[32:35], v[96:99], v[112:115], v[32:35]
    ds_read_b64_tr_b16 v[70:71], v9 offset:34816
    v_mfma_f32_16x16x32_bf16 v[36:39], v[100:103], v[112:115], v[36:39]
    ds_read_b128 v[92:95], v12 offset:5120
    v_mfma_f32_16x16x32_bf16 v[40:43], v[96:99], v[116:119], v[40:43]
    ds_read_b128 v[104:107], v12 offset:6144
    v_mfma_f32_16x16x32_bf16 v[44:47], v[100:103], v[116:119], v[44:47]
    ds_read_b128 v[108:111], v12 offset:7168
    v_mfma_f32_16x16x32_bf16 v[48:51], v[96:99], v[120:123], v[48:51]
    ds_read_b128 v[112:115], v12 offset:8192
    v_mfma_f32_16x16x32_bf16 v[52:55], v[100:103], v[120:123], v[52:55]
    ds_read_b128 v[116:119], v12 offset:9216
    v_mfma_f32_16x16x32_bf16 v[56:59], v[96:99], v[124:127], v[56:59]
    ds_read_b128 v[120:123], v12 offset:10240
    v_mfma_f32_16x16x32_bf16 v[60:63], v[100:103], v[124:127], v[60:63]
    ds_read_b64_tr_b16 v[96:97], v8 offset:40960
    ds_read_b64_tr_b16 v[98:99], v8 offset:43008
    ds_read_b64_tr_b16 v[100:101], v9 offset:40960
    ds_read_b64_tr_b16 v[102:103], v9 offset:43008
    ds_read_b128 v[124:127], v12 offset:11264
    s_mov_b32 s91, 0
    .p2align 6
parallel_sum__ssm_conv_s5__mixer_token_mlp__prompt_kernel_cloop_52:
    s_waitcnt lgkmcnt(11)
    v_mfma_f32_16x16x32_bf16 v[16:19], v[64:67], v[72:75], v[16:19]
    v_mfma_f32_16x16x32_bf16 v[20:23], v[68:71], v[72:75], v[20:23]
    v_mfma_f32_16x16x32_bf16 v[24:27], v[64:67], v[76:79], v[24:27]
    v_mfma_f32_16x16x32_bf16 v[28:31], v[68:71], v[76:79], v[28:31]
    v_mfma_f32_16x16x32_bf16 v[32:35], v[64:67], v[80:83], v[32:35]
    v_mfma_f32_16x16x32_bf16 v[36:39], v[68:71], v[80:83], v[36:39]
    v_mfma_f32_16x16x32_bf16 v[40:43], v[64:67], v[84:87], v[40:43]
    v_mfma_f32_16x16x32_bf16 v[44:47], v[68:71], v[84:87], v[44:47]
    s_waitcnt lgkmcnt(0)
    s_barrier
    v_mfma_f32_16x16x32_bf16 v[48:51], v[64:67], v[88:91], v[48:51]
    ds_read_b128 v[72:75], v12 offset:18432
    v_mfma_f32_16x16x32_bf16 v[52:55], v[68:71], v[88:91], v[52:55]
    ds_read_b128 v[76:79], v12 offset:19456
    v_mfma_f32_16x16x32_bf16 v[56:59], v[64:67], v[92:95], v[56:59]
    ds_read_b128 v[80:83], v12 offset:20480
    v_mfma_f32_16x16x32_bf16 v[60:63], v[68:71], v[92:95], v[60:63]
    ds_read_b128 v[84:87], v12 offset:21504
    v_mfma_f32_16x16x32_bf16 v[16:19], v[96:99], v[104:107], v[16:19]
    ds_read_b128 v[88:91], v12 offset:22528
    v_mfma_f32_16x16x32_bf16 v[20:23], v[100:103], v[104:107], v[20:23]
    ds_read_b64_tr_b16 v[64:65], v8 offset:49152
    v_mfma_f32_16x16x32_bf16 v[24:27], v[96:99], v[108:111], v[24:27]
    ds_read_b64_tr_b16 v[66:67], v8 offset:51200
    v_mfma_f32_16x16x32_bf16 v[28:31], v[100:103], v[108:111], v[28:31]
    ds_read_b64_tr_b16 v[68:69], v9 offset:49152
    v_mfma_f32_16x16x32_bf16 v[32:35], v[96:99], v[112:115], v[32:35]
    ds_read_b64_tr_b16 v[70:71], v9 offset:51200
    v_mfma_f32_16x16x32_bf16 v[36:39], v[100:103], v[112:115], v[36:39]
    ds_read_b128 v[92:95], v12 offset:23552
    v_mfma_f32_16x16x32_bf16 v[40:43], v[96:99], v[116:119], v[40:43]
    ds_read_b128 v[104:107], v12 offset:24576
    v_mfma_f32_16x16x32_bf16 v[44:47], v[100:103], v[116:119], v[44:47]
    ds_read_b128 v[108:111], v12 offset:25600
    v_mfma_f32_16x16x32_bf16 v[48:51], v[96:99], v[120:123], v[48:51]
    ds_read_b128 v[112:115], v12 offset:26624
    v_mfma_f32_16x16x32_bf16 v[52:55], v[100:103], v[120:123], v[52:55]
    ds_read_b128 v[116:119], v12 offset:27648
    v_mfma_f32_16x16x32_bf16 v[56:59], v[96:99], v[124:127], v[56:59]
    ds_read_b128 v[120:123], v12 offset:28672
    v_mfma_f32_16x16x32_bf16 v[60:63], v[100:103], v[124:127], v[60:63]
    ds_read_b64_tr_b16 v[96:97], v8 offset:57344
    s_waitcnt lgkmcnt(7)
    v_mfma_f32_16x16x32_bf16 v[16:19], v[64:67], v[72:75], v[16:19]
    ds_read_b64_tr_b16 v[98:99], v8 offset:59392
    v_mfma_f32_16x16x32_bf16 v[20:23], v[68:71], v[72:75], v[20:23]
    ds_read_b64_tr_b16 v[100:101], v9 offset:57344
    v_mfma_f32_16x16x32_bf16 v[24:27], v[64:67], v[76:79], v[24:27]
    ds_read_b64_tr_b16 v[102:103], v9 offset:59392
    v_mfma_f32_16x16x32_bf16 v[28:31], v[68:71], v[76:79], v[28:31]
    ds_read_b128 v[124:127], v12 offset:29696
    v_mfma_f32_16x16x32_bf16 v[32:35], v[64:67], v[80:83], v[32:35]
    v_mfma_f32_16x16x32_bf16 v[36:39], v[68:71], v[80:83], v[36:39]
    v_mfma_f32_16x16x32_bf16 v[40:43], v[64:67], v[84:87], v[40:43]
    v_mfma_f32_16x16x32_bf16 v[44:47], v[68:71], v[84:87], v[44:47]
    s_waitcnt lgkmcnt(0)
    s_barrier
    v_mfma_f32_16x16x32_bf16 v[48:51], v[64:67], v[88:91], v[48:51]
    ds_read_b128 v[72:75], v11 offset:0
    v_mfma_f32_16x16x32_bf16 v[52:55], v[68:71], v[88:91], v[52:55]
    ds_read_b128 v[76:79], v11 offset:1024
    v_mfma_f32_16x16x32_bf16 v[56:59], v[64:67], v[92:95], v[56:59]
    ds_read_b128 v[80:83], v11 offset:2048
    v_mfma_f32_16x16x32_bf16 v[60:63], v[68:71], v[92:95], v[60:63]
    ds_read_b128 v[84:87], v11 offset:3072
    v_mfma_f32_16x16x32_bf16 v[16:19], v[96:99], v[104:107], v[16:19]
    ds_read_b128 v[88:91], v11 offset:4096
    v_mfma_f32_16x16x32_bf16 v[20:23], v[100:103], v[104:107], v[20:23]
    ds_read_b64_tr_b16 v[64:65], v8 offset:0
    v_mfma_f32_16x16x32_bf16 v[24:27], v[96:99], v[108:111], v[24:27]
    ds_read_b64_tr_b16 v[66:67], v8 offset:2048
    v_mfma_f32_16x16x32_bf16 v[28:31], v[100:103], v[108:111], v[28:31]
    ds_read_b64_tr_b16 v[68:69], v9 offset:0
    v_mfma_f32_16x16x32_bf16 v[32:35], v[96:99], v[112:115], v[32:35]
    ds_read_b64_tr_b16 v[70:71], v9 offset:2048
    v_mfma_f32_16x16x32_bf16 v[36:39], v[100:103], v[112:115], v[36:39]
    ds_read_b128 v[92:95], v11 offset:5120
    v_mfma_f32_16x16x32_bf16 v[40:43], v[96:99], v[116:119], v[40:43]
    ds_read_b128 v[104:107], v11 offset:6144
    v_mfma_f32_16x16x32_bf16 v[44:47], v[100:103], v[116:119], v[44:47]
    ds_read_b128 v[108:111], v11 offset:7168
    v_mfma_f32_16x16x32_bf16 v[48:51], v[96:99], v[120:123], v[48:51]
    ds_read_b128 v[112:115], v11 offset:8192
    v_mfma_f32_16x16x32_bf16 v[52:55], v[100:103], v[120:123], v[52:55]
    ds_read_b128 v[116:119], v11 offset:9216
    v_mfma_f32_16x16x32_bf16 v[56:59], v[96:99], v[124:127], v[56:59]
    ds_read_b128 v[120:123], v11 offset:10240
    v_mfma_f32_16x16x32_bf16 v[60:63], v[100:103], v[124:127], v[60:63]
    ds_read_b64_tr_b16 v[96:97], v8 offset:8192
    s_cmp_eq_u32 s60, s61
    s_cbranch_scc1 parallel_sum__ssm_conv_s5__mixer_token_mlp__prompt_kernel_disp_50
parallel_sum__ssm_conv_s5__mixer_token_mlp__prompt_kernel_back0_48:
    s_add_u32 s60, s60, 1
    s_waitcnt lgkmcnt(7)
    v_mfma_f32_16x16x32_bf16 v[16:19], v[64:67], v[72:75], v[16:19]
    ds_read_b64_tr_b16 v[98:99], v8 offset:10240
    v_mfma_f32_16x16x32_bf16 v[20:23], v[68:71], v[72:75], v[20:23]
    ds_read_b64_tr_b16 v[100:101], v9 offset:8192
    v_mfma_f32_16x16x32_bf16 v[24:27], v[64:67], v[76:79], v[24:27]
    ds_read_b64_tr_b16 v[102:103], v9 offset:10240
    v_mfma_f32_16x16x32_bf16 v[28:31], v[68:71], v[76:79], v[28:31]
    ds_read_b128 v[124:127], v11 offset:11264
    v_mfma_f32_16x16x32_bf16 v[32:35], v[64:67], v[80:83], v[32:35]
    v_mfma_f32_16x16x32_bf16 v[36:39], v[68:71], v[80:83], v[36:39]
    v_mfma_f32_16x16x32_bf16 v[40:43], v[64:67], v[84:87], v[40:43]
    v_mfma_f32_16x16x32_bf16 v[44:47], v[68:71], v[84:87], v[44:47]
    s_waitcnt lgkmcnt(0)
    s_barrier
    v_mfma_f32_16x16x32_bf16 v[48:51], v[64:67], v[88:91], v[48:51]
    ds_read_b128 v[72:75], v11 offset:18432
    v_mfma_f32_16x16x32_bf16 v[52:55], v[68:71], v[88:91], v[52:55]
    ds_read_b128 v[76:79], v11 offset:19456
    v_mfma_f32_16x16x32_bf16 v[56:59], v[64:67], v[92:95], v[56:59]
    ds_read_b128 v[80:83], v11 offset:20480
    v_mfma_f32_16x16x32_bf16 v[60:63], v[68:71], v[92:95], v[60:63]
    ds_read_b128 v[84:87], v11 offset:21504
    v_mfma_f32_16x16x32_bf16 v[16:19], v[96:99], v[104:107], v[16:19]
    ds_read_b128 v[88:91], v11 offset:22528
    v_mfma_f32_16x16x32_bf16 v[20:23], v[100:103], v[104:107], v[20:23]
    ds_read_b64_tr_b16 v[64:65], v8 offset:16384
    v_mfma_f32_16x16x32_bf16 v[24:27], v[96:99], v[108:111], v[24:27]
    ds_read_b64_tr_b16 v[66:67], v8 offset:18432
    v_mfma_f32_16x16x32_bf16 v[28:31], v[100:103], v[108:111], v[28:31]
    ds_read_b64_tr_b16 v[68:69], v9 offset:16384
    v_mfma_f32_16x16x32_bf16 v[32:35], v[96:99], v[112:115], v[32:35]
    ds_read_b64_tr_b16 v[70:71], v9 offset:18432
    v_mfma_f32_16x16x32_bf16 v[36:39], v[100:103], v[112:115], v[36:39]
    ds_read_b128 v[92:95], v11 offset:23552
    v_mfma_f32_16x16x32_bf16 v[40:43], v[96:99], v[116:119], v[40:43]
    ds_read_b128 v[104:107], v11 offset:24576
    v_mfma_f32_16x16x32_bf16 v[44:47], v[100:103], v[116:119], v[44:47]
    ds_read_b128 v[108:111], v11 offset:25600
    v_mfma_f32_16x16x32_bf16 v[48:51], v[96:99], v[120:123], v[48:51]
    ds_read_b128 v[112:115], v11 offset:26624
    v_mfma_f32_16x16x32_bf16 v[52:55], v[100:103], v[120:123], v[52:55]
    ds_read_b128 v[116:119], v11 offset:27648
    v_mfma_f32_16x16x32_bf16 v[56:59], v[96:99], v[124:127], v[56:59]
    ds_read_b128 v[120:123], v11 offset:28672
    v_mfma_f32_16x16x32_bf16 v[60:63], v[100:103], v[124:127], v[60:63]
    ds_read_b64_tr_b16 v[96:97], v8 offset:24576
    s_waitcnt lgkmcnt(7)
    v_mfma_f32_16x16x32_bf16 v[16:19], v[64:67], v[72:75], v[16:19]
    ds_read_b64_tr_b16 v[98:99], v8 offset:26624
    v_mfma_f32_16x16x32_bf16 v[20:23], v[68:71], v[72:75], v[20:23]
    ds_read_b64_tr_b16 v[100:101], v9 offset:24576
    v_mfma_f32_16x16x32_bf16 v[24:27], v[64:67], v[76:79], v[24:27]
    ds_read_b64_tr_b16 v[102:103], v9 offset:26624
    v_mfma_f32_16x16x32_bf16 v[28:31], v[68:71], v[76:79], v[28:31]
    ds_read_b128 v[124:127], v11 offset:29696
    v_mfma_f32_16x16x32_bf16 v[32:35], v[64:67], v[80:83], v[32:35]
    v_mfma_f32_16x16x32_bf16 v[36:39], v[68:71], v[80:83], v[36:39]
    v_mfma_f32_16x16x32_bf16 v[40:43], v[64:67], v[84:87], v[40:43]
    v_mfma_f32_16x16x32_bf16 v[44:47], v[68:71], v[84:87], v[44:47]
    s_waitcnt lgkmcnt(0)
    s_barrier
    v_mfma_f32_16x16x32_bf16 v[48:51], v[64:67], v[88:91], v[48:51]
    ds_read_b128 v[72:75], v12 offset:0
    v_mfma_f32_16x16x32_bf16 v[52:55], v[68:71], v[88:91], v[52:55]
    ds_read_b128 v[76:79], v12 offset:1024
    v_mfma_f32_16x16x32_bf16 v[56:59], v[64:67], v[92:95], v[56:59]
    ds_read_b128 v[80:83], v12 offset:2048
    v_mfma_f32_16x16x32_bf16 v[60:63], v[68:71], v[92:95], v[60:63]
    ds_read_b128 v[84:87], v12 offset:3072
    v_mfma_f32_16x16x32_bf16 v[16:19], v[96:99], v[104:107], v[16:19]
    ds_read_b128 v[88:91], v12 offset:4096
    v_mfma_f32_16x16x32_bf16 v[20:23], v[100:103], v[104:107], v[20:23]
    ds_read_b64_tr_b16 v[64:65], v8 offset:32768
    v_mfma_f32_16x16x32_bf16 v[24:27], v[96:99], v[108:111], v[24:27]
    ds_read_b64_tr_b16 v[66:67], v8 offset:34816
    v_mfma_f32_16x16x32_bf16 v[28:31], v[100:103], v[108:111], v[28:31]
    ds_read_b64_tr_b16 v[68:69], v9 offset:32768
    v_mfma_f32_16x16x32_bf16 v[32:35], v[96:99], v[112:115], v[32:35]
    ds_read_b64_tr_b16 v[70:71], v9 offset:34816
    v_mfma_f32_16x16x32_bf16 v[36:39], v[100:103], v[112:115], v[36:39]
    ds_read_b128 v[92:95], v12 offset:5120
    v_mfma_f32_16x16x32_bf16 v[40:43], v[96:99], v[116:119], v[40:43]
    ds_read_b128 v[104:107], v12 offset:6144
    v_mfma_f32_16x16x32_bf16 v[44:47], v[100:103], v[116:119], v[44:47]
    ds_read_b128 v[108:111], v12 offset:7168
    v_mfma_f32_16x16x32_bf16 v[48:51], v[96:99], v[120:123], v[48:51]
    ds_read_b128 v[112:115], v12 offset:8192
    v_mfma_f32_16x16x32_bf16 v[52:55], v[100:103], v[120:123], v[52:55]
    ds_read_b128 v[116:119], v12 offset:9216
    v_mfma_f32_16x16x32_bf16 v[56:59], v[96:99], v[124:127], v[56:59]
    ds_read_b128 v[120:123], v12 offset:10240
    v_mfma_f32_16x16x32_bf16 v[60:63], v[100:103], v[124:127], v[60:63]
    ds_read_b64_tr_b16 v[96:97], v8 offset:40960
    s_cmp_eq_u32 s60, s61
    s_cbranch_scc1 parallel_sum__ssm_conv_s5__mixer_token_mlp__prompt_kernel_disp_50
parallel_sum__ssm_conv_s5__mixer_token_mlp__prompt_kernel_back1_49:
    s_add_u32 s60, s60, 1
    ds_read_b64_tr_b16 v[98:99], v8 offset:43008
    ds_read_b64_tr_b16 v[100:101], v9 offset:40960
    ds_read_b64_tr_b16 v[102:103], v9 offset:43008
    ds_read_b128 v[124:127], v12 offset:11264
    s_add_u32 s91, s91, 1
    s_cmp_lt_u32 s91, 7
    s_cbranch_scc1 parallel_sum__ssm_conv_s5__mixer_token_mlp__prompt_kernel_cloop_52
    s_waitcnt lgkmcnt(11)
    v_mfma_f32_16x16x32_bf16 v[16:19], v[64:67], v[72:75], v[16:19]
    v_mfma_f32_16x16x32_bf16 v[20:23], v[68:71], v[72:75], v[20:23]
    v_mfma_f32_16x16x32_bf16 v[24:27], v[64:67], v[76:79], v[24:27]
    v_mfma_f32_16x16x32_bf16 v[28:31], v[68:71], v[76:79], v[28:31]
    v_mfma_f32_16x16x32_bf16 v[32:35], v[64:67], v[80:83], v[32:35]
    v_mfma_f32_16x16x32_bf16 v[36:39], v[68:71], v[80:83], v[36:39]
    v_mfma_f32_16x16x32_bf16 v[40:43], v[64:67], v[84:87], v[40:43]
    v_mfma_f32_16x16x32_bf16 v[44:47], v[68:71], v[84:87], v[44:47]
    s_waitcnt lgkmcnt(0)
    s_barrier
    v_mfma_f32_16x16x32_bf16 v[48:51], v[64:67], v[88:91], v[48:51]
    ds_read_b128 v[72:75], v12 offset:18432
    v_mfma_f32_16x16x32_bf16 v[52:55], v[68:71], v[88:91], v[52:55]
    ds_read_b128 v[76:79], v12 offset:19456
    v_mfma_f32_16x16x32_bf16 v[56:59], v[64:67], v[92:95], v[56:59]
    ds_read_b128 v[80:83], v12 offset:20480
    v_mfma_f32_16x16x32_bf16 v[60:63], v[68:71], v[92:95], v[60:63]
    ds_read_b128 v[84:87], v12 offset:21504
    v_mfma_f32_16x16x32_bf16 v[16:19], v[96:99], v[104:107], v[16:19]
    ds_read_b128 v[88:91], v12 offset:22528
    v_mfma_f32_16x16x32_bf16 v[20:23], v[100:103], v[104:107], v[20:23]
    ds_read_b64_tr_b16 v[64:65], v8 offset:49152
    v_mfma_f32_16x16x32_bf16 v[24:27], v[96:99], v[108:111], v[24:27]
    ds_read_b64_tr_b16 v[66:67], v8 offset:51200
    v_mfma_f32_16x16x32_bf16 v[28:31], v[100:103], v[108:111], v[28:31]
    ds_read_b64_tr_b16 v[68:69], v9 offset:49152
    v_mfma_f32_16x16x32_bf16 v[32:35], v[96:99], v[112:115], v[32:35]
    ds_read_b64_tr_b16 v[70:71], v9 offset:51200
    v_mfma_f32_16x16x32_bf16 v[36:39], v[100:103], v[112:115], v[36:39]
    ds_read_b128 v[92:95], v12 offset:23552
    v_mfma_f32_16x16x32_bf16 v[40:43], v[96:99], v[116:119], v[40:43]
    ds_read_b128 v[104:107], v12 offset:24576
    v_mfma_f32_16x16x32_bf16 v[44:47], v[100:103], v[116:119], v[44:47]
    ds_read_b128 v[108:111], v12 offset:25600
    v_mfma_f32_16x16x32_bf16 v[48:51], v[96:99], v[120:123], v[48:51]
    ds_read_b128 v[112:115], v12 offset:26624
    v_mfma_f32_16x16x32_bf16 v[52:55], v[100:103], v[120:123], v[52:55]
    ds_read_b128 v[116:119], v12 offset:27648
    v_mfma_f32_16x16x32_bf16 v[56:59], v[96:99], v[124:127], v[56:59]
    ds_read_b128 v[120:123], v12 offset:28672
    v_mfma_f32_16x16x32_bf16 v[60:63], v[100:103], v[124:127], v[60:63]
    ds_read_b64_tr_b16 v[96:97], v8 offset:57344
    s_waitcnt lgkmcnt(7)
    v_mfma_f32_16x16x32_bf16 v[16:19], v[64:67], v[72:75], v[16:19]
    ds_read_b64_tr_b16 v[98:99], v8 offset:59392
    v_mfma_f32_16x16x32_bf16 v[20:23], v[68:71], v[72:75], v[20:23]
    ds_read_b64_tr_b16 v[100:101], v9 offset:57344
    v_mfma_f32_16x16x32_bf16 v[24:27], v[64:67], v[76:79], v[24:27]
    ds_read_b64_tr_b16 v[102:103], v9 offset:59392
    v_mfma_f32_16x16x32_bf16 v[28:31], v[68:71], v[76:79], v[28:31]
    ds_read_b128 v[124:127], v12 offset:29696
    v_mfma_f32_16x16x32_bf16 v[32:35], v[64:67], v[80:83], v[32:35]
    v_mfma_f32_16x16x32_bf16 v[36:39], v[68:71], v[80:83], v[36:39]
    v_mfma_f32_16x16x32_bf16 v[40:43], v[64:67], v[84:87], v[40:43]
    v_mfma_f32_16x16x32_bf16 v[44:47], v[68:71], v[84:87], v[44:47]
    s_waitcnt lgkmcnt(0)
    s_barrier
    v_mfma_f32_16x16x32_bf16 v[48:51], v[64:67], v[88:91], v[48:51]
    ds_read_b128 v[72:75], v11 offset:0
    v_mfma_f32_16x16x32_bf16 v[52:55], v[68:71], v[88:91], v[52:55]
    ds_read_b128 v[76:79], v11 offset:1024
    v_mfma_f32_16x16x32_bf16 v[56:59], v[64:67], v[92:95], v[56:59]
    ds_read_b128 v[80:83], v11 offset:2048
    v_mfma_f32_16x16x32_bf16 v[60:63], v[68:71], v[92:95], v[60:63]
    ds_read_b128 v[84:87], v11 offset:3072
    v_mfma_f32_16x16x32_bf16 v[16:19], v[96:99], v[104:107], v[16:19]
    ds_read_b128 v[88:91], v11 offset:4096
    v_mfma_f32_16x16x32_bf16 v[20:23], v[100:103], v[104:107], v[20:23]
    ds_read_b64_tr_b16 v[64:65], v8 offset:0
    v_mfma_f32_16x16x32_bf16 v[24:27], v[96:99], v[108:111], v[24:27]
    ds_read_b64_tr_b16 v[66:67], v8 offset:2048
    v_mfma_f32_16x16x32_bf16 v[28:31], v[100:103], v[108:111], v[28:31]
    ds_read_b64_tr_b16 v[68:69], v9 offset:0
    v_mfma_f32_16x16x32_bf16 v[32:35], v[96:99], v[112:115], v[32:35]
    ds_read_b64_tr_b16 v[70:71], v9 offset:2048
    v_mfma_f32_16x16x32_bf16 v[36:39], v[100:103], v[112:115], v[36:39]
    ds_read_b128 v[92:95], v11 offset:5120
    v_mfma_f32_16x16x32_bf16 v[40:43], v[96:99], v[116:119], v[40:43]
    ds_read_b128 v[104:107], v11 offset:6144
    v_mfma_f32_16x16x32_bf16 v[44:47], v[100:103], v[116:119], v[44:47]
    ds_read_b128 v[108:111], v11 offset:7168
    v_mfma_f32_16x16x32_bf16 v[48:51], v[96:99], v[120:123], v[48:51]
    ds_read_b128 v[112:115], v11 offset:8192
    v_mfma_f32_16x16x32_bf16 v[52:55], v[100:103], v[120:123], v[52:55]
    ds_read_b128 v[116:119], v11 offset:9216
    v_mfma_f32_16x16x32_bf16 v[56:59], v[96:99], v[124:127], v[56:59]
    ds_read_b128 v[120:123], v11 offset:10240
    v_mfma_f32_16x16x32_bf16 v[60:63], v[100:103], v[124:127], v[60:63]
    ds_read_b64_tr_b16 v[96:97], v8 offset:8192
    s_waitcnt lgkmcnt(7)
    v_mfma_f32_16x16x32_bf16 v[16:19], v[64:67], v[72:75], v[16:19]
    ds_read_b64_tr_b16 v[98:99], v8 offset:10240
    v_mfma_f32_16x16x32_bf16 v[20:23], v[68:71], v[72:75], v[20:23]
    ds_read_b64_tr_b16 v[100:101], v9 offset:8192
    v_mfma_f32_16x16x32_bf16 v[24:27], v[64:67], v[76:79], v[24:27]
    ds_read_b64_tr_b16 v[102:103], v9 offset:10240
    v_mfma_f32_16x16x32_bf16 v[28:31], v[68:71], v[76:79], v[28:31]
    ds_read_b128 v[124:127], v11 offset:11264
    v_mfma_f32_16x16x32_bf16 v[32:35], v[64:67], v[80:83], v[32:35]
    v_mfma_f32_16x16x32_bf16 v[36:39], v[68:71], v[80:83], v[36:39]
    v_mfma_f32_16x16x32_bf16 v[40:43], v[64:67], v[84:87], v[40:43]
    v_mfma_f32_16x16x32_bf16 v[44:47], v[68:71], v[84:87], v[44:47]
    v_mfma_f32_16x16x32_bf16 v[48:51], v[64:67], v[88:91], v[48:51]
    v_mfma_f32_16x16x32_bf16 v[52:55], v[68:71], v[88:91], v[52:55]
    s_waitcnt lgkmcnt(10)
    v_mfma_f32_16x16x32_bf16 v[56:59], v[64:67], v[92:95], v[56:59]
    v_mfma_f32_16x16x32_bf16 v[60:63], v[68:71], v[92:95], v[60:63]
    s_waitcnt lgkmcnt(1)
    v_mfma_f32_16x16x32_bf16 v[16:19], v[96:99], v[104:107], v[16:19]
    v_mfma_f32_16x16x32_bf16 v[20:23], v[100:103], v[104:107], v[20:23]
    v_mfma_f32_16x16x32_bf16 v[24:27], v[96:99], v[108:111], v[24:27]
    v_mfma_f32_16x16x32_bf16 v[28:31], v[100:103], v[108:111], v[28:31]
    v_mfma_f32_16x16x32_bf16 v[32:35], v[96:99], v[112:115], v[32:35]
    v_mfma_f32_16x16x32_bf16 v[36:39], v[100:103], v[112:115], v[36:39]
    v_mfma_f32_16x16x32_bf16 v[40:43], v[96:99], v[116:119], v[40:43]
    v_mfma_f32_16x16x32_bf16 v[44:47], v[100:103], v[116:119], v[44:47]
    v_mfma_f32_16x16x32_bf16 v[48:51], v[96:99], v[120:123], v[48:51]
    v_mfma_f32_16x16x32_bf16 v[52:55], v[100:103], v[120:123], v[52:55]
    s_waitcnt lgkmcnt(0)
    v_mfma_f32_16x16x32_bf16 v[56:59], v[96:99], v[124:127], v[56:59]
    v_mfma_f32_16x16x32_bf16 v[60:63], v[100:103], v[124:127], v[60:63]
parallel_sum__ssm_conv_s5__mixer_token_mlp__prompt_kernel_d2_13:
    s_add_u32 s72, s48, 0x700000
    s_addc_u32 s73, s49, 0
    s_mov_b32 s74, 0x654000
    s_mov_b32 s75, 0x00020000
    s_lshl_b32 s62, s6, 2
    s_add_u32 s62, s62, s3
    s_mul_i32 s14, s62, 36
    s_mul_i32 s15, s7, 6
    s_add_u32 s14, s14, s15
    s_lshl_b32 s14, s14, 10
    s_add_u32 s15, s14, 4096
    s_mul_i32 s62, s6, 6
    s_add_u32 s62, s62, s7
    s_lshl_b32 s62, s62, 5
    s_add_u32 s62, s62, s3
    s_lshl_b32 s62, s62, 2
    s_add_u32 s62, s62, 51200
    v_mov_b32 v64, 0xbdd2d3e8
    v_mov_b32 v65, v64
    v_mov_b32 v66, 0xc0135761
    v_mov_b32 v67, v66
    v_pk_mul_f32 v[76:77], v[16:17], v[16:17]
    v_pk_mul_f32 v[78:79], v[18:19], v[18:19]
    v_pk_mul_f32 v[80:81], v[20:21], v[20:21]
    v_pk_mul_f32 v[82:83], v[22:23], v[22:23]
    v_pk_fma_f32 v[76:77], v[76:77], v[64:65], v[66:67]
    v_pk_fma_f32 v[78:79], v[78:79], v[64:65], v[66:67]
    v_pk_fma_f32 v[80:81], v[80:81], v[64:65], v[66:67]
    v_pk_fma_f32 v[82:83], v[82:83], v[64:65], v[66:67]
    v_pk_mul_f32 v[76:77], v[76:77], v[16:17]
    v_pk_mul_f32 v[78:79], v[78:79], v[18:19]
    v_pk_mul_f32 v[80:81], v[80:81], v[20:21]
    v_pk_mul_f32 v[82:83], v[82:83], v[22:23]
    v_exp_f32 v76, v76
    v_exp_f32 v78, v78
    v_exp_f32 v80, v80
    v_exp_f32 v82, v82
    v_exp_f32 v77, v77
    v_exp_f32 v79, v79
    v_exp_f32 v81, v81
    v_exp_f32 v83, v83
    v_pk_add_f32 v[76:77], v[76:77], 1.0 op_sel_hi:[1,0]
    v_pk_add_f32 v[78:79], v[78:79], 1.0 op_sel_hi:[1,0]
    v_pk_add_f32 v[80:81], v[80:81], 1.0 op_sel_hi:[1,0]
    v_pk_add_f32 v[82:83], v[82:83], 1.0 op_sel_hi:[1,0]
    v_rcp_f32 v76, v76
    v_rcp_f32 v78, v78
    v_rcp_f32 v80, v80
    v_rcp_f32 v82, v82
    v_rcp_f32 v77, v77
    v_rcp_f32 v79, v79
    v_rcp_f32 v81, v81
    v_rcp_f32 v83, v83
    v_pk_mul_f32 v[16:17], v[16:17], v[76:77]
    v_pk_mul_f32 v[18:19], v[18:19], v[78:79]
    v_pk_mul_f32 v[20:21], v[20:21], v[80:81]
    v_pk_mul_f32 v[22:23], v[22:23], v[82:83]
    v_cvt_pk_bf16_f32 v208, v16, v17
    v_cvt_pk_bf16_f32 v209, v18, v19
    v_cvt_pk_bf16_f32 v210, v20, v21
    v_cvt_pk_bf16_f32 v211, v22, v23
    buffer_store_dwordx4 v[208:211], v13, s[72:75], s14 offen offset:0 sc1
    v_pk_mul_f32 v[76:77], v[24:25], v[24:25]
    v_pk_mul_f32 v[78:79], v[26:27], v[26:27]
    v_pk_mul_f32 v[80:81], v[28:29], v[28:29]
    v_pk_mul_f32 v[82:83], v[30:31], v[30:31]
    v_pk_fma_f32 v[76:77], v[76:77], v[64:65], v[66:67]
    v_pk_fma_f32 v[78:79], v[78:79], v[64:65], v[66:67]
    v_pk_fma_f32 v[80:81], v[80:81], v[64:65], v[66:67]
    v_pk_fma_f32 v[82:83], v[82:83], v[64:65], v[66:67]
    v_pk_mul_f32 v[76:77], v[76:77], v[24:25]
    v_pk_mul_f32 v[78:79], v[78:79], v[26:27]
    v_pk_mul_f32 v[80:81], v[80:81], v[28:29]
    v_pk_mul_f32 v[82:83], v[82:83], v[30:31]
    v_exp_f32 v76, v76
    v_exp_f32 v78, v78
    v_exp_f32 v80, v80
    v_exp_f32 v82, v82
    v_exp_f32 v77, v77
    v_exp_f32 v79, v79
    v_exp_f32 v81, v81
    v_exp_f32 v83, v83
    v_pk_add_f32 v[76:77], v[76:77], 1.0 op_sel_hi:[1,0]
    v_pk_add_f32 v[78:79], v[78:79], 1.0 op_sel_hi:[1,0]
    v_pk_add_f32 v[80:81], v[80:81], 1.0 op_sel_hi:[1,0]
    v_pk_add_f32 v[82:83], v[82:83], 1.0 op_sel_hi:[1,0]
    v_rcp_f32 v76, v76
    v_rcp_f32 v78, v78
    v_rcp_f32 v80, v80
    v_rcp_f32 v82, v82
    v_rcp_f32 v77, v77
    v_rcp_f32 v79, v79
    v_rcp_f32 v81, v81
    v_rcp_f32 v83, v83
    v_pk_mul_f32 v[24:25], v[24:25], v[76:77]
    v_pk_mul_f32 v[26:27], v[26:27], v[78:79]
    v_pk_mul_f32 v[28:29], v[28:29], v[80:81]
    v_pk_mul_f32 v[30:31], v[30:31], v[82:83]
    v_cvt_pk_bf16_f32 v212, v24, v25
    v_cvt_pk_bf16_f32 v213, v26, v27
    v_cvt_pk_bf16_f32 v214, v28, v29
    v_cvt_pk_bf16_f32 v215, v30, v31
    buffer_store_dwordx4 v[212:215], v13, s[72:75], s14 offen offset:1024 sc1
    v_pk_mul_f32 v[76:77], v[32:33], v[32:33]
    v_pk_mul_f32 v[78:79], v[34:35], v[34:35]
    v_pk_mul_f32 v[80:81], v[36:37], v[36:37]
    v_pk_mul_f32 v[82:83], v[38:39], v[38:39]
    v_pk_fma_f32 v[76:77], v[76:77], v[64:65], v[66:67]
    v_pk_fma_f32 v[78:79], v[78:79], v[64:65], v[66:67]
    v_pk_fma_f32 v[80:81], v[80:81], v[64:65], v[66:67]
    v_pk_fma_f32 v[82:83], v[82:83], v[64:65], v[66:67]
    v_pk_mul_f32 v[76:77], v[76:77], v[32:33]
    v_pk_mul_f32 v[78:79], v[78:79], v[34:35]
    v_pk_mul_f32 v[80:81], v[80:81], v[36:37]
    v_pk_mul_f32 v[82:83], v[82:83], v[38:39]
    v_exp_f32 v76, v76
    v_exp_f32 v78, v78
    v_exp_f32 v80, v80
    v_exp_f32 v82, v82
    v_exp_f32 v77, v77
    v_exp_f32 v79, v79
    v_exp_f32 v81, v81
    v_exp_f32 v83, v83
    v_pk_add_f32 v[76:77], v[76:77], 1.0 op_sel_hi:[1,0]
    v_pk_add_f32 v[78:79], v[78:79], 1.0 op_sel_hi:[1,0]
    v_pk_add_f32 v[80:81], v[80:81], 1.0 op_sel_hi:[1,0]
    v_pk_add_f32 v[82:83], v[82:83], 1.0 op_sel_hi:[1,0]
    v_rcp_f32 v76, v76
    v_rcp_f32 v78, v78
    v_rcp_f32 v80, v80
    v_rcp_f32 v82, v82
    v_rcp_f32 v77, v77
    v_rcp_f32 v79, v79
    v_rcp_f32 v81, v81
    v_rcp_f32 v83, v83
    v_pk_mul_f32 v[32:33], v[32:33], v[76:77]
    v_pk_mul_f32 v[34:35], v[34:35], v[78:79]
    v_pk_mul_f32 v[36:37], v[36:37], v[80:81]
    v_pk_mul_f32 v[38:39], v[38:39], v[82:83]
    v_cvt_pk_bf16_f32 v216, v32, v33
    v_cvt_pk_bf16_f32 v217, v34, v35
    v_cvt_pk_bf16_f32 v218, v36, v37
    v_cvt_pk_bf16_f32 v219, v38, v39
    buffer_store_dwordx4 v[216:219], v13, s[72:75], s14 offen offset:2048 sc1
    v_pk_mul_f32 v[76:77], v[40:41], v[40:41]
    v_pk_mul_f32 v[78:79], v[42:43], v[42:43]
    v_pk_mul_f32 v[80:81], v[44:45], v[44:45]
    v_pk_mul_f32 v[82:83], v[46:47], v[46:47]
    v_pk_fma_f32 v[76:77], v[76:77], v[64:65], v[66:67]
    v_pk_fma_f32 v[78:79], v[78:79], v[64:65], v[66:67]
    v_pk_fma_f32 v[80:81], v[80:81], v[64:65], v[66:67]
    v_pk_fma_f32 v[82:83], v[82:83], v[64:65], v[66:67]
    v_pk_mul_f32 v[76:77], v[76:77], v[40:41]
    v_pk_mul_f32 v[78:79], v[78:79], v[42:43]
    v_pk_mul_f32 v[80:81], v[80:81], v[44:45]
    v_pk_mul_f32 v[82:83], v[82:83], v[46:47]
    v_exp_f32 v76, v76
    v_exp_f32 v78, v78
    v_exp_f32 v80, v80
    v_exp_f32 v82, v82
    v_exp_f32 v77, v77
    v_exp_f32 v79, v79
    v_exp_f32 v81, v81
    v_exp_f32 v83, v83
    v_pk_add_f32 v[76:77], v[76:77], 1.0 op_sel_hi:[1,0]
    v_pk_add_f32 v[78:79], v[78:79], 1.0 op_sel_hi:[1,0]
    v_pk_add_f32 v[80:81], v[80:81], 1.0 op_sel_hi:[1,0]
    v_pk_add_f32 v[82:83], v[82:83], 1.0 op_sel_hi:[1,0]
    v_rcp_f32 v76, v76
    v_rcp_f32 v78, v78
    v_rcp_f32 v80, v80
    v_rcp_f32 v82, v82
    v_rcp_f32 v77, v77
    v_rcp_f32 v79, v79
    v_rcp_f32 v81, v81
    v_rcp_f32 v83, v83
    v_pk_mul_f32 v[40:41], v[40:41], v[76:77]
    v_pk_mul_f32 v[42:43], v[42:43], v[78:79]
    v_pk_mul_f32 v[44:45], v[44:45], v[80:81]
    v_pk_mul_f32 v[46:47], v[46:47], v[82:83]
    v_cvt_pk_bf16_f32 v220, v40, v41
    v_cvt_pk_bf16_f32 v221, v42, v43
    v_cvt_pk_bf16_f32 v222, v44, v45
    v_cvt_pk_bf16_f32 v223, v46, v47
    buffer_store_dwordx4 v[220:223], v13, s[72:75], s14 offen offset:3072 sc1
    v_pk_mul_f32 v[76:77], v[48:49], v[48:49]
    v_pk_mul_f32 v[78:79], v[50:51], v[50:51]
    v_pk_mul_f32 v[80:81], v[52:53], v[52:53]
    v_pk_mul_f32 v[82:83], v[54:55], v[54:55]
    v_pk_fma_f32 v[76:77], v[76:77], v[64:65], v[66:67]
    v_pk_fma_f32 v[78:79], v[78:79], v[64:65], v[66:67]
    v_pk_fma_f32 v[80:81], v[80:81], v[64:65], v[66:67]
    v_pk_fma_f32 v[82:83], v[82:83], v[64:65], v[66:67]
    v_pk_mul_f32 v[76:77], v[76:77], v[48:49]
    v_pk_mul_f32 v[78:79], v[78:79], v[50:51]
    v_pk_mul_f32 v[80:81], v[80:81], v[52:53]
    v_pk_mul_f32 v[82:83], v[82:83], v[54:55]
    v_exp_f32 v76, v76
    v_exp_f32 v78, v78
    v_exp_f32 v80, v80
    v_exp_f32 v82, v82
    v_exp_f32 v77, v77
    v_exp_f32 v79, v79
    v_exp_f32 v81, v81
    v_exp_f32 v83, v83
    v_pk_add_f32 v[76:77], v[76:77], 1.0 op_sel_hi:[1,0]
    v_pk_add_f32 v[78:79], v[78:79], 1.0 op_sel_hi:[1,0]
    v_pk_add_f32 v[80:81], v[80:81], 1.0 op_sel_hi:[1,0]
    v_pk_add_f32 v[82:83], v[82:83], 1.0 op_sel_hi:[1,0]
    v_rcp_f32 v76, v76
    v_rcp_f32 v78, v78
    v_rcp_f32 v80, v80
    v_rcp_f32 v82, v82
    v_rcp_f32 v77, v77
    v_rcp_f32 v79, v79
    v_rcp_f32 v81, v81
    v_rcp_f32 v83, v83
    v_pk_mul_f32 v[48:49], v[48:49], v[76:77]
    v_pk_mul_f32 v[50:51], v[50:51], v[78:79]
    v_pk_mul_f32 v[52:53], v[52:53], v[80:81]
    v_pk_mul_f32 v[54:55], v[54:55], v[82:83]
    v_cvt_pk_bf16_f32 v224, v48, v49
    v_cvt_pk_bf16_f32 v225, v50, v51
    v_cvt_pk_bf16_f32 v226, v52, v53
    v_cvt_pk_bf16_f32 v227, v54, v55
    buffer_store_dwordx4 v[224:227], v13, s[72:75], s15 offen offset:0 sc1
    v_pk_mul_f32 v[76:77], v[56:57], v[56:57]
    v_pk_mul_f32 v[78:79], v[58:59], v[58:59]
    v_pk_mul_f32 v[80:81], v[60:61], v[60:61]
    v_pk_mul_f32 v[82:83], v[62:63], v[62:63]
    v_pk_fma_f32 v[76:77], v[76:77], v[64:65], v[66:67]
    v_pk_fma_f32 v[78:79], v[78:79], v[64:65], v[66:67]
    v_pk_fma_f32 v[80:81], v[80:81], v[64:65], v[66:67]
    v_pk_fma_f32 v[82:83], v[82:83], v[64:65], v[66:67]
    v_pk_mul_f32 v[76:77], v[76:77], v[56:57]
    v_pk_mul_f32 v[78:79], v[78:79], v[58:59]
    v_pk_mul_f32 v[80:81], v[80:81], v[60:61]
    v_pk_mul_f32 v[82:83], v[82:83], v[62:63]
    v_exp_f32 v76, v76
    v_exp_f32 v78, v78
    v_exp_f32 v80, v80
    v_exp_f32 v82, v82
    v_exp_f32 v77, v77
    v_exp_f32 v79, v79
    v_exp_f32 v81, v81
    v_exp_f32 v83, v83
    v_pk_add_f32 v[76:77], v[76:77], 1.0 op_sel_hi:[1,0]
    v_pk_add_f32 v[78:79], v[78:79], 1.0 op_sel_hi:[1,0]
    v_pk_add_f32 v[80:81], v[80:81], 1.0 op_sel_hi:[1,0]
    v_pk_add_f32 v[82:83], v[82:83], 1.0 op_sel_hi:[1,0]
    v_rcp_f32 v76, v76
    v_rcp_f32 v78, v78
    v_rcp_f32 v80, v80
    v_rcp_f32 v82, v82
    v_rcp_f32 v77, v77
    v_rcp_f32 v79, v79
    v_rcp_f32 v81, v81
    v_rcp_f32 v83, v83
    v_pk_mul_f32 v[56:57], v[56:57], v[76:77]
    v_pk_mul_f32 v[58:59], v[58:59], v[78:79]
    v_pk_mul_f32 v[60:61], v[60:61], v[80:81]
    v_pk_mul_f32 v[62:63], v[62:63], v[82:83]
    v_cvt_pk_bf16_f32 v228, v56, v57
    v_cvt_pk_bf16_f32 v229, v58, v59
    v_cvt_pk_bf16_f32 v230, v60, v61
    v_cvt_pk_bf16_f32 v231, v62, v63
    buffer_store_dwordx4 v[228:231], v13, s[72:75], s15 offen offset:1024 sc1
    s_branch parallel_sum__ssm_conv_s5__mixer_token_mlp__prompt_kernel_hc_8
parallel_sum__ssm_conv_s5__mixer_token_mlp__prompt_kernel_disp_50:
    s_cmp_eq_u32 s60, 1
    s_cbranch_scc1 parallel_sum__ssm_conv_s5__mixer_token_mlp__prompt_kernel_ch1_44
    s_cmp_eq_u32 s60, 50
    s_cbranch_scc1 parallel_sum__ssm_conv_s5__mixer_token_mlp__prompt_kernel_ch2_45
    s_cmp_eq_u32 s60, 2
    s_cbranch_scc1 parallel_sum__ssm_conv_s5__mixer_token_mlp__prompt_kernel_ch3_46
    s_cmp_eq_u32 s60, 4
    s_cbranch_scc1 parallel_sum__ssm_conv_s5__mixer_token_mlp__prompt_kernel_ch4_47
parallel_sum__ssm_conv_s5__mixer_token_mlp__prompt_kernel_ch0_43:
    s_lshl_b32 s12, s63, 11
    s_sub_u32 s13, s64, 16
    v_lshl_add_u32 v248, v4, 2, s13
    v_lshlrev_b32 v248, 7, v248
    v_lshl_add_u32 v248, v3, 3, v248
    v_add_u32 v249, 128, v248
    v_add_u32 v250, 256, v248
    v_add_u32 v251, 384, v248
    v_min_u32 v248, 0x100000, v248
    v_min_u32 v249, 0x100000, v249
    v_min_u32 v250, 0x100000, v250
    v_min_u32 v251, 0x100000, v251
    buffer_load_dwordx2 v[240:241], v248, s[52:55], s12 offen sc1
    buffer_load_dwordx2 v[242:243], v249, s[52:55], s12 offen sc1
    buffer_load_dwordx2 v[244:245], v250, s[52:55], s12 offen sc1
    buffer_load_dwordx2 v[246:247], v251, s[52:55], s12 offen sc1
    s_mov_b32 s61, 1
    s_branch parallel_sum__ssm_conv_s5__mixer_token_mlp__prompt_kernel_ret_51
parallel_sum__ssm_conv_s5__mixer_token_mlp__prompt_kernel_ch1_44:
    s_mov_b32 s88, 0
parallel_sum__ssm_conv_s5__mixer_token_mlp__prompt_kernel_ep_53:
    s_waitcnt vmcnt(0)
    v_max3_u32 v224, v240, v241, v242
    v_max3_u32 v225, v243, v244, v245
    v_max3_u32 v224, v224, v246, v247
    v_max_u32 v224, v224, v225
    v_cmp_eq_u32 vcc, -1, v224
    s_cmp_eq_u64 vcc, 0
    s_cbranch_scc1 parallel_sum__ssm_conv_s5__mixer_token_mlp__prompt_kernel_epe_54
    s_add_u32 s88, s88, 1
    s_cmp_ge_u32 s88, 0x8000
    s_cbranch_scc1 parallel_sum__ssm_conv_s5__mixer_token_mlp__prompt_kernel_epe_54
    s_lshl_b32 s12, s63, 11
    s_sub_u32 s13, s64, 16
    v_lshl_add_u32 v248, v4, 2, s13
    v_lshlrev_b32 v248, 7, v248
    v_lshl_add_u32 v248, v3, 3, v248
    v_add_u32 v249, 128, v248
    v_add_u32 v250, 256, v248
    v_add_u32 v251, 384, v248
    v_min_u32 v248, 0x100000, v248
    v_min_u32 v249, 0x100000, v249
    v_min_u32 v250, 0x100000, v250
    v_min_u32 v251, 0x100000, v251
    buffer_load_dwordx2 v[240:241], v248, s[52:55], s12 offen sc1
    buffer_load_dwordx2 v[242:243], v249, s[52:55], s12 offen sc1
    buffer_load_dwordx2 v[244:245], v250, s[52:55], s12 offen sc1
    buffer_load_dwordx2 v[246:247], v251, s[52:55], s12 offen sc1
    s_branch parallel_sum__ssm_conv_s5__mixer_token_mlp__prompt_kernel_ep_53
parallel_sum__ssm_conv_s5__mixer_token_mlp__prompt_kernel_epe_54:
    v_fma_f32 v242, -v217, v241, v242
    v_fma_f32 v243, v217, v240, v243
    v_fma_f32 v242, v216, v240, v242
    v_fma_f32 v243, v216, v241, v243
    v_fma_f32 v244, -v217, v243, v244
    v_fma_f32 v245, v217, v242, v245
    v_fma_f32 v244, v216, v242, v244
    v_fma_f32 v245, v216, v243, v245
    v_fma_f32 v246, -v217, v245, v246
    v_fma_f32 v247, v217, v244, v247
    v_fma_f32 v246, v216, v244, v246
    v_fma_f32 v247, v216, v245, v247
    v_mul_f32 v224, v204, v246
    v_mul_f32 v225, v204, v247
    v_fma_f32 v224, -v205, v247, v224
    v_fma_f32 v225, v205, v246, v225
    v_mov_b32 v226, v224
    v_mov_b32 v227, v225
    s_nop 1
    v_permlane16_swap_b32 v224, v226
    v_permlane16_swap_b32 v225, v227
    s_nop 0
    v_add_f32 v224, v224, v226
    v_add_f32 v225, v225, v227
    v_mov_b32 v226, v224
    v_mov_b32 v227, v225
    s_nop 1
    v_permlane32_swap_b32 v224, v226
    v_permlane32_swap_b32 v225, v227
    s_nop 0
    v_add_f32 v224, v224, v226
    v_add_f32 v225, v225, v227
    v_fma_f32 v228, -v207, v225, v200
    v_fma_f32 v232, v207, v224, v201
    v_fma_f32 v228, v206, v224, v228
    v_fma_f32 v232, v206, v225, v232
    v_fma_f32 v229, -v219, v232, v192
    v_fma_f32 v233, v219, v228, v196
    v_fma_f32 v229, v218, v228, v229
    v_fma_f32 v233, v218, v232, v233
    v_fma_f32 v230, -v219, v233, v193
    v_fma_f32 v234, v219, v229, v197
    v_fma_f32 v230, v218, v229, v230
    v_fma_f32 v234, v218, v233, v234
    v_fma_f32 v231, -v219, v234, v194
    v_fma_f32 v235, v219, v230, v198
    v_fma_f32 v231, v218, v230, v231
    v_fma_f32 v235, v218, v234, v235
parallel_sum__ssm_conv_s5__mixer_token_mlp__prompt_kernel_ch2_45:
    v_pk_fma_f32 v[128:129], v[208:209], v[232:233], v[128:129] op_sel:[1,0,0] op_sel_hi:[1,1,1] neg_lo:[1,0,0] neg_hi:[1,0,0]
    v_pk_fma_f32 v[130:131], v[208:209], v[234:235], v[130:131] op_sel:[1,0,0] op_sel_hi:[1,1,1] neg_lo:[1,0,0] neg_hi:[1,0,0]
    v_pk_fma_f32 v[132:133], v[208:209], v[228:229], v[132:133] op_sel:[1,0,0] op_sel_hi:[1,1,1]
    v_pk_fma_f32 v[134:135], v[208:209], v[230:231], v[134:135] op_sel:[1,0,0] op_sel_hi:[1,1,1]
    v_pk_fma_f32 v[128:129], v[208:209], v[228:229], v[128:129] op_sel_hi:[0,1,1]
    v_pk_fma_f32 v[130:131], v[208:209], v[230:231], v[130:131] op_sel_hi:[0,1,1]
    v_pk_fma_f32 v[132:133], v[208:209], v[232:233], v[132:133] op_sel_hi:[0,1,1]
    v_pk_fma_f32 v[134:135], v[208:209], v[234:235], v[134:135] op_sel_hi:[0,1,1]
    v_pk_fma_f32 v[136:137], v[208:209], v[132:133], v[136:137] op_sel:[1,0,0] op_sel_hi:[1,1,1] neg_lo:[1,0,0] neg_hi:[1,0,0]
    v_pk_fma_f32 v[138:139], v[208:209], v[134:135], v[138:139] op_sel:[1,0,0] op_sel_hi:[1,1,1] neg_lo:[1,0,0] neg_hi:[1,0,0]
    v_pk_fma_f32 v[140:141], v[208:209], v[128:129], v[140:141] op_sel:[1,0,0] op_sel_hi:[1,1,1]
    v_pk_fma_f32 v[142:143], v[208:209], v[130:131], v[142:143] op_sel:[1,0,0] op_sel_hi:[1,1,1]
    v_pk_fma_f32 v[136:137], v[208:209], v[128:129], v[136:137] op_sel_hi:[0,1,1]
    v_pk_fma_f32 v[138:139], v[208:209], v[130:131], v[138:139] op_sel_hi:[0,1,1]
    v_pk_fma_f32 v[140:141], v[208:209], v[132:133], v[140:141] op_sel_hi:[0,1,1]
    v_pk_fma_f32 v[142:143], v[208:209], v[134:135], v[142:143] op_sel_hi:[0,1,1]
    v_pk_fma_f32 v[144:145], v[208:209], v[140:141], v[144:145] op_sel:[1,0,0] op_sel_hi:[1,1,1] neg_lo:[1,0,0] neg_hi:[1,0,0]
    v_pk_fma_f32 v[146:147], v[208:209], v[142:143], v[146:147] op_sel:[1,0,0] op_sel_hi:[1,1,1] neg_lo:[1,0,0] neg_hi:[1,0,0]
    v_pk_fma_f32 v[148:149], v[208:209], v[136:137], v[148:149] op_sel:[1,0,0] op_sel_hi:[1,1,1]
    v_pk_fma_f32 v[150:151], v[208:209], v[138:139], v[150:151] op_sel:[1,0,0] op_sel_hi:[1,1,1]
    v_pk_fma_f32 v[144:145], v[208:209], v[136:137], v[144:145] op_sel_hi:[0,1,1]
    v_pk_fma_f32 v[146:147], v[208:209], v[138:139], v[146:147] op_sel_hi:[0,1,1]
    v_pk_fma_f32 v[148:149], v[208:209], v[140:141], v[148:149] op_sel_hi:[0,1,1]
    v_pk_fma_f32 v[150:151], v[208:209], v[142:143], v[150:151] op_sel_hi:[0,1,1]
    v_pk_fma_f32 v[152:153], v[208:209], v[148:149], v[152:153] op_sel:[1,0,0] op_sel_hi:[1,1,1] neg_lo:[1,0,0] neg_hi:[1,0,0]
    v_pk_fma_f32 v[154:155], v[208:209], v[150:151], v[154:155] op_sel:[1,0,0] op_sel_hi:[1,1,1] neg_lo:[1,0,0] neg_hi:[1,0,0]
    v_pk_fma_f32 v[156:157], v[208:209], v[144:145], v[156:157] op_sel:[1,0,0] op_sel_hi:[1,1,1]
    v_pk_fma_f32 v[158:159], v[208:209], v[146:147], v[158:159] op_sel:[1,0,0] op_sel_hi:[1,1,1]
    v_pk_fma_f32 v[152:153], v[208:209], v[144:145], v[152:153] op_sel_hi:[0,1,1]
    v_pk_fma_f32 v[154:155], v[208:209], v[146:147], v[154:155] op_sel_hi:[0,1,1]
    v_pk_fma_f32 v[156:157], v[208:209], v[148:149], v[156:157] op_sel_hi:[0,1,1]
    v_pk_fma_f32 v[158:159], v[208:209], v[150:151], v[158:159] op_sel_hi:[0,1,1]
    v_pk_fma_f32 v[160:161], v[208:209], v[156:157], v[160:161] op_sel:[1,0,0] op_sel_hi:[1,1,1] neg_lo:[1,0,0] neg_hi:[1,0,0]
    v_pk_fma_f32 v[162:163], v[208:209], v[158:159], v[162:163] op_sel:[1,0,0] op_sel_hi:[1,1,1] neg_lo:[1,0,0] neg_hi:[1,0,0]
    v_pk_fma_f32 v[164:165], v[208:209], v[152:153], v[164:165] op_sel:[1,0,0] op_sel_hi:[1,1,1]
    v_pk_fma_f32 v[166:167], v[208:209], v[154:155], v[166:167] op_sel:[1,0,0] op_sel_hi:[1,1,1]
    v_pk_fma_f32 v[160:161], v[208:209], v[152:153], v[160:161] op_sel_hi:[0,1,1]
    v_pk_fma_f32 v[162:163], v[208:209], v[154:155], v[162:163] op_sel_hi:[0,1,1]
    v_pk_fma_f32 v[164:165], v[208:209], v[156:157], v[164:165] op_sel_hi:[0,1,1]
    v_pk_fma_f32 v[166:167], v[208:209], v[158:159], v[166:167] op_sel_hi:[0,1,1]
    v_pk_fma_f32 v[168:169], v[208:209], v[164:165], v[168:169] op_sel:[1,0,0] op_sel_hi:[1,1,1] neg_lo:[1,0,0] neg_hi:[1,0,0]
    v_pk_fma_f32 v[170:171], v[208:209], v[166:167], v[170:171] op_sel:[1,0,0] op_sel_hi:[1,1,1] neg_lo:[1,0,0] neg_hi:[1,0,0]
    v_pk_fma_f32 v[172:173], v[208:209], v[160:161], v[172:173] op_sel:[1,0,0] op_sel_hi:[1,1,1]
    v_pk_fma_f32 v[174:175], v[208:209], v[162:163], v[174:175] op_sel:[1,0,0] op_sel_hi:[1,1,1]
    v_pk_fma_f32 v[168:169], v[208:209], v[160:161], v[168:169] op_sel_hi:[0,1,1]
    v_pk_fma_f32 v[170:171], v[208:209], v[162:163], v[170:171] op_sel_hi:[0,1,1]
    v_pk_fma_f32 v[172:173], v[208:209], v[164:165], v[172:173] op_sel_hi:[0,1,1]
    v_pk_fma_f32 v[174:175], v[208:209], v[166:167], v[174:175] op_sel_hi:[0,1,1]
    v_pk_fma_f32 v[176:177], v[208:209], v[172:173], v[176:177] op_sel:[1,0,0] op_sel_hi:[1,1,1] neg_lo:[1,0,0] neg_hi:[1,0,0]
    v_pk_fma_f32 v[178:179], v[208:209], v[174:175], v[178:179] op_sel:[1,0,0] op_sel_hi:[1,1,1] neg_lo:[1,0,0] neg_hi:[1,0,0]
    v_pk_fma_f32 v[180:181], v[208:209], v[168:169], v[180:181] op_sel:[1,0,0] op_sel_hi:[1,1,1]
    v_pk_fma_f32 v[182:183], v[208:209], v[170:171], v[182:183] op_sel:[1,0,0] op_sel_hi:[1,1,1]
    v_pk_fma_f32 v[176:177], v[208:209], v[168:169], v[176:177] op_sel_hi:[0,1,1]
    v_pk_fma_f32 v[178:179], v[208:209], v[170:171], v[178:179] op_sel_hi:[0,1,1]
    v_pk_fma_f32 v[180:181], v[208:209], v[172:173], v[180:181] op_sel_hi:[0,1,1]
    v_pk_fma_f32 v[182:183], v[208:209], v[174:175], v[182:183] op_sel_hi:[0,1,1]
    v_pk_fma_f32 v[184:185], v[208:209], v[180:181], v[184:185] op_sel:[1,0,0] op_sel_hi:[1,1,1] neg_lo:[1,0,0] neg_hi:[1,0,0]
    v_pk_fma_f32 v[186:187], v[208:209], v[182:183], v[186:187] op_sel:[1,0,0] op_sel_hi:[1,1,1] neg_lo:[1,0,0] neg_hi:[1,0,0]
    v_pk_fma_f32 v[188:189], v[208:209], v[176:177], v[188:189] op_sel:[1,0,0] op_sel_hi:[1,1,1]
    v_pk_fma_f32 v[190:191], v[208:209], v[178:179], v[190:191] op_sel:[1,0,0] op_sel_hi:[1,1,1]
    v_pk_fma_f32 v[184:185], v[208:209], v[176:177], v[184:185] op_sel_hi:[0,1,1]
    v_pk_fma_f32 v[186:187], v[208:209], v[178:179], v[186:187] op_sel_hi:[0,1,1]
    v_pk_fma_f32 v[188:189], v[208:209], v[180:181], v[188:189] op_sel_hi:[0,1,1]
    v_pk_fma_f32 v[190:191], v[208:209], v[182:183], v[190:191] op_sel_hi:[0,1,1]
    s_mov_b32 s61, 2
    s_branch parallel_sum__ssm_conv_s5__mixer_token_mlp__prompt_kernel_ret_51
parallel_sum__ssm_conv_s5__mixer_token_mlp__prompt_kernel_ch3_46:
    s_mul_i32 s12, s64, 36
    s_add_u32 s12, s12, s63
    s_lshl_b32 s12, s12, 13
    s_add_u32 s13, s12, 4096
    v_xor_b32 v248, 32, v13
    v_xor_b32 v249, 128, v13
    v_xor_b32 v250, 160, v13
    v_cvt_pk_bf16_f32 v224, v128, v136
    v_cvt_pk_bf16_f32 v225, v144, v152
    v_cvt_pk_bf16_f32 v226, v160, v168
    v_cvt_pk_bf16_f32 v227, v176, v184
    buffer_store_dwordx4 v[224:227], v13, s[56:59], s12 offen offset:0 sc1
    v_cvt_pk_bf16_f32 v228, -v132, -v140
    v_cvt_pk_bf16_f32 v229, -v148, -v156
    v_cvt_pk_bf16_f32 v230, -v164, -v172
    v_cvt_pk_bf16_f32 v231, -v180, -v188
    buffer_store_dwordx4 v[228:231], v249, s[56:59], s13 offen offset:0 sc1
    v_cvt_pk_bf16_f32 v232, v129, v137
    v_cvt_pk_bf16_f32 v233, v145, v153
    v_cvt_pk_bf16_f32 v234, v161, v169
    v_cvt_pk_bf16_f32 v235, v177, v185
    buffer_store_dwordx4 v[232:235], v248, s[56:59], s12 offen offset:1024 sc1
    v_cvt_pk_bf16_f32 v236, -v133, -v141
    v_cvt_pk_bf16_f32 v237, -v149, -v157
    v_cvt_pk_bf16_f32 v238, -v165, -v173
    v_cvt_pk_bf16_f32 v239, -v181, -v189
    buffer_store_dwordx4 v[236:239], v250, s[56:59], s13 offen offset:1024 sc1
    v_cvt_pk_bf16_f32 v224, v130, v138
    v_cvt_pk_bf16_f32 v225, v146, v154
    v_cvt_pk_bf16_f32 v226, v162, v170
    v_cvt_pk_bf16_f32 v227, v178, v186
    buffer_store_dwordx4 v[224:227], v13, s[56:59], s12 offen offset:2048 sc1
    v_cvt_pk_bf16_f32 v228, -v134, -v142
    v_cvt_pk_bf16_f32 v229, -v150, -v158
    v_cvt_pk_bf16_f32 v230, -v166, -v174
    v_cvt_pk_bf16_f32 v231, -v182, -v190
    buffer_store_dwordx4 v[228:231], v249, s[56:59], s13 offen offset:2048 sc1
    v_cvt_pk_bf16_f32 v232, v131, v139
    v_cvt_pk_bf16_f32 v233, v147, v155
    v_cvt_pk_bf16_f32 v234, v163, v171
    v_cvt_pk_bf16_f32 v235, v179, v187
    buffer_store_dwordx4 v[232:235], v248, s[56:59], s12 offen offset:3072 sc1
    v_cvt_pk_bf16_f32 v236, -v135, -v143
    v_cvt_pk_bf16_f32 v237, -v151, -v159
    v_cvt_pk_bf16_f32 v238, -v167, -v175
    v_cvt_pk_bf16_f32 v239, -v183, -v191
    buffer_store_dwordx4 v[236:239], v250, s[56:59], s13 offen offset:3072 sc1
    s_mov_b32 s61, 4
    s_branch parallel_sum__ssm_conv_s5__mixer_token_mlp__prompt_kernel_ret_51
parallel_sum__ssm_conv_s5__mixer_token_mlp__prompt_kernel_ch4_47:
    s_mul_i32 s12, s64, 9
    s_lshr_b32 s13, s63, 2
    s_add_u32 s12, s12, s13
    s_lshl_b32 s12, s12, 5
    s_add_u32 s12, s12, s3
    s_lshl_b32 s12, s12, 2
    s_add_u32 s12, s12, 32768
    v_mov_b32 v248, 0
    v_mov_b32 v249, 1
    s_waitcnt vmcnt(0)
    s_mov_b64 exec, 1
    buffer_store_dword v249, v248, s[68:71], s12 offen sc1
    s_mov_b64 exec, -1
    s_mov_b32 s61, 99
parallel_sum__ssm_conv_s5__mixer_token_mlp__prompt_kernel_ret_51:
    s_bitcmp1_b32 s60, 0
    s_cbranch_scc1 parallel_sum__ssm_conv_s5__mixer_token_mlp__prompt_kernel_back1_49
    s_branch parallel_sum__ssm_conv_s5__mixer_token_mlp__prompt_kernel_back0_48
parallel_sum__ssm_conv_s5__mixer_token_mlp__prompt_kernel_g1l_7:
    s_and_b32 s6, s51, 1
    s_mul_i32 s6, s6, 3
    s_add_u32 s6, s6, s66
    s_sub_u32 s6, s6, 18
    s_add_u32 s7, s66, 12
    s_cmp_ge_u32 s66, 18
    s_cselect_b32 s5, s6, s7
    s_mul_i32 s6, s5, 43
    s_lshr_b32 s6, s6, 8
    s_mul_i32 s7, s6, 6
    s_sub_u32 s7, s5, s7
    s_mov_b32 s5, 0x43201
    s_cmp_eq_u32 s51, 1
    s_cselect_b32 s5, 0x87650, s5
    s_cmp_eq_u32 s51, 2
    s_cselect_b32 s5, 0x32140, s5
    s_cmp_eq_u32 s51, 3
    s_cselect_b32 s5, 0x76584, s5
    s_cmp_eq_u32 s51, 4
    s_cselect_b32 s5, 0x42103, s5
    s_cmp_eq_u32 s51, 5
    s_cselect_b32 s5, 0x86570, s5
    s_cmp_eq_u32 s51, 6
    s_cselect_b32 s5, 0x43102, s5
    s_cmp_eq_u32 s51, 7
    s_cselect_b32 s5, 0x87560, s5
    s_lshl_b32 s6, s6, 2
    s_lshr_b32 s6, s5, s6
    s_and_b32 s6, s6, 15
    s_lshr_b32 s5, s51, 1
    s_mul_i32 s5, s5, 9
    s_add_u32 s6, s6, s5
    v_lshrrev_b32 v8, 3, v2
    v_mul_u32_u24 v8, 9216, v8
    v_and_b32 v14, 7, v2
    v_lshlrev_b32 v15, 1, v4
    v_xor_b32 v14, v14, v15
    v_lshl_add_u32 v8, v14, 4, v8
    v_add_u32 v9, 72704, v8
    v_add_u32 v10, 145408, v8
    v_add_u32 v11, 218112, v8
    v_lshlrev_b32 v12, 4, v2
    v_add_u32 v13, 4096, v12
    s_mul_i32 s12, s8, 294912
    s_lshl_b32 s13, s6, 8
    s_add_u32 s12, s12, s13
    s_mul_i32 s14, s8, 36
    s_mul_i32 s15, s7, 6
    s_add_u32 s14, s14, s15
    s_lshl_b32 s14, s14, 10
    s_mov_b32 s52, s36
    s_mov_b32 s53, s37
    s_mov_b32 s54, 0x1200000
    s_mov_b32 s55, 0x00020000
    s_mov_b32 s56, s48
    s_mov_b32 s57, s49
    s_mov_b32 s58, 0x240000
    s_mov_b32 s59, 0x00020000
    s_mul_i32 s10, s8, 6
    s_mul_i32 s90, s67, 3
    s_add_u32 s10, s10, s90
    s_lshl_b32 s10, s10, 10
    s_add_u32 s10, s10, 65536
    s_lshl_b32 s90, s90, 10
    s_add_u32 s14, s14, s90
    s_lshl_b32 s89, s67, 7
    s_add_u32 s12, s12, s89
    s_add_u32 m0, s9, 16384
    s_nop 0
    buffer_load_dwordx4 v8, s[52:55], s12 offen offset:0 lds
    buffer_load_dwordx4 v9, s[52:55], s12 offen offset:1024 lds
    buffer_load_dwordx4 v10, s[52:55], s12 offen offset:2048 lds
    buffer_load_dwordx4 v11, s[52:55], s12 offen offset:3072 lds
    s_add_u32 s12, s12, 589824
    v_mov_b32 v24, 144896
    s_cmp_lg_u32 s3, 4
    s_cbranch_scc1 parallel_sum__ssm_conv_s5__mixer_token_mlp__prompt_kernel_wps_57
    s_mov_b32 s88, 0
parallel_sum__ssm_conv_s5__mixer_token_mlp__prompt_kernel_il_58:
    v_readfirstlane_b32 s89, v30
    s_cmp_ge_u32 s89, 8
    s_cbranch_scc1 parallel_sum__ssm_conv_s5__mixer_token_mlp__prompt_kernel_ie_59
    s_add_u32 s88, s88, 1
    s_cmp_ge_u32 s88, 0x8000
    s_cbranch_scc1 parallel_sum__ssm_conv_s5__mixer_token_mlp__prompt_kernel_ie_59
    s_mov_b32 s68, s46
    s_mov_b32 s69, s47
    s_mov_b32 s70, 0x100
    s_mov_b32 s71, 0x00020000
    v_mov_b32 v31, 128
    buffer_load_dword v30, v31, s[68:71], 0 offen sc1
    s_waitcnt vmcnt(0)
    s_branch parallel_sum__ssm_conv_s5__mixer_token_mlp__prompt_kernel_il_58
parallel_sum__ssm_conv_s5__mixer_token_mlp__prompt_kernel_ie_59:
    s_add_u32 s68, s48, 0x1500000
    s_addc_u32 s69, s49, 0
    s_mov_b32 s70, 0x16c00
    s_mov_b32 s71, 0x00020000
    v_lshlrev_b32 v20, 7, v2
    s_mov_b32 s89, 78848
    s_mov_b64 s[72:73], -1
    s_mov_b32 s88, 0
parallel_sum__ssm_conv_s5__mixer_token_mlp__prompt_kernel_poll_60:
    buffer_load_dword v22, v20, s[68:71], s89 offen offset:0 sc1
parallel_sum__ssm_conv_s5__mixer_token_mlp__prompt_kernel_pollck_62:
    s_waitcnt vmcnt(0)
    s_add_u32 s88, s88, 1
    s_mov_b64 s[78:79], 0
    v_cmp_gt_u32 vcc, 1, v22
    s_and_b64 vcc, vcc, s[72:73]
    s_or_b64 s[78:79], s[78:79], vcc
    s_cbranch_scc0 parallel_sum__ssm_conv_s5__mixer_token_mlp__prompt_kernel_pollend_61
    s_sleep 6
    s_cmp_lt_u32 s88, 0x8000
    s_cbranch_scc1 parallel_sum__ssm_conv_s5__mixer_token_mlp__prompt_kernel_poll_60
parallel_sum__ssm_conv_s5__mixer_token_mlp__prompt_kernel_pollend_61:
    v_mov_b32 v25, 1
    ds_write_b32 v24, v25 offset:0
    s_branch parallel_sum__ssm_conv_s5__mixer_token_mlp__prompt_kernel_wpe_56
parallel_sum__ssm_conv_s5__mixer_token_mlp__prompt_kernel_wpo_55:
    s_sleep 1
parallel_sum__ssm_conv_s5__mixer_token_mlp__prompt_kernel_wps_57:
    ds_read_b32 v25, v24 offset:0
    s_waitcnt lgkmcnt(0)
    v_readfirstlane_b32 s88, v25
    s_cmp_eq_u32 s88, 1
    s_cbranch_scc0 parallel_sum__ssm_conv_s5__mixer_token_mlp__prompt_kernel_wpo_55
parallel_sum__ssm_conv_s5__mixer_token_mlp__prompt_kernel_wpe_56:
    s_add_u32 m0, s10, 18432
    s_nop 0
    buffer_load_dwordx4 v12, s[56:59], s14 offen offset:0 sc1 lds
    buffer_load_dwordx4 v12, s[56:59], s14 offen offset:1024 sc1 lds
    buffer_load_dwordx4 v12, s[56:59], s14 offen offset:2048 sc1 lds
    s_add_u32 s14, s14, 73728
    s_add_u32 m0, s9, 32768
    s_nop 0
    buffer_load_dwordx4 v8, s[52:55], s12 offen offset:0 lds
    buffer_load_dwordx4 v9, s[52:55], s12 offen offset:1024 lds
    buffer_load_dwordx4 v10, s[52:55], s12 offen offset:2048 lds
    buffer_load_dwordx4 v11, s[52:55], s12 offen offset:3072 lds
    s_add_u32 s12, s12, 589824
    s_add_u32 m0, s10, 36864
    s_nop 0
    buffer_load_dwordx4 v12, s[56:59], s14 offen offset:0 sc1 lds
    buffer_load_dwordx4 v12, s[56:59], s14 offen offset:1024 sc1 lds
    buffer_load_dwordx4 v12, s[56:59], s14 offen offset:2048 sc1 lds
    s_add_u32 s14, s14, 73728
    s_waitcnt vmcnt(7)
    s_barrier
    s_add_u32 m0, s9, 49152
    s_nop 0
    buffer_load_dwordx4 v8, s[52:55], s12 offen offset:0 lds
    buffer_load_dwordx4 v9, s[52:55], s12 offen offset:1024 lds
    buffer_load_dwordx4 v10, s[52:55], s12 offen offset:2048 lds
    buffer_load_dwordx4 v11, s[52:55], s12 offen offset:3072 lds
    s_add_u32 s12, s12, 589824
    s_add_u32 m0, s10, 55296
    s_nop 0
    buffer_load_dwordx4 v12, s[56:59], s14 offen offset:0 sc1 lds
    buffer_load_dwordx4 v12, s[56:59], s14 offen offset:1024 sc1 lds
    buffer_load_dwordx4 v12, s[56:59], s14 offen offset:2048 sc1 lds
    s_add_u32 s14, s14, 73728
    s_add_u32 m0, s9, 0
    s_nop 0
    buffer_load_dwordx4 v8, s[52:55], s12 offen offset:0 lds
    buffer_load_dwordx4 v9, s[52:55], s12 offen offset:1024 lds
    buffer_load_dwordx4 v10, s[52:55], s12 offen offset:2048 lds
    buffer_load_dwordx4 v11, s[52:55], s12 offen offset:3072 lds
    s_add_u32 s12, s12, 589824
    s_add_u32 m0, s10, 0
    s_nop 0
    buffer_load_dwordx4 v12, s[56:59], s14 offen offset:0 sc1 lds
    buffer_load_dwordx4 v12, s[56:59], s14 offen offset:1024 sc1 lds
    buffer_load_dwordx4 v12, s[56:59], s14 offen offset:2048 sc1 lds
    s_add_u32 s14, s14, 73728
    s_mov_b32 s91, 0
parallel_sum__ssm_conv_s5__mixer_token_mlp__prompt_kernel_lloop_63:
    s_waitcnt vmcnt(14)
    s_barrier
    s_add_u32 m0, s9, 16384
    s_nop 0
    buffer_load_dwordx4 v8, s[52:55], s12 offen offset:0 lds
    buffer_load_dwordx4 v9, s[52:55], s12 offen offset:1024 lds
    buffer_load_dwordx4 v10, s[52:55], s12 offen offset:2048 lds
    buffer_load_dwordx4 v11, s[52:55], s12 offen offset:3072 lds
    s_add_u32 s12, s12, 589824
    s_add_u32 m0, s10, 18432
    s_nop 0
    buffer_load_dwordx4 v12, s[56:59], s14 offen offset:0 sc1 lds
    buffer_load_dwordx4 v12, s[56:59], s14 offen offset:1024 sc1 lds
    buffer_load_dwordx4 v12, s[56:59], s14 offen offset:2048 sc1 lds
    s_add_u32 s14, s14, 73728
    s_waitcnt vmcnt(14)
    s_barrier
    s_add_u32 m0, s9, 32768
    s_nop 0
    buffer_load_dwordx4 v8, s[52:55], s12 offen offset:0 lds
    buffer_load_dwordx4 v9, s[52:55], s12 offen offset:1024 lds
    buffer_load_dwordx4 v10, s[52:55], s12 offen offset:2048 lds
    buffer_load_dwordx4 v11, s[52:55], s12 offen offset:3072 lds
    s_add_u32 s12, s12, 589824
    s_add_u32 m0, s10, 36864
    s_nop 0
    buffer_load_dwordx4 v12, s[56:59], s14 offen offset:0 sc1 lds
    buffer_load_dwordx4 v12, s[56:59], s14 offen offset:1024 sc1 lds
    buffer_load_dwordx4 v12, s[56:59], s14 offen offset:2048 sc1 lds
    s_add_u32 s14, s14, 73728
    s_waitcnt vmcnt(14)
    s_barrier
    s_add_u32 m0, s9, 49152
    s_nop 0
    buffer_load_dwordx4 v8, s[52:55], s12 offen offset:0 lds
    buffer_load_dwordx4 v9, s[52:55], s12 offen offset:1024 lds
    buffer_load_dwordx4 v10, s[52:55], s12 offen offset:2048 lds
    buffer_load_dwordx4 v11, s[52:55], s12 offen offset:3072 lds
    s_add_u32 s12, s12, 589824
    s_add_u32 m0, s10, 55296
    s_nop 0
    buffer_load_dwordx4 v12, s[56:59], s14 offen offset:0 sc1 lds
    buffer_load_dwordx4 v12, s[56:59], s14 offen offset:1024 sc1 lds
    buffer_load_dwordx4 v12, s[56:59], s14 offen offset:2048 sc1 lds
    s_add_u32 s14, s14, 73728
    s_waitcnt vmcnt(14)
    s_barrier
    s_add_u32 m0, s9, 0
    s_nop 0
    buffer_load_dwordx4 v8, s[52:55], s12 offen offset:0 lds
    buffer_load_dwordx4 v9, s[52:55], s12 offen offset:1024 lds
    buffer_load_dwordx4 v10, s[52:55], s12 offen offset:2048 lds
    buffer_load_dwordx4 v11, s[52:55], s12 offen offset:3072 lds
    s_add_u32 s12, s12, 589824
    s_add_u32 m0, s10, 0
    s_nop 0
    buffer_load_dwordx4 v12, s[56:59], s14 offen offset:0 sc1 lds
    buffer_load_dwordx4 v12, s[56:59], s14 offen offset:1024 sc1 lds
    buffer_load_dwordx4 v12, s[56:59], s14 offen offset:2048 sc1 lds
    s_add_u32 s14, s14, 73728
    s_add_u32 s91, s91, 1
    s_cmp_lt_u32 s91, 6
    s_cbranch_scc1 parallel_sum__ssm_conv_s5__mixer_token_mlp__prompt_kernel_lloop_63
    s_waitcnt vmcnt(14)
    s_barrier
    s_add_u32 m0, s9, 16384
    s_nop 0
    buffer_load_dwordx4 v8, s[52:55], s12 offen offset:0 lds
    buffer_load_dwordx4 v9, s[52:55], s12 offen offset:1024 lds
    buffer_load_dwordx4 v10, s[52:55], s12 offen offset:2048 lds
    buffer_load_dwordx4 v11, s[52:55], s12 offen offset:3072 lds
    s_add_u32 s12, s12, 589824
    s_add_u32 m0, s10, 18432
    s_nop 0
    buffer_load_dwordx4 v12, s[56:59], s14 offen offset:0 sc1 lds
    buffer_load_dwordx4 v12, s[56:59], s14 offen offset:1024 sc1 lds
    buffer_load_dwordx4 v12, s[56:59], s14 offen offset:2048 sc1 lds
    s_add_u32 s14, s14, 73728
    s_waitcnt vmcnt(14)
    s_barrier
    s_and_b32 s5, s2, 1
    s_lshl_b32 s5, s5, 3
    s_lshr_b32 s6, s2, 5
    s_lshl_b32 s6, s6, 2
    s_lshr_b32 s6, 0x71543260, s6
    s_and_b32 s6, s6, 7
    s_add_u32 s5, s5, s6
    s_bfe_u32 s6, s2, 0x20003
    s_bfe_u32 s7, s2, 0x20001
    s_lshl_b32 s11, s5, 2
    s_add_u32 s11, s11, s6
    s_add_u32 s68, s48, 0x1500000
    s_addc_u32 s69, s49, 0
    s_mov_b32 s70, 0x16c00
    s_mov_b32 s71, 0x00020000
    s_mul_i32 s80, s7, 10
    v_add_u32 v19, s80, v2
    v_lshrrev_b32 v18, 2, v19
    v_and_b32 v19, 3, v19
    v_lshlrev_b32 v19, 2, v19
    v_lshl_add_u32 v19, v18, 7, v19
    v_min_u32 v19, 1148, v19
    v_min_u32 v18, 8, v2
    v_lshlrev_b32 v18, 7, v18
    v_lshrrev_b32 v20, 2, v2
    v_min_u32 v20, 8, v20
    v_mul_u32_u24 v20, 768, v20
    v_and_b32 v21, 3, v2
    v_lshl_add_u32 v20, v21, 2, v20
    s_mul_i32 s86, s5, 1152
    s_add_u32 s86, s86, 32768
    s_cmp_eq_u32 s7, 3
    s_cselect_b32 s72, 0x3f, 0x3ff
    s_mov_b32 s73, 0
    s_mul_i32 s87, s6, 1152
    s_add_u32 s87, s87, 88064
    s_mov_b64 s[74:75], 0x1ff
    buffer_load_dword v22, v19, s[68:71], s86 offen sc1
    buffer_load_dword v23, v18, s[68:71], s87 offen sc1
    s_add_u32 m0, s9, 32768
    s_nop 0
    buffer_load_dwordx4 v8, s[52:55], s12 offen offset:0 lds
    buffer_load_dwordx4 v9, s[52:55], s12 offen offset:1024 lds
    buffer_load_dwordx4 v10, s[52:55], s12 offen offset:2048 lds
    buffer_load_dwordx4 v11, s[52:55], s12 offen offset:3072 lds
    s_add_u32 s12, s12, 589824
    s_add_u32 m0, s10, 36864
    s_nop 0
    buffer_load_dwordx4 v12, s[56:59], s14 offen offset:0 sc1 lds
    buffer_load_dwordx4 v12, s[56:59], s14 offen offset:1024 sc1 lds
    buffer_load_dwordx4 v12, s[56:59], s14 offen offset:2048 sc1 lds
    s_add_u32 s14, s14, 73728
    s_waitcnt vmcnt(14)
    s_barrier
    s_add_u32 m0, s9, 49152
    s_nop 0
    buffer_load_dwordx4 v8, s[52:55], s12 offen offset:0 lds
    buffer_load_dwordx4 v9, s[52:55], s12 offen offset:1024 lds
    buffer_load_dwordx4 v10, s[52:55], s12 offen offset:2048 lds
    buffer_load_dwordx4 v11, s[52:55], s12 offen offset:3072 lds
    s_add_u32 s12, s12, 589824
    s_add_u32 m0, s10, 55296
    s_nop 0
    buffer_load_dwordx4 v12, s[56:59], s14 offen offset:0 sc1 lds
    buffer_load_dwordx4 v12, s[56:59], s14 offen offset:1024 sc1 lds
    buffer_load_dwordx4 v12, s[56:59], s14 offen offset:2048 sc1 lds
    s_add_u32 s14, s14, 73728
    s_waitcnt vmcnt(14)
    s_barrier
    s_add_u32 m0, s9, 0
    s_nop 0
    buffer_load_dwordx4 v8, s[52:55], s12 offen offset:0 lds
    buffer_load_dwordx4 v9, s[52:55], s12 offen offset:1024 lds
    buffer_load_dwordx4 v10, s[52:55], s12 offen offset:2048 lds
    buffer_load_dwordx4 v11, s[52:55], s12 offen offset:3072 lds
    s_add_u32 s12, s12, 589824
    s_add_u32 m0, s10, 0
    s_nop 0
    buffer_load_dwordx4 v12, s[56:59], s14 offen offset:0 sc1 lds
    buffer_load_dwordx4 v12, s[56:59], s14 offen offset:1024 sc1 lds
    buffer_load_dwordx4 v12, s[56:59], s14 offen offset:2048 sc1 lds
    s_add_u32 s14, s14, 73728
    s_add_u32 s60, s48, 0x280000
    s_addc_u32 s61, s49, 0
    s_mov_b32 s62, 0x480000
    s_mov_b32 s63, 0x00020000
    s_add_u32 s62, s5, 1
    s_mul_i32 s62, s62, 294912
    s_add_u32 s56, s48, 0x700000
    s_addc_u32 s57, s49, 0
    s_mov_b32 s58, 0x654000
    s_mov_b32 s59, 0x00020000
    s_mov_b32 s52, s40
    s_mov_b32 s53, s41
    s_mov_b32 s54, 0x1200000
    s_mov_b32 s55, 0x00020000
    s_mul_i32 s15, s6, 9
    s_add_u32 s81, s80, s8
    s_add_u32 s82, s81, 144
    s_mul_i32 s82, s82, 36
    s_add_u32 s82, s82, s15
    s_lshl_b32 s82, s82, 10
    s_mul_i32 s13, s5, 36
    s_add_u32 s81, s81, s13
    s_lshl_b32 s81, s81, 13
    s_mul_i32 s12, s7, 1152
    s_lshl_b32 s13, s8, 5
    s_add_u32 s12, s12, s13
    s_lshl_b32 s12, s12, 12
    s_lshl_b32 s13, s5, 8
    s_add_u32 s12, s12, s13
    s_mul_i32 s80, s7, 36
    s_add_u32 s14, s80, s8
    s_mul_i32 s14, s14, 36
    s_add_u32 s14, s14, s15
    s_lshl_b32 s14, s14, 10
    s_mul_i32 s83, s6, 3
    s_lshr_b32 s83, s83, 1
    s_mul_i32 s13, s7, 54
    s_add_u32 s83, s83, s13
    s_lshl_b32 s83, s83, 7
    s_add_u32 s83, s83, 51200
    s_mov_b64 s[84:85], 0
    v_lshrrev_b32 v8, 3, v2
    v_mul_u32_u24 v8, 4096, v8
    v_and_b32 v14, 7, v2
    v_lshlrev_b32 v15, 1, v4
    v_xor_b32 v14, v14, v15
    v_lshl_add_u32 v8, v14, 4, v8
    v_add_u32 v9, 31744, v8
    v_add_u32 v10, 63488, v8
    v_add_u32 v11, 95232, v8
    s_mul_i32 s10, s8, 9
    s_mul_i32 s90, s67, 5
    s_add_u32 s10, s10, s90
    s_lshl_b32 s10, s10, 10
    s_add_u32 s10, s10, 65536
    s_lshl_b32 s90, s90, 10
    s_add_u32 s82, s82, s90
    s_lshl_b32 s89, s67, 12
    s_add_u32 s81, s81, s89
    s_add_u32 s14, s14, s90
    s_lshl_b32 s89, s67, 7
    s_add_u32 s12, s12, s89
    v_mov_b32 v26, 0
    v_mov_b32 v27, 0
    s_waitcnt vmcnt(14)
    s_barrier
    s_mov_b32 s88, 0
    s_branch parallel_sum__ssm_conv_s5__mixer_token_mlp__prompt_kernel_pollck_66
parallel_sum__ssm_conv_s5__mixer_token_mlp__prompt_kernel_poll_64:
    buffer_load_dword v22, v19, s[68:71], s86 offen offset:0 sc1
    buffer_load_dword v23, v18, s[68:71], s87 offen offset:0 sc1
    s_waitcnt vmcnt(0)
parallel_sum__ssm_conv_s5__mixer_token_mlp__prompt_kernel_pollck_66:
    s_add_u32 s88, s88, 1
    s_mov_b64 s[78:79], 0
    v_cmp_gt_u32 vcc, 1, v22
    s_and_b64 vcc, vcc, s[72:73]
    s_or_b64 s[78:79], s[78:79], vcc
    v_cmp_gt_u32 vcc, 1, v23
    s_and_b64 vcc, vcc, s[74:75]
    s_or_b64 s[78:79], s[78:79], vcc
    s_cbranch_scc0 parallel_sum__ssm_conv_s5__mixer_token_mlp__prompt_kernel_pollend_65
    s_sleep 6
    s_cmp_lt_u32 s88, 0x8000
    s_cbranch_scc1 parallel_sum__ssm_conv_s5__mixer_token_mlp__prompt_kernel_poll_64
parallel_sum__ssm_conv_s5__mixer_token_mlp__prompt_kernel_pollend_65:
    s_mov_b32 s74, -1
    s_mov_b32 s75, 15
    s_mov_b32 s86, s8
    s_add_u32 m0, s9, 16384
    s_nop 0
    buffer_load_dwordx4 v12, s[60:63], s81 offen offset:0 sc1 lds
    buffer_load_dwordx4 v12, s[60:63], s81 offen offset:1024 sc1 lds
    buffer_load_dwordx4 v12, s[60:63], s81 offen offset:2048 sc1 lds
    buffer_load_dwordx4 v12, s[60:63], s81 offen offset:3072 sc1 lds
    s_add_u32 s81, s81, 16384
    s_cmp_lg_u32 s67, 0
    s_cbranch_scc1 parallel_sum__ssm_conv_s5__mixer_token_mlp__prompt_kernel_x_67
    s_add_u32 m0, s10, 22528
    s_nop 0
    buffer_load_dwordx4 v13, s[56:59], s82 offen sc1 lds
parallel_sum__ssm_conv_s5__mixer_token_mlp__prompt_kernel_x_67:
    s_add_u32 m0, s10, 18432
    s_nop 0
    buffer_load_dwordx4 v12, s[56:59], s82 offen offset:0 sc1 lds
    buffer_load_dwordx4 v12, s[56:59], s82 offen offset:1024 sc1 lds
    buffer_load_dwordx4 v12, s[56:59], s82 offen offset:2048 sc1 lds
    buffer_load_dwordx4 v12, s[56:59], s82 offen offset:3072 sc1 lds
    s_add_u32 s82, s82, 73728
    s_waitcnt vmcnt(15)
    s_barrier
    s_add_u32 m0, s9, 32768
    s_nop 0
    buffer_load_dwordx4 v12, s[60:63], s81 offen offset:0 sc1 lds
    buffer_load_dwordx4 v12, s[60:63], s81 offen offset:1024 sc1 lds
    buffer_load_dwordx4 v12, s[60:63], s81 offen offset:2048 sc1 lds
    buffer_load_dwordx4 v12, s[60:63], s81 offen offset:3072 sc1 lds
    s_add_u32 s81, s81, 16384
    s_cmp_lg_u32 s67, 0
    s_cbranch_scc1 parallel_sum__ssm_conv_s5__mixer_token_mlp__prompt_kernel_x_68
    s_add_u32 m0, s10, 40960
    s_nop 0
    buffer_load_dwordx4 v13, s[56:59], s82 offen sc1 lds
parallel_sum__ssm_conv_s5__mixer_token_mlp__prompt_kernel_x_68:
    s_add_u32 m0, s10, 36864
    s_nop 0
    buffer_load_dwordx4 v12, s[56:59], s82 offen offset:0 sc1 lds
    buffer_load_dwordx4 v12, s[56:59], s82 offen offset:1024 sc1 lds
    buffer_load_dwordx4 v12, s[56:59], s82 offen offset:2048 sc1 lds
    buffer_load_dwordx4 v12, s[56:59], s82 offen offset:3072 sc1 lds
    s_add_u32 s82, s82, 73728
    s_waitcnt vmcnt(16)
    s_barrier
    s_add_u32 m0, s9, 49152
    s_nop 0
    buffer_load_dwordx4 v12, s[60:63], s81 offen offset:0 sc1 lds
    buffer_load_dwordx4 v12, s[60:63], s81 offen offset:1024 sc1 lds
    buffer_load_dwordx4 v12, s[60:63], s81 offen offset:2048 sc1 lds
    buffer_load_dwordx4 v12, s[60:63], s81 offen offset:3072 sc1 lds
    s_add_u32 s81, s81, 16384
    s_cmp_lg_u32 s67, 0
    s_cbranch_scc1 parallel_sum__ssm_conv_s5__mixer_token_mlp__prompt_kernel_x_69
    s_add_u32 m0, s10, 59392
    s_nop 0
    buffer_load_dwordx4 v13, s[56:59], s82 offen sc1 lds
parallel_sum__ssm_conv_s5__mixer_token_mlp__prompt_kernel_x_69:
    s_add_u32 m0, s10, 55296
    s_nop 0
    buffer_load_dwordx4 v12, s[56:59], s82 offen offset:0 sc1 lds
    buffer_load_dwordx4 v12, s[56:59], s82 offen offset:1024 sc1 lds
    buffer_load_dwordx4 v12, s[56:59], s82 offen offset:2048 sc1 lds
    buffer_load_dwordx4 v12, s[56:59], s82 offen offset:3072 sc1 lds
    s_add_u32 s82, s82, 73728
    s_branch parallel_sum__ssm_conv_s5__mixer_token_mlp__prompt_kernel_hl_9
parallel_sum__ssm_conv_s5__mixer_token_mlp__prompt_kernel_pk_4:
    s_cmp_lg_u32 s66, 31
    s_cbranch_scc1 parallel_sum__ssm_conv_s5__mixer_token_mlp__prompt_kernel_ncw_70
    s_getpc_b64 s[10:11]
parallel_sum__ssm_conv_s5__mixer_token_mlp__prompt_kernel_pc_71:
    s_sub_u32 s10, s10, parallel_sum__ssm_conv_s5__mixer_token_mlp__prompt_kernel_pc_71-parallel_sum__ssm_conv_s5__mixer_token_mlp__prompt_kernel
    s_subb_u32 s11, s11, 0
    s_lshl_b32 s13, s3, 13
    v_lshlrev_b32 v8, 7, v2
    v_add_u32 v8, s13, v8
    v_min_u32 v8, code_end-parallel_sum__ssm_conv_s5__mixer_token_mlp__prompt_kernel-4, v8
    v_mov_b32 v9, s11
    v_add_co_u32 v8, vcc, s10, v8
    s_nop 1
    v_addc_co_u32 v9, vcc, 0, v9, vcc
    global_load_dword v1, v[8:9], off
parallel_sum__ssm_conv_s5__mixer_token_mlp__prompt_kernel_ncw_70:
    s_mov_b32 s50, 2
    s_sub_u32 s12, s66, 27
    s_lshl_b32 s12, s12, 3
    s_add_u32 s12, s12, s51
    s_and_b32 s87, s3, 3
    v_lshlrev_b32 v44, 4, v2
    s_waitcnt lgkmcnt(0)
    s_barrier
    s_cmp_ge_u32 s3, 4
    s_cbranch_scc1 parallel_sum__ssm_conv_s5__mixer_token_mlp__prompt_kernel_tch_72
    s_setprio 2
    s_add_u32 s60, s48, 0x1500000
    s_addc_u32 s61, s49, 0
    s_mov_b32 s62, 0x16c00
    s_mov_b32 s63, 0x00020000
    s_lshl_b32 s14, s12, 7
    s_add_u32 s14, s14, 88064
    s_cmp_ge_u32 s12, 36
    s_cbranch_scc1 parallel_sum__ssm_conv_s5__mixer_token_mlp__prompt_kernel_pdone_73
    s_mul_i32 s9, s3, 12288
    s_mul_i32 s10, s12, 18432
    s_mov_b32 s72, s26
    s_mov_b32 s73, s27
    s_mov_b32 s74, 0xa2000
    s_mov_b32 s75, 0x00020000
    s_mov_b32 s76, s28
    s_mov_b32 s77, s29
    s_mov_b32 s78, 0xa2000
    s_mov_b32 s79, 0x00020000
    s_mul_i32 s11, s87, 288
    s_add_u32 s10, s10, s11
    v_add_u32 v46, 0, v2
    v_mul_u32_u24 v47, 3641, v46
    v_lshrrev_b32 v47, 16, v47
    v_mul_u32_u24 v48, 864, v47
    v_lshl_add_u32 v50, v46, 4, v48
    s_add_u32 m0, s9, 0
    s_nop 0
    buffer_load_dwordx4 v50, s[72:75], s10 offen lds
    s_add_u32 m0, s9, 5120
    s_nop 0
    buffer_load_dwordx4 v50, s[76:79], s10 offen lds
    v_add_u32 v46, 64, v2
    v_mul_u32_u24 v47, 3641, v46
    v_lshrrev_b32 v47, 16, v47
    v_mul_u32_u24 v48, 864, v47
    v_lshl_add_u32 v51, v46, 4, v48
    s_add_u32 m0, s9, 1024
    s_nop 0
    buffer_load_dwordx4 v51, s[72:75], s10 offen lds
    s_add_u32 m0, s9, 6144
    s_nop 0
    buffer_load_dwordx4 v51, s[76:79], s10 offen lds
    v_add_u32 v46, 128, v2
    v_mul_u32_u24 v47, 3641, v46
    v_lshrrev_b32 v47, 16, v47
    v_mul_u32_u24 v48, 864, v47
    v_lshl_add_u32 v52, v46, 4, v48
    s_add_u32 m0, s9, 2048
    s_nop 0
    buffer_load_dwordx4 v52, s[72:75], s10 offen lds
    s_add_u32 m0, s9, 7168
    s_nop 0
    buffer_load_dwordx4 v52, s[76:79], s10 offen lds
    v_add_u32 v46, 192, v2
    v_mul_u32_u24 v47, 3641, v46
    v_lshrrev_b32 v47, 16, v47
    v_mul_u32_u24 v48, 864, v47
    v_lshl_add_u32 v53, v46, 4, v48
    s_add_u32 m0, s9, 3072
    s_nop 0
    buffer_load_dwordx4 v53, s[72:75], s10 offen lds
    s_add_u32 m0, s9, 8192
    s_nop 0
    buffer_load_dwordx4 v53, s[76:79], s10 offen lds
    v_add_u32 v46, 256, v2
    v_mul_u32_u24 v47, 3641, v46
    v_lshrrev_b32 v47, 16, v47
    v_mul_u32_u24 v48, 864, v47
    v_lshl_add_u32 v54, v46, 4, v48
    s_add_u32 m0, s9, 4096
    s_nop 0
    buffer_load_dwordx4 v54, s[72:75], s10 offen lds
    s_add_u32 m0, s9, 9216
    s_nop 0
    buffer_load_dwordx4 v54, s[76:79], s10 offen lds
    s_add_u32 s52, s48, 0x700000
    s_addc_u32 s53, s49, 0
    s_mov_b32 s54, 0x654000
    s_mov_b32 s55, 0x00020000
    v_mul_u32_u24 v6, 288, v3
    v_lshl_add_u32 v6, v4, 3, v6
    v_add_u32 v6, s9, v6
    s_mul_i32 s71, s87, 9
    s_add_u32 s71, s71, 144
    s_mul_i32 s71, s71, 36
    s_add_u32 s71, s71, s12
    s_lshl_b32 s71, s71, 10
    s_mul_i32 s11, s87, 288
    v_lshlrev_b32 v5, 1, v2
    s_mov_b32 s72, s18
    s_mov_b32 s73, s19
    s_mov_b32 s74, 0x480
    s_mov_b32 s75, 0x00020000
    buffer_load_ushort v104, v5, s[72:75], s11 offen offset:0
    buffer_load_ushort v107, v5, s[72:75], s11 offen offset:128
    buffer_load_ushort v110, v5, s[72:75], s11 offen offset:256
    s_mov_b32 s72, s20
    s_mov_b32 s73, s21
    s_mov_b32 s74, 0x480
    s_mov_b32 s75, 0x00020000
    buffer_load_ushort v105, v5, s[72:75], s11 offen offset:0
    buffer_load_ushort v108, v5, s[72:75], s11 offen offset:128
    buffer_load_ushort v111, v5, s[72:75], s11 offen offset:256
    s_mov_b32 s72, s30
    s_mov_b32 s73, s31
    s_mov_b32 s74, 0x480
    s_mov_b32 s75, 0x00020000
    buffer_load_ushort v106, v5, s[72:75], s11 offen offset:0
    buffer_load_ushort v109, v5, s[72:75], s11 offen offset:128
    buffer_load_ushort v112, v5, s[72:75], s11 offen offset:256
    s_mov_b32 s85, 0x3fb8aa3b
    s_mov_b32 s86, 0x3e22f983
    v_lshl_add_u32 v7, v2, 3, s9
    v_lshl_add_u32 v8, v4, 5, s9
    s_waitcnt vmcnt(0)
    v_lshlrev_b32 v104, 16, v104
    v_lshlrev_b32 v105, 16, v105
    v_lshlrev_b32 v106, 16, v106
    v_mul_f32 v106, s85, v106
    v_exp_f32 v106, v106
    s_nop 0
    v_cvt_pk_bf16_f32 v106, v106, v106
    v_lshlrev_b32 v106, 16, v106
    v_mul_f32 v116, v106, v104
    v_mul_f32 v117, v106, v105
    v_mul_f32 v116, s85, v116
    v_mul_f32 v117, s86, v117
    v_fract_f32 v118, v117
    v_exp_f32 v120, v116
    v_sin_f32 v121, v118
    v_cos_f32 v118, v118
    s_nop 0
    v_mul_f32 v121, v120, v121
    v_mul_f32 v120, v120, v118
    v_add_f32 v118, -1.0, v120
    v_mul_f32 v119, v104, v104
    v_fma_f32 v119, v105, v105, v119
    v_rcp_f32 v119, v119
    v_mul_f32 v122, v118, v104
    v_fma_f32 v122, v121, v105, v122
    v_mul_f32 v123, v121, v104
    v_fma_f32 v123, -v118, v105, v123
    v_add_f32 v119, v119, v119
    v_mul_f32 v122, v122, v119
    v_mul_f32 v123, v123, v119
    ds_write_b64 v7, v[122:123] offset:10240
    v_lshlrev_b32 v107, 16, v107
    v_lshlrev_b32 v108, 16, v108
    v_lshlrev_b32 v109, 16, v109
    v_mul_f32 v109, s85, v109
    v_exp_f32 v109, v109
    s_nop 0
    v_cvt_pk_bf16_f32 v109, v109, v109
    v_lshlrev_b32 v109, 16, v109
    v_mul_f32 v116, v109, v107
    v_mul_f32 v117, v109, v108
    v_mul_f32 v116, s85, v116
    v_mul_f32 v117, s86, v117
    v_fract_f32 v118, v117
    v_exp_f32 v120, v116
    v_sin_f32 v121, v118
    v_cos_f32 v118, v118
    s_nop 0
    v_mul_f32 v121, v120, v121
    v_mul_f32 v120, v120, v118
    v_add_f32 v118, -1.0, v120
    v_mul_f32 v119, v107, v107
    v_fma_f32 v119, v108, v108, v119
    v_rcp_f32 v119, v119
    v_mul_f32 v122, v118, v107
    v_fma_f32 v122, v121, v108, v122
    v_mul_f32 v123, v121, v107
    v_fma_f32 v123, -v118, v108, v123
    v_add_f32 v119, v119, v119
    v_mul_f32 v122, v122, v119
    v_mul_f32 v123, v123, v119
    ds_write_b64 v7, v[122:123] offset:10752
    v_lshlrev_b32 v110, 16, v110
    v_lshlrev_b32 v111, 16, v111
    v_lshlrev_b32 v112, 16, v112
    v_mul_f32 v112, s85, v112
    v_exp_f32 v112, v112
    s_nop 0
    v_cvt_pk_bf16_f32 v112, v112, v112
    v_lshlrev_b32 v112, 16, v112
    v_mul_f32 v116, v112, v110
    v_mul_f32 v117, v112, v111
    v_mul_f32 v116, s85, v116
    v_mul_f32 v117, s86, v117
    v_fract_f32 v118, v117
    v_exp_f32 v120, v116
    v_sin_f32 v121, v118
    v_cos_f32 v118, v118
    s_nop 0
    v_mul_f32 v121, v120, v121
    v_mul_f32 v120, v120, v118
    v_add_f32 v118, -1.0, v120
    v_mul_f32 v119, v110, v110
    v_fma_f32 v119, v111, v111, v119
    v_rcp_f32 v119, v119
    v_mul_f32 v122, v118, v110
    v_fma_f32 v122, v121, v111, v122
    v_mul_f32 v123, v121, v110
    v_fma_f32 v123, -v118, v111, v123
    v_add_f32 v119, v119, v119
    v_mul_f32 v122, v122, v119
    v_mul_f32 v123, v123, v119
    ds_write_b64 v7, v[122:123] offset:11264
    ds_read_b64 v[64:65], v6 offset:0
    ds_read_b64 v[66:67], v6 offset:5120
    ds_read_b128 v[68:71], v8 offset:10240
    ds_read_b128 v[72:75], v8 offset:10256
    s_waitcnt lgkmcnt(0)
    v_lshlrev_b32 v76, 16, v64
    v_and_b32 v80, s4, v64
    v_lshlrev_b32 v84, 16, v65
    v_and_b32 v88, s4, v65
    v_lshlrev_b32 v77, 16, v66
    v_and_b32 v81, s4, v66
    v_lshlrev_b32 v85, 16, v67
    v_and_b32 v89, s4, v67
    v_mul_f32 v78, v76, v68
    v_mul_f32 v82, v80, v70
    v_mul_f32 v86, v84, v72
    v_mul_f32 v90, v88, v74
    v_mul_f32 v79, v76, v69
    v_mul_f32 v83, v80, v71
    v_mul_f32 v87, v84, v73
    v_mul_f32 v91, v88, v75
    v_fma_f32 v78, -v77, v69, v78
    v_fma_f32 v82, -v81, v71, v82
    v_fma_f32 v86, -v85, v73, v86
    v_fma_f32 v90, -v89, v75, v90
    v_fma_f32 v79, v77, v68, v79
    v_fma_f32 v83, v81, v70, v83
    v_fma_f32 v87, v85, v72, v87
    v_fma_f32 v91, v89, v74, v91
    v_cvt_pk_bf16_f32 v24, v78, v79
    v_cvt_pk_bf16_f32 v25, v82, v83
    v_cvt_pk_bf16_f32 v26, v86, v87
    v_cvt_pk_bf16_f32 v27, v90, v91
    buffer_store_dwordx4 v[24:27], v44, s[52:55], s71 offen sc1
    s_add_u32 s71, s71, 36864
    ds_read_b64 v[64:65], v6 offset:32
    ds_read_b64 v[66:67], v6 offset:5152
    ds_read_b128 v[68:71], v8 offset:10368
    ds_read_b128 v[72:75], v8 offset:10384
    s_waitcnt lgkmcnt(0)
    v_lshlrev_b32 v76, 16, v64
    v_and_b32 v80, s4, v64
    v_lshlrev_b32 v84, 16, v65
    v_and_b32 v88, s4, v65
    v_lshlrev_b32 v77, 16, v66
    v_and_b32 v81, s4, v66
    v_lshlrev_b32 v85, 16, v67
    v_and_b32 v89, s4, v67
    v_mul_f32 v78, v76, v68
    v_mul_f32 v82, v80, v70
    v_mul_f32 v86, v84, v72
    v_mul_f32 v90, v88, v74
    v_mul_f32 v79, v76, v69
    v_mul_f32 v83, v80, v71
    v_mul_f32 v87, v84, v73
    v_mul_f32 v91, v88, v75
    v_fma_f32 v78, -v77, v69, v78
    v_fma_f32 v82, -v81, v71, v82
    v_fma_f32 v86, -v85, v73, v86
    v_fma_f32 v90, -v89, v75, v90
    v_fma_f32 v79, v77, v68, v79
    v_fma_f32 v83, v81, v70, v83
    v_fma_f32 v87, v85, v72, v87
    v_fma_f32 v91, v89, v74, v91
    v_cvt_pk_bf16_f32 v28, v78, v79
    v_cvt_pk_bf16_f32 v29, v82, v83
    v_cvt_pk_bf16_f32 v30, v86, v87
    v_cvt_pk_bf16_f32 v31, v90, v91
    buffer_store_dwordx4 v[28:31], v44, s[52:55], s71 offen sc1
    s_add_u32 s71, s71, 36864
    ds_read_b64 v[64:65], v6 offset:64
    ds_read_b64 v[66:67], v6 offset:5184
    ds_read_b128 v[68:71], v8 offset:10496
    ds_read_b128 v[72:75], v8 offset:10512
    s_waitcnt lgkmcnt(0)
    v_lshlrev_b32 v76, 16, v64
    v_and_b32 v80, s4, v64
    v_lshlrev_b32 v84, 16, v65
    v_and_b32 v88, s4, v65
    v_lshlrev_b32 v77, 16, v66
    v_and_b32 v81, s4, v66
    v_lshlrev_b32 v85, 16, v67
    v_and_b32 v89, s4, v67
    v_mul_f32 v78, v76, v68
    v_mul_f32 v82, v80, v70
    v_mul_f32 v86, v84, v72
    v_mul_f32 v90, v88, v74
    v_mul_f32 v79, v76, v69
    v_mul_f32 v83, v80, v71
    v_mul_f32 v87, v84, v73
    v_mul_f32 v91, v88, v75
    v_fma_f32 v78, -v77, v69, v78
    v_fma_f32 v82, -v81, v71, v82
    v_fma_f32 v86, -v85, v73, v86
    v_fma_f32 v90, -v89, v75, v90
    v_fma_f32 v79, v77, v68, v79
    v_fma_f32 v83, v81, v70, v83
    v_fma_f32 v87, v85, v72, v87
    v_fma_f32 v91, v89, v74, v91
    v_cvt_pk_bf16_f32 v32, v78, v79
    v_cvt_pk_bf16_f32 v33, v82, v83
    v_cvt_pk_bf16_f32 v34, v86, v87
    v_cvt_pk_bf16_f32 v35, v90, v91
    buffer_store_dwordx4 v[32:35], v44, s[52:55], s71 offen sc1
    s_add_u32 s71, s71, 36864
    ds_read_b64 v[64:65], v6 offset:96
    ds_read_b64 v[66:67], v6 offset:5216
    ds_read_b128 v[68:71], v8 offset:10624
    ds_read_b128 v[72:75], v8 offset:10640
    s_waitcnt lgkmcnt(0)
    v_lshlrev_b32 v76, 16, v64
    v_and_b32 v80, s4, v64
    v_lshlrev_b32 v84, 16, v65
    v_and_b32 v88, s4, v65
    v_lshlrev_b32 v77, 16, v66
    v_and_b32 v81, s4, v66
    v_lshlrev_b32 v85, 16, v67
    v_and_b32 v89, s4, v67
    v_mul_f32 v78, v76, v68
    v_mul_f32 v82, v80, v70
    v_mul_f32 v86, v84, v72
    v_mul_f32 v90, v88, v74
    v_mul_f32 v79, v76, v69
    v_mul_f32 v83, v80, v71
    v_mul_f32 v87, v84, v73
    v_mul_f32 v91, v88, v75
    v_fma_f32 v78, -v77, v69, v78
    v_fma_f32 v82, -v81, v71, v82
    v_fma_f32 v86, -v85, v73, v86
    v_fma_f32 v90, -v89, v75, v90
    v_fma_f32 v79, v77, v68, v79
    v_fma_f32 v83, v81, v70, v83
    v_fma_f32 v87, v85, v72, v87
    v_fma_f32 v91, v89, v74, v91
    v_cvt_pk_bf16_f32 v24, v78, v79
    v_cvt_pk_bf16_f32 v25, v82, v83
    v_cvt_pk_bf16_f32 v26, v86, v87
    v_cvt_pk_bf16_f32 v27, v90, v91
    buffer_store_dwordx4 v[24:27], v44, s[52:55], s71 offen sc1
    s_add_u32 s71, s71, 36864
    ds_read_b64 v[64:65], v6 offset:128
    ds_read_b64 v[66:67], v6 offset:5248
    ds_read_b128 v[68:71], v8 offset:10752
    ds_read_b128 v[72:75], v8 offset:10768
    s_waitcnt lgkmcnt(0)
    v_lshlrev_b32 v76, 16, v64
    v_and_b32 v80, s4, v64
    v_lshlrev_b32 v84, 16, v65
    v_and_b32 v88, s4, v65
    v_lshlrev_b32 v77, 16, v66
    v_and_b32 v81, s4, v66
    v_lshlrev_b32 v85, 16, v67
    v_and_b32 v89, s4, v67
    v_mul_f32 v78, v76, v68
    v_mul_f32 v82, v80, v70
    v_mul_f32 v86, v84, v72
    v_mul_f32 v90, v88, v74
    v_mul_f32 v79, v76, v69
    v_mul_f32 v83, v80, v71
    v_mul_f32 v87, v84, v73
    v_mul_f32 v91, v88, v75
    v_fma_f32 v78, -v77, v69, v78
    v_fma_f32 v82, -v81, v71, v82
    v_fma_f32 v86, -v85, v73, v86
    v_fma_f32 v90, -v89, v75, v90
    v_fma_f32 v79, v77, v68, v79
    v_fma_f32 v83, v81, v70, v83
    v_fma_f32 v87, v85, v72, v87
    v_fma_f32 v91, v89, v74, v91
    v_cvt_pk_bf16_f32 v28, v78, v79
    v_cvt_pk_bf16_f32 v29, v82, v83
    v_cvt_pk_bf16_f32 v30, v86, v87
    v_cvt_pk_bf16_f32 v31, v90, v91
    buffer_store_dwordx4 v[28:31], v44, s[52:55], s71 offen sc1
    s_add_u32 s71, s71, 36864
    ds_read_b64 v[64:65], v6 offset:160
    ds_read_b64 v[66:67], v6 offset:5280
    ds_read_b128 v[68:71], v8 offset:10880
    ds_read_b128 v[72:75], v8 offset:10896
    s_waitcnt lgkmcnt(0)
    v_lshlrev_b32 v76, 16, v64
    v_and_b32 v80, s4, v64
    v_lshlrev_b32 v84, 16, v65
    v_and_b32 v88, s4, v65
    v_lshlrev_b32 v77, 16, v66
    v_and_b32 v81, s4, v66
    v_lshlrev_b32 v85, 16, v67
    v_and_b32 v89, s4, v67
    v_mul_f32 v78, v76, v68
    v_mul_f32 v82, v80, v70
    v_mul_f32 v86, v84, v72
    v_mul_f32 v90, v88, v74
    v_mul_f32 v79, v76, v69
    v_mul_f32 v83, v80, v71
    v_mul_f32 v87, v84, v73
    v_mul_f32 v91, v88, v75
    v_fma_f32 v78, -v77, v69, v78
    v_fma_f32 v82, -v81, v71, v82
    v_fma_f32 v86, -v85, v73, v86
    v_fma_f32 v90, -v89, v75, v90
    v_fma_f32 v79, v77, v68, v79
    v_fma_f32 v83, v81, v70, v83
    v_fma_f32 v87, v85, v72, v87
    v_fma_f32 v91, v89, v74, v91
    v_cvt_pk_bf16_f32 v32, v78, v79
    v_cvt_pk_bf16_f32 v33, v82, v83
    v_cvt_pk_bf16_f32 v34, v86, v87
    v_cvt_pk_bf16_f32 v35, v90, v91
    buffer_store_dwordx4 v[32:35], v44, s[52:55], s71 offen sc1
    s_add_u32 s71, s71, 36864
    ds_read_b64 v[64:65], v6 offset:192
    ds_read_b64 v[66:67], v6 offset:5312
    ds_read_b128 v[68:71], v8 offset:11008
    ds_read_b128 v[72:75], v8 offset:11024
    s_waitcnt lgkmcnt(0)
    v_lshlrev_b32 v76, 16, v64
    v_and_b32 v80, s4, v64
    v_lshlrev_b32 v84, 16, v65
    v_and_b32 v88, s4, v65
    v_lshlrev_b32 v77, 16, v66
    v_and_b32 v81, s4, v66
    v_lshlrev_b32 v85, 16, v67
    v_and_b32 v89, s4, v67
    v_mul_f32 v78, v76, v68
    v_mul_f32 v82, v80, v70
    v_mul_f32 v86, v84, v72
    v_mul_f32 v90, v88, v74
    v_mul_f32 v79, v76, v69
    v_mul_f32 v83, v80, v71
    v_mul_f32 v87, v84, v73
    v_mul_f32 v91, v88, v75
    v_fma_f32 v78, -v77, v69, v78
    v_fma_f32 v82, -v81, v71, v82
    v_fma_f32 v86, -v85, v73, v86
    v_fma_f32 v90, -v89, v75, v90
    v_fma_f32 v79, v77, v68, v79
    v_fma_f32 v83, v81, v70, v83
    v_fma_f32 v87, v85, v72, v87
    v_fma_f32 v91, v89, v74, v91
    v_cvt_pk_bf16_f32 v24, v78, v79
    v_cvt_pk_bf16_f32 v25, v82, v83
    v_cvt_pk_bf16_f32 v26, v86, v87
    v_cvt_pk_bf16_f32 v27, v90, v91
    buffer_store_dwordx4 v[24:27], v44, s[52:55], s71 offen sc1
    s_add_u32 s71, s71, 36864
    ds_read_b64 v[64:65], v6 offset:224
    ds_read_b64 v[66:67], v6 offset:5344
    ds_read_b128 v[68:71], v8 offset:11136
    ds_read_b128 v[72:75], v8 offset:11152
    s_waitcnt lgkmcnt(0)
    v_lshlrev_b32 v76, 16, v64
    v_and_b32 v80, s4, v64
    v_lshlrev_b32 v84, 16, v65
    v_and_b32 v88, s4, v65
    v_lshlrev_b32 v77, 16, v66
    v_and_b32 v81, s4, v66
    v_lshlrev_b32 v85, 16, v67
    v_and_b32 v89, s4, v67
    v_mul_f32 v78, v76, v68
    v_mul_f32 v82, v80, v70
    v_mul_f32 v86, v84, v72
    v_mul_f32 v90, v88, v74
    v_mul_f32 v79, v76, v69
    v_mul_f32 v83, v80, v71
    v_mul_f32 v87, v84, v73
    v_mul_f32 v91, v88, v75
    v_fma_f32 v78, -v77, v69, v78
    v_fma_f32 v82, -v81, v71, v82
    v_fma_f32 v86, -v85, v73, v86
    v_fma_f32 v90, -v89, v75, v90
    v_fma_f32 v79, v77, v68, v79
    v_fma_f32 v83, v81, v70, v83
    v_fma_f32 v87, v85, v72, v87
    v_fma_f32 v91, v89, v74, v91
    v_cvt_pk_bf16_f32 v28, v78, v79
    v_cvt_pk_bf16_f32 v29, v82, v83
    v_cvt_pk_bf16_f32 v30, v86, v87
    v_cvt_pk_bf16_f32 v31, v90, v91
    buffer_store_dwordx4 v[28:31], v44, s[52:55], s71 offen sc1
    s_add_u32 s71, s71, 36864
    ds_read_b64 v[64:65], v6 offset:256
    ds_read_b64 v[66:67], v6 offset:5376
    ds_read_b128 v[68:71], v8 offset:11264
    ds_read_b128 v[72:75], v8 offset:11280
    s_waitcnt lgkmcnt(0)
    v_lshlrev_b32 v76, 16, v64
    v_and_b32 v80, s4, v64
    v_lshlrev_b32 v84, 16, v65
    v_and_b32 v88, s4, v65
    v_lshlrev_b32 v77, 16, v66
    v_and_b32 v81, s4, v66
    v_lshlrev_b32 v85, 16, v67
    v_and_b32 v89, s4, v67
    v_mul_f32 v78, v76, v68
    v_mul_f32 v82, v80, v70
    v_mul_f32 v86, v84, v72
    v_mul_f32 v90, v88, v74
    v_mul_f32 v79, v76, v69
    v_mul_f32 v83, v80, v71
    v_mul_f32 v87, v84, v73
    v_mul_f32 v91, v88, v75
    v_fma_f32 v78, -v77, v69, v78
    v_fma_f32 v82, -v81, v71, v82
    v_fma_f32 v86, -v85, v73, v86
    v_fma_f32 v90, -v89, v75, v90
    v_fma_f32 v79, v77, v68, v79
    v_fma_f32 v83, v81, v70, v83
    v_fma_f32 v87, v85, v72, v87
    v_fma_f32 v91, v89, v74, v91
    v_cvt_pk_bf16_f32 v32, v78, v79
    v_cvt_pk_bf16_f32 v33, v82, v83
    v_cvt_pk_bf16_f32 v34, v86, v87
    v_cvt_pk_bf16_f32 v35, v90, v91
    buffer_store_dwordx4 v[32:35], v44, s[52:55], s71 offen sc1
    s_add_u32 s71, s71, 36864
    s_waitcnt vmcnt(0)
parallel_sum__ssm_conv_s5__mixer_token_mlp__prompt_kernel_pdone_73:
    v_mov_b32 v20, 144896
    v_mov_b32 v21, 1
    s_mov_b64 exec, 1
    ds_add_rtn_u32 v22, v20, v21 offset:12
    s_waitcnt lgkmcnt(0)
    v_readfirstlane_b32 s13, v22
    s_cmp_lg_u32 s13, 3
    s_cbranch_scc1 parallel_sum__ssm_conv_s5__mixer_token_mlp__prompt_kernel_s4_74
    v_mov_b32 v30, 0
    s_mov_b32 s88, 0
parallel_sum__ssm_conv_s5__mixer_token_mlp__prompt_kernel_il_75:
    v_readfirstlane_b32 s89, v30
    s_cmp_ge_u32 s89, 8
    s_cbranch_scc1 parallel_sum__ssm_conv_s5__mixer_token_mlp__prompt_kernel_ie_76
    s_add_u32 s88, s88, 1
    s_cmp_ge_u32 s88, 0x8000
    s_cbranch_scc1 parallel_sum__ssm_conv_s5__mixer_token_mlp__prompt_kernel_ie_76
    s_mov_b32 s68, s46
    s_mov_b32 s69, s47
    s_mov_b32 s70, 0x100
    s_mov_b32 s71, 0x00020000
    v_mov_b32 v31, 128
    buffer_load_dword v30, v31, s[68:71], 0 offen sc1
    s_waitcnt vmcnt(0)
    s_branch parallel_sum__ssm_conv_s5__mixer_token_mlp__prompt_kernel_il_75
parallel_sum__ssm_conv_s5__mixer_token_mlp__prompt_kernel_ie_76:
    v_mov_b32 v20, 0
    buffer_store_dword v21, v20, s[60:63], s14 offen sc1
parallel_sum__ssm_conv_s5__mixer_token_mlp__prompt_kernel_s4_74:
    s_mov_b64 exec, -1
    s_branch parallel_sum__ssm_conv_s5__mixer_token_mlp__prompt_kernel_pkc0_77
parallel_sum__ssm_conv_s5__mixer_token_mlp__prompt_kernel_tch_72:
    s_mov_b32 s52, s36
    s_mov_b32 s53, s37
    s_mov_b32 s54, 0x1200000
    s_mov_b32 s55, 0x00020000
    s_mov_b32 s56, s40
    s_mov_b32 s57, s41
    s_mov_b32 s58, 0x1200000
    s_mov_b32 s59, 0x00020000
    v_lshrrev_b32 v16, 1, v2
    v_mul_u32_u24 v16, 9216, v16
    v_and_b32 v17, 1, v2
    v_lshl_add_u32 v16, v17, 7, v16
    v_lshlrev_b32 v17, 12, v4
    v_lshl_add_u32 v17, v3, 7, v17
    s_mov_b32 s62, 0x43201
    s_cmp_eq_u32 s51, 1
    s_cselect_b32 s62, 0x87650, s62
    s_cmp_eq_u32 s51, 2
    s_cselect_b32 s62, 0x32140, s62
    s_cmp_eq_u32 s51, 3
    s_cselect_b32 s62, 0x76584, s62
    s_cmp_eq_u32 s51, 4
    s_cselect_b32 s62, 0x42103, s62
    s_cmp_eq_u32 s51, 5
    s_cselect_b32 s62, 0x86570, s62
    s_cmp_eq_u32 s51, 6
    s_cselect_b32 s62, 0x43102, s62
    s_cmp_eq_u32 s51, 7
    s_cselect_b32 s62, 0x87560, s62
    s_bitcmp1_b32 s51, 0
    s_cselect_b32 s60, 2048, 0
    s_lshr_b32 s63, s51, 1
    s_mul_i32 s88, s63, 4718592
    s_add_u32 s60, s60, s88
    s_mul_i32 s63, s63, 9
    s_sub_u32 s61, s66, 27
    s_lshl_b32 s61, s61, 2
    s_and_b32 s15, s3, 3
    s_add_u32 s61, s61, s15
    v_mov_b32 v22, 0
    s_mov_b32 s91, 0
parallel_sum__ssm_conv_s5__mixer_token_mlp__prompt_kernel_tl_79:
    s_cmp_ge_u32 s61, 296
    s_cselect_b32 s14, 24, 0
    s_add_u32 s14, s14, s61
    s_waitcnt vmcnt(1)
    s_cmp_ge_u32 s14, 320
    s_cbranch_scc1 parallel_sum__ssm_conv_s5__mixer_token_mlp__prompt_kernel_w2l_80
    s_mul_i32 s89, s14, 52429
    s_lshr_b32 s89, s89, 18
    s_mul_i32 s90, s89, 5
    s_sub_u32 s90, s14, s90
    s_lshl_b32 s90, s90, 2
    s_lshr_b32 s90, s62, s90
    s_and_b32 s90, s90, 15
    s_add_u32 s90, s90, s63
    s_lshl_b32 s90, s90, 8
    s_mul_i32 s88, s89, 294912
    s_add_u32 s88, s88, s90
    buffer_load_dword v1, v16, s[52:55], s88 offen
    s_branch parallel_sum__ssm_conv_s5__mixer_token_mlp__prompt_kernel_go_81
parallel_sum__ssm_conv_s5__mixer_token_mlp__prompt_kernel_w2l_80:
    s_sub_u32 s88, s14, 320
    s_min_u32 s88, s88, 287
    s_lshl_b32 s88, s88, 14
    s_add_u32 s88, s88, s60
    buffer_load_dword v1, v17, s[56:59], s88 offen
parallel_sum__ssm_conv_s5__mixer_token_mlp__prompt_kernel_go_81:
    s_add_u32 s61, s61, 20
    s_add_u32 s91, s91, 1
    s_cmp_lt_u32 s91, 10
    s_cbranch_scc1 parallel_sum__ssm_conv_s5__mixer_token_mlp__prompt_kernel_tl_79
    s_cmp_lg_u32 s3, 4
    s_cbranch_scc1 parallel_sum__ssm_conv_s5__mixer_token_mlp__prompt_kernel_w4_82
    s_mov_b32 s68, s46
    s_mov_b32 s69, s47
    s_mov_b32 s70, 0x100
    s_mov_b32 s71, 0x00020000
    v_mov_b32 v31, 128
    buffer_load_dword v30, v31, s[68:71], 0 offen sc1
parallel_sum__ssm_conv_s5__mixer_token_mlp__prompt_kernel_w4_82:
    s_mov_b32 s91, 0
parallel_sum__ssm_conv_s5__mixer_token_mlp__prompt_kernel_tl_83:
    s_cmp_ge_u32 s61, 296
    s_cselect_b32 s14, 24, 0
    s_add_u32 s14, s14, s61
    s_waitcnt vmcnt(1)
    s_cmp_ge_u32 s14, 320
    s_cbranch_scc1 parallel_sum__ssm_conv_s5__mixer_token_mlp__prompt_kernel_w2l_84
    s_mul_i32 s89, s14, 52429
    s_lshr_b32 s89, s89, 18
    s_mul_i32 s90, s89, 5
    s_sub_u32 s90, s14, s90
    s_lshl_b32 s90, s90, 2
    s_lshr_b32 s90, s62, s90
    s_and_b32 s90, s90, 15
    s_add_u32 s90, s90, s63
    s_lshl_b32 s90, s90, 8
    s_mul_i32 s88, s89, 294912
    s_add_u32 s88, s88, s90
    buffer_load_dword v1, v16, s[52:55], s88 offen
    s_branch parallel_sum__ssm_conv_s5__mixer_token_mlp__prompt_kernel_go_85
parallel_sum__ssm_conv_s5__mixer_token_mlp__prompt_kernel_w2l_84:
    s_sub_u32 s88, s14, 320
    s_min_u32 s88, s88, 287
    s_lshl_b32 s88, s88, 14
    s_add_u32 s88, s88, s60
    buffer_load_dword v1, v17, s[56:59], s88 offen
parallel_sum__ssm_conv_s5__mixer_token_mlp__prompt_kernel_go_85:
    s_add_u32 s61, s61, 20
    s_add_u32 s91, s91, 1
    s_cmp_lt_u32 s91, 2
    s_cbranch_scc1 parallel_sum__ssm_conv_s5__mixer_token_mlp__prompt_kernel_tl_83
    s_cmp_lg_u32 s3, 4
    s_cbranch_scc1 parallel_sum__ssm_conv_s5__mixer_token_mlp__prompt_kernel_w4_86
    s_mov_b32 s88, 0
parallel_sum__ssm_conv_s5__mixer_token_mlp__prompt_kernel_il_87:
    v_readfirstlane_b32 s89, v30
    s_cmp_ge_u32 s89, 8
    s_cbranch_scc1 parallel_sum__ssm_conv_s5__mixer_token_mlp__prompt_kernel_ie_88
    s_add_u32 s88, s88, 1
    s_cmp_ge_u32 s88, 0x8000
    s_cbranch_scc1 parallel_sum__ssm_conv_s5__mixer_token_mlp__prompt_kernel_ie_88
    s_mov_b32 s68, s46
    s_mov_b32 s69, s47
    s_mov_b32 s70, 0x100
    s_mov_b32 s71, 0x00020000
    v_mov_b32 v31, 128
    buffer_load_dword v30, v31, s[68:71], 0 offen sc1
    s_waitcnt vmcnt(0)
    s_branch parallel_sum__ssm_conv_s5__mixer_token_mlp__prompt_kernel_il_87
parallel_sum__ssm_conv_s5__mixer_token_mlp__prompt_kernel_ie_88:
    s_add_u32 s68, s48, 0x1500000
    s_addc_u32 s69, s49, 0
    s_mov_b32 s70, 0x16c00
    s_mov_b32 s71, 0x00020000
    v_lshlrev_b32 v20, 7, v2
    s_mov_b32 s13, 78848
    buffer_load_dword v22, v20, s[68:71], s13 offen sc1
parallel_sum__ssm_conv_s5__mixer_token_mlp__prompt_kernel_w4_86:
    s_mov_b32 s91, 0
parallel_sum__ssm_conv_s5__mixer_token_mlp__prompt_kernel_tl_89:
    s_cmp_ge_u32 s61, 296
    s_cselect_b32 s14, 24, 0
    s_add_u32 s14, s14, s61
    s_waitcnt vmcnt(1)
    s_cmp_ge_u32 s14, 320
    s_cbranch_scc1 parallel_sum__ssm_conv_s5__mixer_token_mlp__prompt_kernel_w2l_90
    s_mul_i32 s89, s14, 52429
    s_lshr_b32 s89, s89, 18
    s_mul_i32 s90, s89, 5
    s_sub_u32 s90, s14, s90
    s_lshl_b32 s90, s90, 2
    s_lshr_b32 s90, s62, s90
    s_and_b32 s90, s90, 15
    s_add_u32 s90, s90, s63
    s_lshl_b32 s90, s90, 8
    s_mul_i32 s88, s89, 294912
    s_add_u32 s88, s88, s90
    buffer_load_dword v1, v16, s[52:55], s88 offen
    s_branch parallel_sum__ssm_conv_s5__mixer_token_mlp__prompt_kernel_go_91
parallel_sum__ssm_conv_s5__mixer_token_mlp__prompt_kernel_w2l_90:
    s_sub_u32 s88, s14, 320
    s_min_u32 s88, s88, 287
    s_lshl_b32 s88, s88, 14
    s_add_u32 s88, s88, s60
    buffer_load_dword v1, v17, s[56:59], s88 offen
parallel_sum__ssm_conv_s5__mixer_token_mlp__prompt_kernel_go_91:
    s_add_u32 s61, s61, 20
    s_add_u32 s91, s91, 1
    s_cmp_lt_u32 s91, 2
    s_cbranch_scc1 parallel_sum__ssm_conv_s5__mixer_token_mlp__prompt_kernel_tl_89
    s_cmp_lg_u32 s3, 4
    s_cbranch_scc1 parallel_sum__ssm_conv_s5__mixer_token_mlp__prompt_kernel_w4_92
    s_add_u32 s68, s48, 0x1500000
    s_addc_u32 s69, s49, 0
    s_mov_b32 s70, 0x16c00
    s_mov_b32 s71, 0x00020000
    v_lshlrev_b32 v20, 7, v2
    s_mov_b32 s13, 78848
    s_mov_b64 s[72:73], -1
    s_mov_b32 s88, 0
    s_branch parallel_sum__ssm_conv_s5__mixer_token_mlp__prompt_kernel_pollck_95
parallel_sum__ssm_conv_s5__mixer_token_mlp__prompt_kernel_poll_93:
    buffer_load_dword v22, v20, s[68:71], s13 offen offset:0 sc1
    s_waitcnt vmcnt(0)
parallel_sum__ssm_conv_s5__mixer_token_mlp__prompt_kernel_pollck_95:
    s_add_u32 s88, s88, 1
    s_mov_b64 s[78:79], 0
    v_cmp_gt_u32 vcc, 1, v22
    s_and_b64 vcc, vcc, s[72:73]
    s_or_b64 s[78:79], s[78:79], vcc
    s_cbranch_scc0 parallel_sum__ssm_conv_s5__mixer_token_mlp__prompt_kernel_pollend_94
    s_sleep 6
    s_cmp_lt_u32 s88, 0x8000
    s_cbranch_scc1 parallel_sum__ssm_conv_s5__mixer_token_mlp__prompt_kernel_poll_93
parallel_sum__ssm_conv_s5__mixer_token_mlp__prompt_kernel_pollend_94:
    v_mov_b32 v24, 144896
    v_mov_b32 v25, 1
    ds_write_b32 v24, v25
parallel_sum__ssm_conv_s5__mixer_token_mlp__prompt_kernel_w4_92:
    s_mov_b32 s91, 0
parallel_sum__ssm_conv_s5__mixer_token_mlp__prompt_kernel_tl_96:
    s_cmp_ge_u32 s61, 296
    s_cselect_b32 s14, 24, 0
    s_add_u32 s14, s14, s61
    s_waitcnt vmcnt(1)
    s_cmp_ge_u32 s14, 320
    s_cbranch_scc1 parallel_sum__ssm_conv_s5__mixer_token_mlp__prompt_kernel_w2l_97
    s_mul_i32 s89, s14, 52429
    s_lshr_b32 s89, s89, 18
    s_mul_i32 s90, s89, 5
    s_sub_u32 s90, s14, s90
    s_lshl_b32 s90, s90, 2
    s_lshr_b32 s90, s62, s90
    s_and_b32 s90, s90, 15
    s_add_u32 s90, s90, s63
    s_lshl_b32 s90, s90, 8
    s_mul_i32 s88, s89, 294912
    s_add_u32 s88, s88, s90
    buffer_load_dword v1, v16, s[52:55], s88 offen
    s_branch parallel_sum__ssm_conv_s5__mixer_token_mlp__prompt_kernel_go_98
parallel_sum__ssm_conv_s5__mixer_token_mlp__prompt_kernel_w2l_97:
    s_sub_u32 s88, s14, 320
    s_min_u32 s88, s88, 287
    s_lshl_b32 s88, s88, 14
    s_add_u32 s88, s88, s60
    buffer_load_dword v1, v17, s[56:59], s88 offen
parallel_sum__ssm_conv_s5__mixer_token_mlp__prompt_kernel_go_98:
    s_add_u32 s61, s61, 20
    s_add_u32 s91, s91, 1
    s_cmp_lt_u32 s91, 8
    s_cbranch_scc1 parallel_sum__ssm_conv_s5__mixer_token_mlp__prompt_kernel_tl_96
    v_mov_b32 v24, 144896
parallel_sum__ssm_conv_s5__mixer_token_mlp__prompt_kernel_wpo_99:
    s_sleep 1
parallel_sum__ssm_conv_s5__mixer_token_mlp__prompt_kernel_wps_101:
    ds_read_b32 v25, v24 offset:0
    s_waitcnt lgkmcnt(0)
    v_readfirstlane_b32 s88, v25
    s_cmp_eq_u32 s88, 1
    s_cbranch_scc0 parallel_sum__ssm_conv_s5__mixer_token_mlp__prompt_kernel_wpo_99
parallel_sum__ssm_conv_s5__mixer_token_mlp__prompt_kernel_wpe_100:
parallel_sum__ssm_conv_s5__mixer_token_mlp__prompt_kernel_pkw_102:
    ds_read_b32 v25, v24 offset:12
    s_waitcnt lgkmcnt(0)
    v_readfirstlane_b32 s88, v25
    s_cmp_ge_u32 s88, 4
    s_cbranch_scc0 parallel_sum__ssm_conv_s5__mixer_token_mlp__prompt_kernel_pkw_102
    s_and_b32 s5, s2, 1
    s_lshl_b32 s5, s5, 3
    s_lshr_b32 s6, s2, 5
    s_lshl_b32 s6, s6, 2
    s_lshr_b32 s6, 0x71543260, s6
    s_and_b32 s6, s6, 7
    s_add_u32 s5, s5, s6
    s_bfe_u32 s6, s2, 0x20003
    s_bfe_u32 s7, s2, 0x20001
    s_lshl_b32 s11, s5, 2
    s_add_u32 s11, s11, s6
    s_add_u32 s68, s48, 0x1500000
    s_addc_u32 s69, s49, 0
    s_mov_b32 s70, 0x16c00
    s_mov_b32 s71, 0x00020000
    s_mul_i32 s80, s7, 10
    v_add_u32 v19, s80, v2
    v_lshrrev_b32 v18, 2, v19
    v_and_b32 v19, 3, v19
    v_lshlrev_b32 v19, 2, v19
    v_lshl_add_u32 v19, v18, 7, v19
    v_min_u32 v19, 1148, v19
    v_min_u32 v18, 8, v2
    v_lshlrev_b32 v18, 7, v18
    v_lshrrev_b32 v20, 2, v2
    v_min_u32 v20, 8, v20
    v_mul_u32_u24 v20, 768, v20
    v_and_b32 v21, 3, v2
    v_lshl_add_u32 v20, v21, 2, v20
    s_mul_i32 s86, s5, 1152
    s_add_u32 s86, s86, 32768
    s_cmp_eq_u32 s7, 3
    s_cselect_b32 s72, 0x3f, 0x3ff
    s_mov_b32 s73, 0
    s_mul_i32 s87, s6, 1152
    s_add_u32 s87, s87, 88064
    s_mov_b64 s[74:75], 0x1ff
    buffer_load_dword v22, v19, s[68:71], s86 offen sc1
    buffer_load_dword v23, v18, s[68:71], s87 offen sc1
    s_mov_b32 s91, 0
parallel_sum__ssm_conv_s5__mixer_token_mlp__prompt_kernel_tl_103:
    s_cmp_ge_u32 s61, 296
    s_cselect_b32 s14, 24, 0
    s_add_u32 s14, s14, s61
    s_waitcnt vmcnt(1)
    s_cmp_ge_u32 s14, 320
    s_cbranch_scc1 parallel_sum__ssm_conv_s5__mixer_token_mlp__prompt_kernel_w2l_104
    s_mul_i32 s89, s14, 52429
    s_lshr_b32 s89, s89, 18
    s_mul_i32 s90, s89, 5
    s_sub_u32 s90, s14, s90
    s_lshl_b32 s90, s90, 2
    s_lshr_b32 s90, s62, s90
    s_and_b32 s90, s90, 15
    s_add_u32 s90, s90, s63
    s_lshl_b32 s90, s90, 8
    s_mul_i32 s88, s89, 294912
    s_add_u32 s88, s88, s90
    buffer_load_dword v1, v16, s[52:55], s88 offen
    s_branch parallel_sum__ssm_conv_s5__mixer_token_mlp__prompt_kernel_go_105
parallel_sum__ssm_conv_s5__mixer_token_mlp__prompt_kernel_w2l_104:
    s_sub_u32 s88, s14, 320
    s_min_u32 s88, s88, 287
    s_lshl_b32 s88, s88, 14
    s_add_u32 s88, s88, s60
    buffer_load_dword v1, v17, s[56:59], s88 offen
parallel_sum__ssm_conv_s5__mixer_token_mlp__prompt_kernel_go_105:
    s_add_u32 s61, s61, 20
    s_add_u32 s91, s91, 1
    s_cmp_lt_u32 s91, 2
    s_cbranch_scc1 parallel_sum__ssm_conv_s5__mixer_token_mlp__prompt_kernel_tl_103
    s_branch parallel_sum__ssm_conv_s5__mixer_token_mlp__prompt_kernel_hl0_78
parallel_sum__ssm_conv_s5__mixer_token_mlp__prompt_kernel_pkc0_77:
parallel_sum__ssm_conv_s5__mixer_token_mlp__prompt_kernel_pkc_17:
    v_lshrrev_b32 v10, 2, v3
    v_lshl_add_u32 v10, v4, 2, v10
    v_lshlrev_b32 v10, 7, v10
    v_and_b32 v11, 3, v3
    v_lshl_add_u32 v10, v11, 3, v10
    s_lshr_b32 s90, s3, 1
    s_lshl_b32 s90, s90, 12
    v_add_u32 v10, s90, v10
    v_and_b32 v11, 1, v4
    v_lshlrev_b32 v11, 1, v11
    v_lshrrev_b32 v8, 3, v3
    v_or_b32 v11, v11, v8
    s_and_b32 s90, s3, 1
    s_lshl_b32 s90, s90, 1
    v_xor_b32 v8, s90, v11
    v_xor_b32 v9, 1, v8
    v_lshl_add_u32 v8, v8, 5, v10
    v_lshl_add_u32 v9, v9, 5, v10
    v_lshlrev_b32 v13, 4, v2
    v_lshrrev_b32 v10, 3, v3
    v_lshl_add_u32 v10, v4, 2, v10
    v_lshlrev_b32 v10, 4, v10
    s_lshl_b32 s90, s3, 8
    v_add_u32 v10, s90, v10
    v_bfe_u32 v11, v3, 2, 1
    v_mul_u32_u24 v11, 4224, v11
    v_bfe_u32 v12, v3, 1, 1
    v_mul_u32_u24 v12, 1056, v12
    v_xor_b32 v11, v11, v12
    v_and_b32 v12, 1, v3
    v_lshl_add_u32 v11, v12, 3, v11
    v_xor_b32 v10, v10, v11
    v_xor_b32 v14, 32, v10
    v_add_u32 v11, 65536, v13
    v_add_u32 v12, 102400, v13
parallel_sum__ssm_conv_s5__mixer_token_mlp__prompt_kernel_hc_8:
    s_add_u32 s56, s48, 0x1500000
    s_addc_u32 s57, s49, 0
    s_mov_b32 s58, 0x16c00
    s_mov_b32 s59, 0x00020000
    s_barrier
    ds_read_b128 v[96:99], v11 offset:18432
    ds_read_b128 v[100:103], v11 offset:19456
    ds_read_b128 v[104:107], v11 offset:20480
    ds_read_b128 v[108:111], v11 offset:21504
    ds_read_b128 v[112:115], v11 offset:22528
    ds_read_b128 v[116:119], v11 offset:23552
    ds_read_b128 v[120:123], v11 offset:24576
    ds_read_b128 v[124:127], v11 offset:25600
    ds_read_b64_tr_b16 v[88:89], v10 offset:16384
    ds_read_b64_tr_b16 v[90:91], v14 offset:16384
    ds_read_b64_tr_b16 v[92:93], v10 offset:18432
    ds_read_b64_tr_b16 v[94:95], v14 offset:18432
    ds_read_b128 v[128:131], v11 offset:26624
    ds_read_b128 v[140:143], v11 offset:27648
    ds_read_b128 v[144:147], v11 offset:28672
    ds_read_b128 v[148:151], v11 offset:29696
    ds_read_b128 v[152:155], v11 offset:30720
    ds_read_b128 v[156:159], v11 offset:31744
    ds_read_b128 v[160:163], v11 offset:32768
    ds_read_b128 v[164:167], v11 offset:33792
    ds_read_b128 v[168:171], v11 offset:34816
    ds_read_b64_tr_b16 v[132:133], v10 offset:24576
    ds_read_b64_tr_b16 v[134:135], v14 offset:24576
    ds_read_b64_tr_b16 v[136:137], v10 offset:26624
    ds_read_b64_tr_b16 v[138:139], v14 offset:26624
    ds_read_b128 v[172:175], v11 offset:35840
    s_waitcnt lgkmcnt(14)
    v_mfma_f32_16x16x32_bf16 v[16:19], v[96:99], v[88:91], 0
    v_mfma_f32_16x16x32_bf16 v[20:23], v[96:99], v[92:95], 0
    v_mfma_f32_16x16x32_bf16 v[24:27], v[100:103], v[88:91], 0
    v_mfma_f32_16x16x32_bf16 v[28:31], v[100:103], v[92:95], 0
    v_mfma_f32_16x16x32_bf16 v[32:35], v[104:107], v[88:91], 0
    v_mfma_f32_16x16x32_bf16 v[36:39], v[104:107], v[92:95], 0
    v_mfma_f32_16x16x32_bf16 v[40:43], v[108:111], v[88:91], 0
    v_mfma_f32_16x16x32_bf16 v[44:47], v[108:111], v[92:95], 0
    v_mfma_f32_16x16x32_bf16 v[48:51], v[112:115], v[88:91], 0
    v_mfma_f32_16x16x32_bf16 v[52:55], v[112:115], v[92:95], 0
    v_mfma_f32_16x16x32_bf16 v[56:59], v[116:119], v[88:91], 0
    v_mfma_f32_16x16x32_bf16 v[60:63], v[116:119], v[92:95], 0
    v_mfma_f32_16x16x32_bf16 v[64:67], v[120:123], v[88:91], 0
    v_mfma_f32_16x16x32_bf16 v[68:71], v[120:123], v[92:95], 0
    s_waitcnt lgkmcnt(0)
    s_barrier
    v_mfma_f32_16x16x32_bf16 v[72:75], v[124:127], v[88:91], 0
    ds_read_b128 v[96:99], v12 offset:0
    v_mfma_f32_16x16x32_bf16 v[76:79], v[124:127], v[92:95], 0
    ds_read_b128 v[100:103], v12 offset:1024
    v_mfma_f32_16x16x32_bf16 v[80:83], v[128:131], v[88:91], 0
    ds_read_b128 v[104:107], v12 offset:2048
    v_mfma_f32_16x16x32_bf16 v[84:87], v[128:131], v[92:95], 0
    ds_read_b128 v[108:111], v12 offset:3072
    s_cmp_eq_u32 s50, 2
    s_cbranch_scc1 parallel_sum__ssm_conv_s5__mixer_token_mlp__prompt_kernel_nouf_106
    v_mov_b32 v5, 0
    v_mov_b32 v6, 1
    s_waitcnt vmcnt(0)
    s_mov_b64 exec, 1
    buffer_store_dword v6, v5, s[56:59], s62 offen sc1
    s_mov_b64 exec, -1
parallel_sum__ssm_conv_s5__mixer_token_mlp__prompt_kernel_nouf_106:
    v_mfma_f32_16x16x32_bf16 v[16:19], v[140:143], v[132:135], v[16:19]
    ds_read_b128 v[112:115], v12 offset:4096
    v_mfma_f32_16x16x32_bf16 v[20:23], v[140:143], v[136:139], v[20:23]
    ds_read_b128 v[116:119], v12 offset:5120
    v_mfma_f32_16x16x32_bf16 v[24:27], v[144:147], v[132:135], v[24:27]
    ds_read_b128 v[120:123], v12 offset:6144
    v_mfma_f32_16x16x32_bf16 v[28:31], v[144:147], v[136:139], v[28:31]
    ds_read_b128 v[124:127], v12 offset:7168
    v_mfma_f32_16x16x32_bf16 v[32:35], v[148:151], v[132:135], v[32:35]
    ds_read_b64_tr_b16 v[88:89], v10 offset:32768
    v_mfma_f32_16x16x32_bf16 v[36:39], v[148:151], v[136:139], v[36:39]
    ds_read_b64_tr_b16 v[90:91], v14 offset:32768
    v_mfma_f32_16x16x32_bf16 v[40:43], v[152:155], v[132:135], v[40:43]
    ds_read_b64_tr_b16 v[92:93], v10 offset:34816
    v_mfma_f32_16x16x32_bf16 v[44:47], v[152:155], v[136:139], v[44:47]
    ds_read_b64_tr_b16 v[94:95], v14 offset:34816
    v_mfma_f32_16x16x32_bf16 v[48:51], v[156:159], v[132:135], v[48:51]
    ds_read_b128 v[128:131], v12 offset:8192
    v_mfma_f32_16x16x32_bf16 v[52:55], v[156:159], v[136:139], v[52:55]
    ds_read_b128 v[140:143], v12 offset:9216
    v_mfma_f32_16x16x32_bf16 v[56:59], v[160:163], v[132:135], v[56:59]
    ds_read_b128 v[144:147], v12 offset:10240
    v_mfma_f32_16x16x32_bf16 v[60:63], v[160:163], v[136:139], v[60:63]
    ds_read_b128 v[148:151], v12 offset:11264
    v_mfma_f32_16x16x32_bf16 v[64:67], v[164:167], v[132:135], v[64:67]
    ds_read_b128 v[152:155], v12 offset:12288
    v_mfma_f32_16x16x32_bf16 v[68:71], v[164:167], v[136:139], v[68:71]
    ds_read_b128 v[156:159], v12 offset:13312
    v_mfma_f32_16x16x32_bf16 v[72:75], v[168:171], v[132:135], v[72:75]
    ds_read_b128 v[160:163], v12 offset:14336
    v_mfma_f32_16x16x32_bf16 v[76:79], v[168:171], v[136:139], v[76:79]
    ds_read_b128 v[164:167], v12 offset:15360
    v_mfma_f32_16x16x32_bf16 v[80:83], v[172:175], v[132:135], v[80:83]
    ds_read_b128 v[168:171], v12 offset:16384
    v_mfma_f32_16x16x32_bf16 v[84:87], v[172:175], v[136:139], v[84:87]
    ds_read_b64_tr_b16 v[132:133], v10 offset:40960
    s_waitcnt lgkmcnt(10)
    v_mfma_f32_16x16x32_bf16 v[16:19], v[96:99], v[88:91], v[16:19]
    ds_read_b64_tr_b16 v[134:135], v14 offset:40960
    v_mfma_f32_16x16x32_bf16 v[20:23], v[96:99], v[92:95], v[20:23]
    ds_read_b64_tr_b16 v[136:137], v10 offset:43008
    v_mfma_f32_16x16x32_bf16 v[24:27], v[100:103], v[88:91], v[24:27]
    ds_read_b64_tr_b16 v[138:139], v14 offset:43008
    v_mfma_f32_16x16x32_bf16 v[28:31], v[100:103], v[92:95], v[28:31]
    ds_read_b128 v[172:175], v12 offset:17408
    v_mfma_f32_16x16x32_bf16 v[32:35], v[104:107], v[88:91], v[32:35]
    v_mfma_f32_16x16x32_bf16 v[36:39], v[104:107], v[92:95], v[36:39]
    v_mfma_f32_16x16x32_bf16 v[40:43], v[108:111], v[88:91], v[40:43]
    v_mfma_f32_16x16x32_bf16 v[44:47], v[108:111], v[92:95], v[44:47]
    v_mfma_f32_16x16x32_bf16 v[48:51], v[112:115], v[88:91], v[48:51]
    v_mfma_f32_16x16x32_bf16 v[52:55], v[112:115], v[92:95], v[52:55]
    v_mfma_f32_16x16x32_bf16 v[56:59], v[116:119], v[88:91], v[56:59]
    v_mfma_f32_16x16x32_bf16 v[60:63], v[116:119], v[92:95], v[60:63]
    v_mfma_f32_16x16x32_bf16 v[64:67], v[120:123], v[88:91], v[64:67]
    v_mfma_f32_16x16x32_bf16 v[68:71], v[120:123], v[92:95], v[68:71]
    s_waitcnt lgkmcnt(0)
    s_barrier
    v_mfma_f32_16x16x32_bf16 v[72:75], v[124:127], v[88:91], v[72:75]
    ds_read_b128 v[96:99], v12 offset:18432
    v_mfma_f32_16x16x32_bf16 v[76:79], v[124:127], v[92:95], v[76:79]
    ds_read_b128 v[100:103], v12 offset:19456
    v_mfma_f32_16x16x32_bf16 v[80:83], v[128:131], v[88:91], v[80:83]
    ds_read_b128 v[104:107], v12 offset:20480
    v_mfma_f32_16x16x32_bf16 v[84:87], v[128:131], v[92:95], v[84:87]
    ds_read_b128 v[108:111], v12 offset:21504
    s_and_b32 s5, s2, 1
    s_lshl_b32 s5, s5, 3
    s_lshr_b32 s6, s2, 5
    s_lshl_b32 s6, s6, 2
    s_lshr_b32 s6, 0x71543260, s6
    s_and_b32 s6, s6, 7
    s_add_u32 s5, s5, s6
    s_bfe_u32 s6, s2, 0x20003
    s_bfe_u32 s7, s2, 0x20001
    s_lshl_b32 s11, s5, 2
    s_add_u32 s11, s11, s6
    s_add_u32 s52, s48, 0xe00000
    s_addc_u32 s53, s49, 0
    s_mov_b32 s54, 0x6c0000
    s_mov_b32 s55, 0x00020000
    s_sub_u32 s13, s7, s3
    s_sub_u32 s13, s13, 1
    s_and_b32 s13, s13, 3
    s_lshl_b32 s14, s11, 2
    s_add_u32 s14, s14, s3
    s_mul_i32 s15, s14, 3
    s_add_u32 s15, s15, s13
    s_mul_i32 s15, s15, 9216
    s_lshl_b32 s14, s14, 7
    s_lshl_b32 s13, s13, 2
    s_add_u32 s14, s14, s13
    v_mfma_f32_16x16x32_bf16 v[16:19], v[140:143], v[132:135], v[16:19]
    ds_read_b128 v[112:115], v12 offset:22528
    v_mfma_f32_16x16x32_bf16 v[20:23], v[140:143], v[136:139], v[20:23]
    ds_read_b128 v[116:119], v12 offset:23552
    v_mfma_f32_16x16x32_bf16 v[24:27], v[144:147], v[132:135], v[24:27]
    ds_read_b128 v[120:123], v12 offset:24576
    v_mfma_f32_16x16x32_bf16 v[28:31], v[144:147], v[136:139], v[28:31]
    ds_read_b128 v[124:127], v12 offset:25600
    v_mfma_f32_16x16x32_bf16 v[32:35], v[148:151], v[132:135], v[32:35]
    ds_read_b64_tr_b16 v[88:89], v10 offset:49152
    v_mfma_f32_16x16x32_bf16 v[36:39], v[148:151], v[136:139], v[36:39]
    ds_read_b64_tr_b16 v[90:91], v14 offset:49152
    v_mfma_f32_16x16x32_bf16 v[40:43], v[152:155], v[132:135], v[40:43]
    ds_read_b64_tr_b16 v[92:93], v10 offset:51200
    v_mfma_f32_16x16x32_bf16 v[44:47], v[152:155], v[136:139], v[44:47]
    ds_read_b64_tr_b16 v[94:95], v14 offset:51200
    v_mfma_f32_16x16x32_bf16 v[48:51], v[156:159], v[132:135], v[48:51]
    ds_read_b128 v[128:131], v12 offset:26624
    v_mfma_f32_16x16x32_bf16 v[52:55], v[156:159], v[136:139], v[52:55]
    ds_read_b128 v[140:143], v12 offset:27648
    v_mfma_f32_16x16x32_bf16 v[56:59], v[160:163], v[132:135], v[56:59]
    ds_read_b128 v[144:147], v12 offset:28672
    v_mfma_f32_16x16x32_bf16 v[60:63], v[160:163], v[136:139], v[60:63]
    ds_read_b128 v[148:151], v12 offset:29696
    v_mfma_f32_16x16x32_bf16 v[64:67], v[164:167], v[132:135], v[64:67]
    ds_read_b128 v[152:155], v12 offset:30720
    v_mfma_f32_16x16x32_bf16 v[68:71], v[164:167], v[136:139], v[68:71]
    ds_read_b128 v[156:159], v12 offset:31744
    v_mfma_f32_16x16x32_bf16 v[72:75], v[168:171], v[132:135], v[72:75]
    ds_read_b128 v[160:163], v12 offset:32768
    v_mfma_f32_16x16x32_bf16 v[76:79], v[168:171], v[136:139], v[76:79]
    ds_read_b128 v[164:167], v12 offset:33792
    v_mfma_f32_16x16x32_bf16 v[80:83], v[172:175], v[132:135], v[80:83]
    ds_read_b128 v[168:171], v12 offset:34816
    v_mfma_f32_16x16x32_bf16 v[84:87], v[172:175], v[136:139], v[84:87]
    ds_read_b64_tr_b16 v[132:133], v10 offset:57344
    s_waitcnt lgkmcnt(10)
    v_mfma_f32_16x16x32_bf16 v[16:19], v[96:99], v[88:91], v[16:19]
    ds_read_b64_tr_b16 v[134:135], v14 offset:57344
    v_mfma_f32_16x16x32_bf16 v[20:23], v[96:99], v[92:95], v[20:23]
    ds_read_b64_tr_b16 v[136:137], v10 offset:59392
    v_mfma_f32_16x16x32_bf16 v[24:27], v[100:103], v[88:91], v[24:27]
    ds_read_b64_tr_b16 v[138:139], v14 offset:59392
    v_mfma_f32_16x16x32_bf16 v[28:31], v[100:103], v[92:95], v[28:31]
    ds_read_b128 v[172:175], v12 offset:35840
    v_mfma_f32_16x16x32_bf16 v[32:35], v[104:107], v[88:91], v[32:35]
    v_mfma_f32_16x16x32_bf16 v[36:39], v[104:107], v[92:95], v[36:39]
    v_mfma_f32_16x16x32_bf16 v[40:43], v[108:111], v[88:91], v[40:43]
    v_mfma_f32_16x16x32_bf16 v[44:47], v[108:111], v[92:95], v[44:47]
    v_mfma_f32_16x16x32_bf16 v[48:51], v[112:115], v[88:91], v[48:51]
    v_mfma_f32_16x16x32_bf16 v[52:55], v[112:115], v[92:95], v[52:55]
    v_mfma_f32_16x16x32_bf16 v[56:59], v[116:119], v[88:91], v[56:59]
    v_mfma_f32_16x16x32_bf16 v[60:63], v[116:119], v[92:95], v[60:63]
    v_mfma_f32_16x16x32_bf16 v[64:67], v[120:123], v[88:91], v[64:67]
    v_mfma_f32_16x16x32_bf16 v[68:71], v[120:123], v[92:95], v[68:71]
    s_waitcnt lgkmcnt(0)
    s_barrier
    v_mfma_f32_16x16x32_bf16 v[72:75], v[124:127], v[88:91], v[72:75]
    ds_read_b128 v[96:99], v11 offset:0
    v_mfma_f32_16x16x32_bf16 v[76:79], v[124:127], v[92:95], v[76:79]
    ds_read_b128 v[100:103], v11 offset:1024
    v_mfma_f32_16x16x32_bf16 v[80:83], v[128:131], v[88:91], v[80:83]
    ds_read_b128 v[104:107], v11 offset:2048
    v_mfma_f32_16x16x32_bf16 v[84:87], v[128:131], v[92:95], v[84:87]
    ds_read_b128 v[108:111], v11 offset:3072
    v_mfma_f32_16x16x32_bf16 v[16:19], v[140:143], v[132:135], v[16:19]
    ds_read_b128 v[112:115], v11 offset:4096
    v_mfma_f32_16x16x32_bf16 v[20:23], v[140:143], v[136:139], v[20:23]
    ds_read_b128 v[116:119], v11 offset:5120
    v_mfma_f32_16x16x32_bf16 v[24:27], v[144:147], v[132:135], v[24:27]
    ds_read_b128 v[120:123], v11 offset:6144
    v_mfma_f32_16x16x32_bf16 v[28:31], v[144:147], v[136:139], v[28:31]
    ds_read_b128 v[124:127], v11 offset:7168
    v_mfma_f32_16x16x32_bf16 v[32:35], v[148:151], v[132:135], v[32:35]
    ds_read_b64_tr_b16 v[88:89], v10 offset:0
    v_mfma_f32_16x16x32_bf16 v[36:39], v[148:151], v[136:139], v[36:39]
    ds_read_b64_tr_b16 v[90:91], v14 offset:0
    v_mfma_f32_16x16x32_bf16 v[40:43], v[152:155], v[132:135], v[40:43]
    ds_read_b64_tr_b16 v[92:93], v10 offset:2048
    v_mfma_f32_16x16x32_bf16 v[44:47], v[152:155], v[136:139], v[44:47]
    ds_read_b64_tr_b16 v[94:95], v14 offset:2048
    v_mfma_f32_16x16x32_bf16 v[48:51], v[156:159], v[132:135], v[48:51]
    ds_read_b128 v[128:131], v11 offset:8192
    v_mfma_f32_16x16x32_bf16 v[52:55], v[156:159], v[136:139], v[52:55]
    ds_read_b128 v[140:143], v11 offset:9216
    v_mfma_f32_16x16x32_bf16 v[56:59], v[160:163], v[132:135], v[56:59]
    ds_read_b128 v[144:147], v11 offset:10240
    v_mfma_f32_16x16x32_bf16 v[60:63], v[160:163], v[136:139], v[60:63]
    ds_read_b128 v[148:151], v11 offset:11264
    v_mfma_f32_16x16x32_bf16 v[64:67], v[164:167], v[132:135], v[64:67]
    ds_read_b128 v[152:155], v11 offset:12288
    v_mfma_f32_16x16x32_bf16 v[68:71], v[164:167], v[136:139], v[68:71]
    ds_read_b128 v[156:159], v11 offset:13312
    v_mfma_f32_16x16x32_bf16 v[72:75], v[168:171], v[132:135], v[72:75]
    ds_read_b128 v[160:163], v11 offset:14336
    v_mfma_f32_16x16x32_bf16 v[76:79], v[168:171], v[136:139], v[76:79]
    ds_read_b128 v[164:167], v11 offset:15360
    v_mfma_f32_16x16x32_bf16 v[80:83], v[172:175], v[132:135], v[80:83]
    ds_read_b128 v[168:171], v11 offset:16384
    v_mfma_f32_16x16x32_bf16 v[84:87], v[172:175], v[136:139], v[84:87]
    ds_read_b64_tr_b16 v[132:133], v10 offset:8192
    s_waitcnt lgkmcnt(10)
    v_mfma_f32_16x16x32_bf16 v[16:19], v[96:99], v[88:91], v[16:19]
    ds_read_b64_tr_b16 v[134:135], v14 offset:8192
    v_mfma_f32_16x16x32_bf16 v[20:23], v[96:99], v[92:95], v[20:23]
    ds_read_b64_tr_b16 v[136:137], v10 offset:10240
    v_mfma_f32_16x16x32_bf16 v[24:27], v[100:103], v[88:91], v[24:27]
    ds_read_b64_tr_b16 v[138:139], v14 offset:10240
    v_mfma_f32_16x16x32_bf16 v[28:31], v[100:103], v[92:95], v[28:31]
    ds_read_b128 v[172:175], v11 offset:17408
    v_mfma_f32_16x16x32_bf16 v[32:35], v[104:107], v[88:91], v[32:35]
    v_mfma_f32_16x16x32_bf16 v[36:39], v[104:107], v[92:95], v[36:39]
    v_mfma_f32_16x16x32_bf16 v[40:43], v[108:111], v[88:91], v[40:43]
    v_mfma_f32_16x16x32_bf16 v[44:47], v[108:111], v[92:95], v[44:47]
    v_mfma_f32_16x16x32_bf16 v[48:51], v[112:115], v[88:91], v[48:51]
    v_mfma_f32_16x16x32_bf16 v[52:55], v[112:115], v[92:95], v[52:55]
    v_mfma_f32_16x16x32_bf16 v[56:59], v[116:119], v[88:91], v[56:59]
    v_mfma_f32_16x16x32_bf16 v[60:63], v[116:119], v[92:95], v[60:63]
    v_mfma_f32_16x16x32_bf16 v[64:67], v[120:123], v[88:91], v[64:67]
    v_mfma_f32_16x16x32_bf16 v[68:71], v[120:123], v[92:95], v[68:71]
    s_waitcnt lgkmcnt(0)
    s_barrier
    v_mfma_f32_16x16x32_bf16 v[72:75], v[124:127], v[88:91], v[72:75]
    ds_read_b128 v[96:99], v11 offset:18432
    v_mfma_f32_16x16x32_bf16 v[76:79], v[124:127], v[92:95], v[76:79]
    ds_read_b128 v[100:103], v11 offset:19456
    v_mfma_f32_16x16x32_bf16 v[80:83], v[128:131], v[88:91], v[80:83]
    ds_read_b128 v[104:107], v11 offset:20480
    v_mfma_f32_16x16x32_bf16 v[84:87], v[128:131], v[92:95], v[84:87]
    ds_read_b128 v[108:111], v11 offset:21504
    v_mfma_f32_16x16x32_bf16 v[16:19], v[140:143], v[132:135], v[16:19]
    ds_read_b128 v[112:115], v11 offset:22528
    v_mfma_f32_16x16x32_bf16 v[20:23], v[140:143], v[136:139], v[20:23]
    ds_read_b128 v[116:119], v11 offset:23552
    v_mfma_f32_16x16x32_bf16 v[24:27], v[144:147], v[132:135], v[24:27]
    ds_read_b128 v[120:123], v11 offset:24576
    v_mfma_f32_16x16x32_bf16 v[28:31], v[144:147], v[136:139], v[28:31]
    ds_read_b128 v[124:127], v11 offset:25600
    v_mfma_f32_16x16x32_bf16 v[32:35], v[148:151], v[132:135], v[32:35]
    ds_read_b64_tr_b16 v[88:89], v10 offset:16384
    v_mfma_f32_16x16x32_bf16 v[36:39], v[148:151], v[136:139], v[36:39]
    ds_read_b64_tr_b16 v[90:91], v14 offset:16384
    v_mfma_f32_16x16x32_bf16 v[40:43], v[152:155], v[132:135], v[40:43]
    ds_read_b64_tr_b16 v[92:93], v10 offset:18432
    v_mfma_f32_16x16x32_bf16 v[44:47], v[152:155], v[136:139], v[44:47]
    ds_read_b64_tr_b16 v[94:95], v14 offset:18432
    v_mfma_f32_16x16x32_bf16 v[48:51], v[156:159], v[132:135], v[48:51]
    ds_read_b128 v[128:131], v11 offset:26624
    v_mfma_f32_16x16x32_bf16 v[52:55], v[156:159], v[136:139], v[52:55]
    ds_read_b128 v[140:143], v11 offset:27648
    v_mfma_f32_16x16x32_bf16 v[56:59], v[160:163], v[132:135], v[56:59]
    ds_read_b128 v[144:147], v11 offset:28672
    v_mfma_f32_16x16x32_bf16 v[60:63], v[160:163], v[136:139], v[60:63]
    ds_read_b128 v[148:151], v11 offset:29696
    v_mfma_f32_16x16x32_bf16 v[64:67], v[164:167], v[132:135], v[64:67]
    ds_read_b128 v[152:155], v11 offset:30720
    v_mfma_f32_16x16x32_bf16 v[68:71], v[164:167], v[136:139], v[68:71]
    ds_read_b128 v[156:159], v11 offset:31744
    v_mfma_f32_16x16x32_bf16 v[72:75], v[168:171], v[132:135], v[72:75]
    ds_read_b128 v[160:163], v11 offset:32768
    v_mfma_f32_16x16x32_bf16 v[76:79], v[168:171], v[136:139], v[76:79]
    ds_read_b128 v[164:167], v11 offset:33792
    v_mfma_f32_16x16x32_bf16 v[80:83], v[172:175], v[132:135], v[80:83]
    ds_read_b128 v[168:171], v11 offset:34816
    v_mfma_f32_16x16x32_bf16 v[84:87], v[172:175], v[136:139], v[84:87]
    ds_read_b64_tr_b16 v[132:133], v10 offset:24576
    s_waitcnt lgkmcnt(10)
    v_mfma_f32_16x16x32_bf16 v[16:19], v[96:99], v[88:91], v[16:19]
    ds_read_b64_tr_b16 v[134:135], v14 offset:24576
    v_mfma_f32_16x16x32_bf16 v[20:23], v[96:99], v[92:95], v[20:23]
    ds_read_b64_tr_b16 v[136:137], v10 offset:26624
    v_mfma_f32_16x16x32_bf16 v[24:27], v[100:103], v[88:91], v[24:27]
    ds_read_b64_tr_b16 v[138:139], v14 offset:26624
    v_mfma_f32_16x16x32_bf16 v[28:31], v[100:103], v[92:95], v[28:31]
    ds_read_b128 v[172:175], v11 offset:35840
    v_mfma_f32_16x16x32_bf16 v[32:35], v[104:107], v[88:91], v[32:35]
    v_mfma_f32_16x16x32_bf16 v[36:39], v[104:107], v[92:95], v[36:39]
    v_mfma_f32_16x16x32_bf16 v[40:43], v[108:111], v[88:91], v[40:43]
    v_mfma_f32_16x16x32_bf16 v[44:47], v[108:111], v[92:95], v[44:47]
    v_mfma_f32_16x16x32_bf16 v[48:51], v[112:115], v[88:91], v[48:51]
    v_mfma_f32_16x16x32_bf16 v[52:55], v[112:115], v[92:95], v[52:55]
    v_mfma_f32_16x16x32_bf16 v[56:59], v[116:119], v[88:91], v[56:59]
    v_mfma_f32_16x16x32_bf16 v[60:63], v[116:119], v[92:95], v[60:63]
    v_mfma_f32_16x16x32_bf16 v[64:67], v[120:123], v[88:91], v[64:67]
    v_mfma_f32_16x16x32_bf16 v[68:71], v[120:123], v[92:95], v[68:71]
    s_waitcnt lgkmcnt(0)
    s_barrier
    v_mfma_f32_16x16x32_bf16 v[72:75], v[124:127], v[88:91], v[72:75]
    ds_read_b128 v[96:99], v12 offset:0
    v_mfma_f32_16x16x32_bf16 v[76:79], v[124:127], v[92:95], v[76:79]
    ds_read_b128 v[100:103], v12 offset:1024
    v_mfma_f32_16x16x32_bf16 v[80:83], v[128:131], v[88:91], v[80:83]
    ds_read_b128 v[104:107], v12 offset:2048
    v_mfma_f32_16x16x32_bf16 v[84:87], v[128:131], v[92:95], v[84:87]
    ds_read_b128 v[108:111], v12 offset:3072
    v_mfma_f32_16x16x32_bf16 v[16:19], v[140:143], v[132:135], v[16:19]
    ds_read_b128 v[112:115], v12 offset:4096
    v_mfma_f32_16x16x32_bf16 v[20:23], v[140:143], v[136:139], v[20:23]
    ds_read_b128 v[116:119], v12 offset:5120
    v_mfma_f32_16x16x32_bf16 v[24:27], v[144:147], v[132:135], v[24:27]
    ds_read_b128 v[120:123], v12 offset:6144
    v_mfma_f32_16x16x32_bf16 v[28:31], v[144:147], v[136:139], v[28:31]
    ds_read_b128 v[124:127], v12 offset:7168
    v_mfma_f32_16x16x32_bf16 v[32:35], v[148:151], v[132:135], v[32:35]
    ds_read_b64_tr_b16 v[88:89], v8 offset:32768
    v_mfma_f32_16x16x32_bf16 v[36:39], v[148:151], v[136:139], v[36:39]
    ds_read_b64_tr_b16 v[90:91], v8 offset:34816
    v_mfma_f32_16x16x32_bf16 v[40:43], v[152:155], v[132:135], v[40:43]
    ds_read_b64_tr_b16 v[92:93], v9 offset:32768
    v_mfma_f32_16x16x32_bf16 v[44:47], v[152:155], v[136:139], v[44:47]
    ds_read_b64_tr_b16 v[94:95], v9 offset:34816
    v_mfma_f32_16x16x32_bf16 v[48:51], v[156:159], v[132:135], v[48:51]
    ds_read_b128 v[128:131], v12 offset:8192
    v_mfma_f32_16x16x32_bf16 v[52:55], v[156:159], v[136:139], v[52:55]
    ds_read_b128 v[140:143], v12 offset:9216
    v_mfma_f32_16x16x32_bf16 v[56:59], v[160:163], v[132:135], v[56:59]
    ds_read_b128 v[144:147], v12 offset:10240
    v_mfma_f32_16x16x32_bf16 v[60:63], v[160:163], v[136:139], v[60:63]
    ds_read_b128 v[148:151], v12 offset:11264
    v_mfma_f32_16x16x32_bf16 v[64:67], v[164:167], v[132:135], v[64:67]
    ds_read_b128 v[152:155], v12 offset:12288
    v_mfma_f32_16x16x32_bf16 v[68:71], v[164:167], v[136:139], v[68:71]
    ds_read_b128 v[156:159], v12 offset:13312
    v_mfma_f32_16x16x32_bf16 v[72:75], v[168:171], v[132:135], v[72:75]
    ds_read_b128 v[160:163], v12 offset:14336
    v_mfma_f32_16x16x32_bf16 v[76:79], v[168:171], v[136:139], v[76:79]
    ds_read_b128 v[164:167], v12 offset:15360
    v_mfma_f32_16x16x32_bf16 v[80:83], v[172:175], v[132:135], v[80:83]
    ds_read_b128 v[168:171], v12 offset:16384
    v_mfma_f32_16x16x32_bf16 v[84:87], v[172:175], v[136:139], v[84:87]
    ds_read_b64_tr_b16 v[132:133], v8 offset:40960
    ds_read_b64_tr_b16 v[134:135], v8 offset:43008
    ds_read_b64_tr_b16 v[136:137], v9 offset:40960
    ds_read_b64_tr_b16 v[138:139], v9 offset:43008
    ds_read_b128 v[172:175], v12 offset:17408
    s_mov_b32 s91, 0
    .p2align 6
parallel_sum__ssm_conv_s5__mixer_token_mlp__prompt_kernel_cloop_107:
    s_waitcnt lgkmcnt(14)
    v_mfma_f32_16x16x32_bf16 v[16:19], v[96:99], v[88:91], v[16:19]
    v_mfma_f32_16x16x32_bf16 v[20:23], v[96:99], v[92:95], v[20:23]
    v_mfma_f32_16x16x32_bf16 v[24:27], v[100:103], v[88:91], v[24:27]
    v_mfma_f32_16x16x32_bf16 v[28:31], v[100:103], v[92:95], v[28:31]
    v_mfma_f32_16x16x32_bf16 v[32:35], v[104:107], v[88:91], v[32:35]
    v_mfma_f32_16x16x32_bf16 v[36:39], v[104:107], v[92:95], v[36:39]
    v_mfma_f32_16x16x32_bf16 v[40:43], v[108:111], v[88:91], v[40:43]
    v_mfma_f32_16x16x32_bf16 v[44:47], v[108:111], v[92:95], v[44:47]
    v_mfma_f32_16x16x32_bf16 v[48:51], v[112:115], v[88:91], v[48:51]
    v_mfma_f32_16x16x32_bf16 v[52:55], v[112:115], v[92:95], v[52:55]
    v_mfma_f32_16x16x32_bf16 v[56:59], v[116:119], v[88:91], v[56:59]
    v_mfma_f32_16x16x32_bf16 v[60:63], v[116:119], v[92:95], v[60:63]
    v_mfma_f32_16x16x32_bf16 v[64:67], v[120:123], v[88:91], v[64:67]
    v_mfma_f32_16x16x32_bf16 v[68:71], v[120:123], v[92:95], v[68:71]
    s_waitcnt lgkmcnt(0)
    s_barrier
    v_mfma_f32_16x16x32_bf16 v[72:75], v[124:127], v[88:91], v[72:75]
    ds_read_b128 v[96:99], v12 offset:18432
    v_mfma_f32_16x16x32_bf16 v[76:79], v[124:127], v[92:95], v[76:79]
    ds_read_b128 v[100:103], v12 offset:19456
    v_mfma_f32_16x16x32_bf16 v[80:83], v[128:131], v[88:91], v[80:83]
    ds_read_b128 v[104:107], v12 offset:20480
    v_mfma_f32_16x16x32_bf16 v[84:87], v[128:131], v[92:95], v[84:87]
    ds_read_b128 v[108:111], v12 offset:21504
    v_mfma_f32_16x16x32_bf16 v[16:19], v[140:143], v[132:135], v[16:19]
    ds_read_b128 v[112:115], v12 offset:22528
    v_mfma_f32_16x16x32_bf16 v[20:23], v[140:143], v[136:139], v[20:23]
    ds_read_b128 v[116:119], v12 offset:23552
    v_mfma_f32_16x16x32_bf16 v[24:27], v[144:147], v[132:135], v[24:27]
    ds_read_b128 v[120:123], v12 offset:24576
    v_mfma_f32_16x16x32_bf16 v[28:31], v[144:147], v[136:139], v[28:31]
    ds_read_b128 v[124:127], v12 offset:25600
    v_mfma_f32_16x16x32_bf16 v[32:35], v[148:151], v[132:135], v[32:35]
    ds_read_b64_tr_b16 v[88:89], v8 offset:49152
    v_mfma_f32_16x16x32_bf16 v[36:39], v[148:151], v[136:139], v[36:39]
    ds_read_b64_tr_b16 v[90:91], v8 offset:51200
    v_mfma_f32_16x16x32_bf16 v[40:43], v[152:155], v[132:135], v[40:43]
    ds_read_b64_tr_b16 v[92:93], v9 offset:49152
    v_mfma_f32_16x16x32_bf16 v[44:47], v[152:155], v[136:139], v[44:47]
    ds_read_b64_tr_b16 v[94:95], v9 offset:51200
    v_mfma_f32_16x16x32_bf16 v[48:51], v[156:159], v[132:135], v[48:51]
    ds_read_b128 v[128:131], v12 offset:26624
    v_mfma_f32_16x16x32_bf16 v[52:55], v[156:159], v[136:139], v[52:55]
    ds_read_b128 v[140:143], v12 offset:27648
    v_mfma_f32_16x16x32_bf16 v[56:59], v[160:163], v[132:135], v[56:59]
    ds_read_b128 v[144:147], v12 offset:28672
    v_mfma_f32_16x16x32_bf16 v[60:63], v[160:163], v[136:139], v[60:63]
    ds_read_b128 v[148:151], v12 offset:29696
    v_mfma_f32_16x16x32_bf16 v[64:67], v[164:167], v[132:135], v[64:67]
    ds_read_b128 v[152:155], v12 offset:30720
    v_mfma_f32_16x16x32_bf16 v[68:71], v[164:167], v[136:139], v[68:71]
    ds_read_b128 v[156:159], v12 offset:31744
    v_mfma_f32_16x16x32_bf16 v[72:75], v[168:171], v[132:135], v[72:75]
    ds_read_b128 v[160:163], v12 offset:32768
    v_mfma_f32_16x16x32_bf16 v[76:79], v[168:171], v[136:139], v[76:79]
    ds_read_b128 v[164:167], v12 offset:33792
    v_mfma_f32_16x16x32_bf16 v[80:83], v[172:175], v[132:135], v[80:83]
    ds_read_b128 v[168:171], v12 offset:34816
    v_mfma_f32_16x16x32_bf16 v[84:87], v[172:175], v[136:139], v[84:87]
    ds_read_b64_tr_b16 v[132:133], v8 offset:57344
    s_waitcnt lgkmcnt(10)
    v_mfma_f32_16x16x32_bf16 v[16:19], v[96:99], v[88:91], v[16:19]
    ds_read_b64_tr_b16 v[134:135], v8 offset:59392
    v_mfma_f32_16x16x32_bf16 v[20:23], v[96:99], v[92:95], v[20:23]
    ds_read_b64_tr_b16 v[136:137], v9 offset:57344
    v_mfma_f32_16x16x32_bf16 v[24:27], v[100:103], v[88:91], v[24:27]
    ds_read_b64_tr_b16 v[138:139], v9 offset:59392
    v_mfma_f32_16x16x32_bf16 v[28:31], v[100:103], v[92:95], v[28:31]
    ds_read_b128 v[172:175], v12 offset:35840
    v_mfma_f32_16x16x32_bf16 v[32:35], v[104:107], v[88:91], v[32:35]
    v_mfma_f32_16x16x32_bf16 v[36:39], v[104:107], v[92:95], v[36:39]
    v_mfma_f32_16x16x32_bf16 v[40:43], v[108:111], v[88:91], v[40:43]
    v_mfma_f32_16x16x32_bf16 v[44:47], v[108:111], v[92:95], v[44:47]
    v_mfma_f32_16x16x32_bf16 v[48:51], v[112:115], v[88:91], v[48:51]
    v_mfma_f32_16x16x32_bf16 v[52:55], v[112:115], v[92:95], v[52:55]
    v_mfma_f32_16x16x32_bf16 v[56:59], v[116:119], v[88:91], v[56:59]
    v_mfma_f32_16x16x32_bf16 v[60:63], v[116:119], v[92:95], v[60:63]
    v_mfma_f32_16x16x32_bf16 v[64:67], v[120:123], v[88:91], v[64:67]
    v_mfma_f32_16x16x32_bf16 v[68:71], v[120:123], v[92:95], v[68:71]
    s_waitcnt lgkmcnt(0)
    s_barrier
    v_mfma_f32_16x16x32_bf16 v[72:75], v[124:127], v[88:91], v[72:75]
    ds_read_b128 v[96:99], v11 offset:0
    v_mfma_f32_16x16x32_bf16 v[76:79], v[124:127], v[92:95], v[76:79]
    ds_read_b128 v[100:103], v11 offset:1024
    v_mfma_f32_16x16x32_bf16 v[80:83], v[128:131], v[88:91], v[80:83]
    ds_read_b128 v[104:107], v11 offset:2048
    v_mfma_f32_16x16x32_bf16 v[84:87], v[128:131], v[92:95], v[84:87]
    ds_read_b128 v[108:111], v11 offset:3072
    v_mfma_f32_16x16x32_bf16 v[16:19], v[140:143], v[132:135], v[16:19]
    ds_read_b128 v[112:115], v11 offset:4096
    v_mfma_f32_16x16x32_bf16 v[20:23], v[140:143], v[136:139], v[20:23]
    ds_read_b128 v[116:119], v11 offset:5120
    v_mfma_f32_16x16x32_bf16 v[24:27], v[144:147], v[132:135], v[24:27]
    ds_read_b128 v[120:123], v11 offset:6144
    v_mfma_f32_16x16x32_bf16 v[28:31], v[144:147], v[136:139], v[28:31]
    ds_read_b128 v[124:127], v11 offset:7168
    v_mfma_f32_16x16x32_bf16 v[32:35], v[148:151], v[132:135], v[32:35]
    ds_read_b64_tr_b16 v[88:89], v8 offset:0
    v_mfma_f32_16x16x32_bf16 v[36:39], v[148:151], v[136:139], v[36:39]
    ds_read_b64_tr_b16 v[90:91], v8 offset:2048
    v_mfma_f32_16x16x32_bf16 v[40:43], v[152:155], v[132:135], v[40:43]
    ds_read_b64_tr_b16 v[92:93], v9 offset:0
    v_mfma_f32_16x16x32_bf16 v[44:47], v[152:155], v[136:139], v[44:47]
    ds_read_b64_tr_b16 v[94:95], v9 offset:2048
    v_mfma_f32_16x16x32_bf16 v[48:51], v[156:159], v[132:135], v[48:51]
    ds_read_b128 v[128:131], v11 offset:8192
    v_mfma_f32_16x16x32_bf16 v[52:55], v[156:159], v[136:139], v[52:55]
    ds_read_b128 v[140:143], v11 offset:9216
    v_mfma_f32_16x16x32_bf16 v[56:59], v[160:163], v[132:135], v[56:59]
    ds_read_b128 v[144:147], v11 offset:10240
    v_mfma_f32_16x16x32_bf16 v[60:63], v[160:163], v[136:139], v[60:63]
    ds_read_b128 v[148:151], v11 offset:11264
    v_mfma_f32_16x16x32_bf16 v[64:67], v[164:167], v[132:135], v[64:67]
    ds_read_b128 v[152:155], v11 offset:12288
    v_mfma_f32_16x16x32_bf16 v[68:71], v[164:167], v[136:139], v[68:71]
    ds_read_b128 v[156:159], v11 offset:13312
    v_mfma_f32_16x16x32_bf16 v[72:75], v[168:171], v[132:135], v[72:75]
    ds_read_b128 v[160:163], v11 offset:14336
    v_mfma_f32_16x16x32_bf16 v[76:79], v[168:171], v[136:139], v[76:79]
    ds_read_b128 v[164:167], v11 offset:15360
    v_mfma_f32_16x16x32_bf16 v[80:83], v[172:175], v[132:135], v[80:83]
    ds_read_b128 v[168:171], v11 offset:16384
    v_mfma_f32_16x16x32_bf16 v[84:87], v[172:175], v[136:139], v[84:87]
    ds_read_b64_tr_b16 v[132:133], v8 offset:8192
    s_waitcnt lgkmcnt(10)
    v_mfma_f32_16x16x32_bf16 v[16:19], v[96:99], v[88:91], v[16:19]
    ds_read_b64_tr_b16 v[134:135], v8 offset:10240
    v_mfma_f32_16x16x32_bf16 v[20:23], v[96:99], v[92:95], v[20:23]
    ds_read_b64_tr_b16 v[136:137], v9 offset:8192
    v_mfma_f32_16x16x32_bf16 v[24:27], v[100:103], v[88:91], v[24:27]
    ds_read_b64_tr_b16 v[138:139], v9 offset:10240
    v_mfma_f32_16x16x32_bf16 v[28:31], v[100:103], v[92:95], v[28:31]
    ds_read_b128 v[172:175], v11 offset:17408
    v_mfma_f32_16x16x32_bf16 v[32:35], v[104:107], v[88:91], v[32:35]
    v_mfma_f32_16x16x32_bf16 v[36:39], v[104:107], v[92:95], v[36:39]
    v_mfma_f32_16x16x32_bf16 v[40:43], v[108:111], v[88:91], v[40:43]
    v_mfma_f32_16x16x32_bf16 v[44:47], v[108:111], v[92:95], v[44:47]
    v_mfma_f32_16x16x32_bf16 v[48:51], v[112:115], v[88:91], v[48:51]
    v_mfma_f32_16x16x32_bf16 v[52:55], v[112:115], v[92:95], v[52:55]
    v_mfma_f32_16x16x32_bf16 v[56:59], v[116:119], v[88:91], v[56:59]
    v_mfma_f32_16x16x32_bf16 v[60:63], v[116:119], v[92:95], v[60:63]
    v_mfma_f32_16x16x32_bf16 v[64:67], v[120:123], v[88:91], v[64:67]
    v_mfma_f32_16x16x32_bf16 v[68:71], v[120:123], v[92:95], v[68:71]
    s_waitcnt lgkmcnt(0)
    s_barrier
    v_mfma_f32_16x16x32_bf16 v[72:75], v[124:127], v[88:91], v[72:75]
    ds_read_b128 v[96:99], v11 offset:18432
    v_mfma_f32_16x16x32_bf16 v[76:79], v[124:127], v[92:95], v[76:79]
    ds_read_b128 v[100:103], v11 offset:19456
    v_mfma_f32_16x16x32_bf16 v[80:83], v[128:131], v[88:91], v[80:83]
    ds_read_b128 v[104:107], v11 offset:20480
    v_mfma_f32_16x16x32_bf16 v[84:87], v[128:131], v[92:95], v[84:87]
    ds_read_b128 v[108:111], v11 offset:21504
    v_mfma_f32_16x16x32_bf16 v[16:19], v[140:143], v[132:135], v[16:19]
    ds_read_b128 v[112:115], v11 offset:22528
    v_mfma_f32_16x16x32_bf16 v[20:23], v[140:143], v[136:139], v[20:23]
    ds_read_b128 v[116:119], v11 offset:23552
    v_mfma_f32_16x16x32_bf16 v[24:27], v[144:147], v[132:135], v[24:27]
    ds_read_b128 v[120:123], v11 offset:24576
    v_mfma_f32_16x16x32_bf16 v[28:31], v[144:147], v[136:139], v[28:31]
    ds_read_b128 v[124:127], v11 offset:25600
    v_mfma_f32_16x16x32_bf16 v[32:35], v[148:151], v[132:135], v[32:35]
    ds_read_b64_tr_b16 v[88:89], v8 offset:16384
    v_mfma_f32_16x16x32_bf16 v[36:39], v[148:151], v[136:139], v[36:39]
    ds_read_b64_tr_b16 v[90:91], v8 offset:18432
    v_mfma_f32_16x16x32_bf16 v[40:43], v[152:155], v[132:135], v[40:43]
    ds_read_b64_tr_b16 v[92:93], v9 offset:16384
    v_mfma_f32_16x16x32_bf16 v[44:47], v[152:155], v[136:139], v[44:47]
    ds_read_b64_tr_b16 v[94:95], v9 offset:18432
    v_mfma_f32_16x16x32_bf16 v[48:51], v[156:159], v[132:135], v[48:51]
    ds_read_b128 v[128:131], v11 offset:26624
    v_mfma_f32_16x16x32_bf16 v[52:55], v[156:159], v[136:139], v[52:55]
    ds_read_b128 v[140:143], v11 offset:27648
    v_mfma_f32_16x16x32_bf16 v[56:59], v[160:163], v[132:135], v[56:59]
    ds_read_b128 v[144:147], v11 offset:28672
    v_mfma_f32_16x16x32_bf16 v[60:63], v[160:163], v[136:139], v[60:63]
    ds_read_b128 v[148:151], v11 offset:29696
    v_mfma_f32_16x16x32_bf16 v[64:67], v[164:167], v[132:135], v[64:67]
    ds_read_b128 v[152:155], v11 offset:30720
    v_mfma_f32_16x16x32_bf16 v[68:71], v[164:167], v[136:139], v[68:71]
    ds_read_b128 v[156:159], v11 offset:31744
    v_mfma_f32_16x16x32_bf16 v[72:75], v[168:171], v[132:135], v[72:75]
    ds_read_b128 v[160:163], v11 offset:32768
    v_mfma_f32_16x16x32_bf16 v[76:79], v[168:171], v[136:139], v[76:79]
    ds_read_b128 v[164:167], v11 offset:33792
    v_mfma_f32_16x16x32_bf16 v[80:83], v[172:175], v[132:135], v[80:83]
    ds_read_b128 v[168:171], v11 offset:34816
    v_mfma_f32_16x16x32_bf16 v[84:87], v[172:175], v[136:139], v[84:87]
    ds_read_b64_tr_b16 v[132:133], v8 offset:24576
    s_waitcnt lgkmcnt(10)
    v_mfma_f32_16x16x32_bf16 v[16:19], v[96:99], v[88:91], v[16:19]
    ds_read_b64_tr_b16 v[134:135], v8 offset:26624
    v_mfma_f32_16x16x32_bf16 v[20:23], v[96:99], v[92:95], v[20:23]
    ds_read_b64_tr_b16 v[136:137], v9 offset:24576
    v_mfma_f32_16x16x32_bf16 v[24:27], v[100:103], v[88:91], v[24:27]
    ds_read_b64_tr_b16 v[138:139], v9 offset:26624
    v_mfma_f32_16x16x32_bf16 v[28:31], v[100:103], v[92:95], v[28:31]
    ds_read_b128 v[172:175], v11 offset:35840
    v_mfma_f32_16x16x32_bf16 v[32:35], v[104:107], v[88:91], v[32:35]
    v_mfma_f32_16x16x32_bf16 v[36:39], v[104:107], v[92:95], v[36:39]
    v_mfma_f32_16x16x32_bf16 v[40:43], v[108:111], v[88:91], v[40:43]
    v_mfma_f32_16x16x32_bf16 v[44:47], v[108:111], v[92:95], v[44:47]
    v_mfma_f32_16x16x32_bf16 v[48:51], v[112:115], v[88:91], v[48:51]
    v_mfma_f32_16x16x32_bf16 v[52:55], v[112:115], v[92:95], v[52:55]
    v_mfma_f32_16x16x32_bf16 v[56:59], v[116:119], v[88:91], v[56:59]
    v_mfma_f32_16x16x32_bf16 v[60:63], v[116:119], v[92:95], v[60:63]
    v_mfma_f32_16x16x32_bf16 v[64:67], v[120:123], v[88:91], v[64:67]
    v_mfma_f32_16x16x32_bf16 v[68:71], v[120:123], v[92:95], v[68:71]
    s_waitcnt lgkmcnt(0)
    s_barrier
    v_mfma_f32_16x16x32_bf16 v[72:75], v[124:127], v[88:91], v[72:75]
    ds_read_b128 v[96:99], v12 offset:0
    v_mfma_f32_16x16x32_bf16 v[76:79], v[124:127], v[92:95], v[76:79]
    ds_read_b128 v[100:103], v12 offset:1024
    v_mfma_f32_16x16x32_bf16 v[80:83], v[128:131], v[88:91], v[80:83]
    ds_read_b128 v[104:107], v12 offset:2048
    v_mfma_f32_16x16x32_bf16 v[84:87], v[128:131], v[92:95], v[84:87]
    ds_read_b128 v[108:111], v12 offset:3072
    v_mfma_f32_16x16x32_bf16 v[16:19], v[140:143], v[132:135], v[16:19]
    ds_read_b128 v[112:115], v12 offset:4096
    v_mfma_f32_16x16x32_bf16 v[20:23], v[140:143], v[136:139], v[20:23]
    ds_read_b128 v[116:119], v12 offset:5120
    v_mfma_f32_16x16x32_bf16 v[24:27], v[144:147], v[132:135], v[24:27]
    ds_read_b128 v[120:123], v12 offset:6144
    v_mfma_f32_16x16x32_bf16 v[28:31], v[144:147], v[136:139], v[28:31]
    ds_read_b128 v[124:127], v12 offset:7168
    v_mfma_f32_16x16x32_bf16 v[32:35], v[148:151], v[132:135], v[32:35]
    ds_read_b64_tr_b16 v[88:89], v8 offset:32768
    v_mfma_f32_16x16x32_bf16 v[36:39], v[148:151], v[136:139], v[36:39]
    ds_read_b64_tr_b16 v[90:91], v8 offset:34816
    v_mfma_f32_16x16x32_bf16 v[40:43], v[152:155], v[132:135], v[40:43]
    ds_read_b64_tr_b16 v[92:93], v9 offset:32768
    v_mfma_f32_16x16x32_bf16 v[44:47], v[152:155], v[136:139], v[44:47]
    ds_read_b64_tr_b16 v[94:95], v9 offset:34816
    v_mfma_f32_16x16x32_bf16 v[48:51], v[156:159], v[132:135], v[48:51]
    ds_read_b128 v[128:131], v12 offset:8192
    v_mfma_f32_16x16x32_bf16 v[52:55], v[156:159], v[136:139], v[52:55]
    ds_read_b128 v[140:143], v12 offset:9216
    v_mfma_f32_16x16x32_bf16 v[56:59], v[160:163], v[132:135], v[56:59]
    ds_read_b128 v[144:147], v12 offset:10240
    v_mfma_f32_16x16x32_bf16 v[60:63], v[160:163], v[136:139], v[60:63]
    ds_read_b128 v[148:151], v12 offset:11264
    v_mfma_f32_16x16x32_bf16 v[64:67], v[164:167], v[132:135], v[64:67]
    ds_read_b128 v[152:155], v12 offset:12288
    v_mfma_f32_16x16x32_bf16 v[68:71], v[164:167], v[136:139], v[68:71]
    ds_read_b128 v[156:159], v12 offset:13312
    v_mfma_f32_16x16x32_bf16 v[72:75], v[168:171], v[132:135], v[72:75]
    ds_read_b128 v[160:163], v12 offset:14336
    v_mfma_f32_16x16x32_bf16 v[76:79], v[168:171], v[136:139], v[76:79]
    ds_read_b128 v[164:167], v12 offset:15360
    v_mfma_f32_16x16x32_bf16 v[80:83], v[172:175], v[132:135], v[80:83]
    ds_read_b128 v[168:171], v12 offset:16384
    v_mfma_f32_16x16x32_bf16 v[84:87], v[172:175], v[136:139], v[84:87]
    ds_read_b64_tr_b16 v[132:133], v8 offset:40960
    ds_read_b64_tr_b16 v[134:135], v8 offset:43008
    ds_read_b64_tr_b16 v[136:137], v9 offset:40960
    ds_read_b64_tr_b16 v[138:139], v9 offset:43008
    ds_read_b128 v[172:175], v12 offset:17408
    s_add_u32 s91, s91, 1
    s_cmp_lt_u32 s91, 4
    s_cbranch_scc1 parallel_sum__ssm_conv_s5__mixer_token_mlp__prompt_kernel_cloop_107
    s_waitcnt lgkmcnt(14)
    v_mfma_f32_16x16x32_bf16 v[16:19], v[96:99], v[88:91], v[16:19]
    v_mfma_f32_16x16x32_bf16 v[20:23], v[96:99], v[92:95], v[20:23]
    v_mfma_f32_16x16x32_bf16 v[24:27], v[100:103], v[88:91], v[24:27]
    v_mfma_f32_16x16x32_bf16 v[28:31], v[100:103], v[92:95], v[28:31]
    v_mfma_f32_16x16x32_bf16 v[32:35], v[104:107], v[88:91], v[32:35]
    v_mfma_f32_16x16x32_bf16 v[36:39], v[104:107], v[92:95], v[36:39]
    v_mfma_f32_16x16x32_bf16 v[40:43], v[108:111], v[88:91], v[40:43]
    v_mfma_f32_16x16x32_bf16 v[44:47], v[108:111], v[92:95], v[44:47]
    v_mfma_f32_16x16x32_bf16 v[48:51], v[112:115], v[88:91], v[48:51]
    v_mfma_f32_16x16x32_bf16 v[52:55], v[112:115], v[92:95], v[52:55]
    v_mfma_f32_16x16x32_bf16 v[56:59], v[116:119], v[88:91], v[56:59]
    v_mfma_f32_16x16x32_bf16 v[60:63], v[116:119], v[92:95], v[60:63]
    v_mfma_f32_16x16x32_bf16 v[64:67], v[120:123], v[88:91], v[64:67]
    v_mfma_f32_16x16x32_bf16 v[68:71], v[120:123], v[92:95], v[68:71]
    s_waitcnt lgkmcnt(0)
    s_barrier
    v_mfma_f32_16x16x32_bf16 v[72:75], v[124:127], v[88:91], v[72:75]
    ds_read_b128 v[96:99], v12 offset:18432
    v_mfma_f32_16x16x32_bf16 v[76:79], v[124:127], v[92:95], v[76:79]
    ds_read_b128 v[100:103], v12 offset:19456
    v_mfma_f32_16x16x32_bf16 v[80:83], v[128:131], v[88:91], v[80:83]
    ds_read_b128 v[104:107], v12 offset:20480
    v_mfma_f32_16x16x32_bf16 v[84:87], v[128:131], v[92:95], v[84:87]
    ds_read_b128 v[108:111], v12 offset:21504
    v_mfma_f32_16x16x32_bf16 v[16:19], v[140:143], v[132:135], v[16:19]
    ds_read_b128 v[112:115], v12 offset:22528
    v_mfma_f32_16x16x32_bf16 v[20:23], v[140:143], v[136:139], v[20:23]
    ds_read_b128 v[116:119], v12 offset:23552
    v_mfma_f32_16x16x32_bf16 v[24:27], v[144:147], v[132:135], v[24:27]
    ds_read_b128 v[120:123], v12 offset:24576
    v_mfma_f32_16x16x32_bf16 v[28:31], v[144:147], v[136:139], v[28:31]
    ds_read_b128 v[124:127], v12 offset:25600
    v_mfma_f32_16x16x32_bf16 v[32:35], v[148:151], v[132:135], v[32:35]
    ds_read_b64_tr_b16 v[88:89], v8 offset:49152
    v_mfma_f32_16x16x32_bf16 v[36:39], v[148:151], v[136:139], v[36:39]
    ds_read_b64_tr_b16 v[90:91], v8 offset:51200
    v_mfma_f32_16x16x32_bf16 v[40:43], v[152:155], v[132:135], v[40:43]
    ds_read_b64_tr_b16 v[92:93], v9 offset:49152
    v_mfma_f32_16x16x32_bf16 v[44:47], v[152:155], v[136:139], v[44:47]
    ds_read_b64_tr_b16 v[94:95], v9 offset:51200
    v_mfma_f32_16x16x32_bf16 v[48:51], v[156:159], v[132:135], v[48:51]
    ds_read_b128 v[128:131], v12 offset:26624
    v_mfma_f32_16x16x32_bf16 v[52:55], v[156:159], v[136:139], v[52:55]
    ds_read_b128 v[140:143], v12 offset:27648
    v_mfma_f32_16x16x32_bf16 v[56:59], v[160:163], v[132:135], v[56:59]
    ds_read_b128 v[144:147], v12 offset:28672
    v_mfma_f32_16x16x32_bf16 v[60:63], v[160:163], v[136:139], v[60:63]
    ds_read_b128 v[148:151], v12 offset:29696
    v_mfma_f32_16x16x32_bf16 v[64:67], v[164:167], v[132:135], v[64:67]
    ds_read_b128 v[152:155], v12 offset:30720
    v_mfma_f32_16x16x32_bf16 v[68:71], v[164:167], v[136:139], v[68:71]
    ds_read_b128 v[156:159], v12 offset:31744
    v_mfma_f32_16x16x32_bf16 v[72:75], v[168:171], v[132:135], v[72:75]
    ds_read_b128 v[160:163], v12 offset:32768
    v_mfma_f32_16x16x32_bf16 v[76:79], v[168:171], v[136:139], v[76:79]
    ds_read_b128 v[164:167], v12 offset:33792
    v_mfma_f32_16x16x32_bf16 v[80:83], v[172:175], v[132:135], v[80:83]
    ds_read_b128 v[168:171], v12 offset:34816
    v_mfma_f32_16x16x32_bf16 v[84:87], v[172:175], v[136:139], v[84:87]
    ds_read_b64_tr_b16 v[132:133], v8 offset:57344
    s_waitcnt lgkmcnt(10)
    v_mfma_f32_16x16x32_bf16 v[16:19], v[96:99], v[88:91], v[16:19]
    ds_read_b64_tr_b16 v[134:135], v8 offset:59392
    v_mfma_f32_16x16x32_bf16 v[20:23], v[96:99], v[92:95], v[20:23]
    ds_read_b64_tr_b16 v[136:137], v9 offset:57344
    v_mfma_f32_16x16x32_bf16 v[24:27], v[100:103], v[88:91], v[24:27]
    ds_read_b64_tr_b16 v[138:139], v9 offset:59392
    v_mfma_f32_16x16x32_bf16 v[28:31], v[100:103], v[92:95], v[28:31]
    ds_read_b128 v[172:175], v12 offset:35840
    v_mfma_f32_16x16x32_bf16 v[32:35], v[104:107], v[88:91], v[32:35]
    v_mfma_f32_16x16x32_bf16 v[36:39], v[104:107], v[92:95], v[36:39]
    v_mfma_f32_16x16x32_bf16 v[40:43], v[108:111], v[88:91], v[40:43]
    v_mfma_f32_16x16x32_bf16 v[44:47], v[108:111], v[92:95], v[44:47]
    v_mfma_f32_16x16x32_bf16 v[48:51], v[112:115], v[88:91], v[48:51]
    v_mfma_f32_16x16x32_bf16 v[52:55], v[112:115], v[92:95], v[52:55]
    v_mfma_f32_16x16x32_bf16 v[56:59], v[116:119], v[88:91], v[56:59]
    v_mfma_f32_16x16x32_bf16 v[60:63], v[116:119], v[92:95], v[60:63]
    v_mfma_f32_16x16x32_bf16 v[64:67], v[120:123], v[88:91], v[64:67]
    v_mfma_f32_16x16x32_bf16 v[68:71], v[120:123], v[92:95], v[68:71]
    v_mfma_f32_16x16x32_bf16 v[72:75], v[124:127], v[88:91], v[72:75]
    v_mfma_f32_16x16x32_bf16 v[76:79], v[124:127], v[92:95], v[76:79]
    s_waitcnt lgkmcnt(13)
    v_mfma_f32_16x16x32_bf16 v[80:83], v[128:131], v[88:91], v[80:83]
    v_mfma_f32_16x16x32_bf16 v[84:87], v[128:131], v[92:95], v[84:87]
    s_waitcnt lgkmcnt(0)
    s_cmp_eq_u32 s3, s7
    s_cbranch_scc1 parallel_sum__ssm_conv_s5__mixer_token_mlp__prompt_kernel_own_108
    v_mfma_f32_16x16x32_bf16 v[16:19], v[140:143], v[132:135], v[16:19]
    v_mfma_f32_16x16x32_bf16 v[20:23], v[140:143], v[136:139], v[20:23]
    v_mfma_f32_16x16x32_bf16 v[24:27], v[144:147], v[132:135], v[24:27]
    v_mfma_f32_16x16x32_bf16 v[28:31], v[144:147], v[136:139], v[28:31]
    v_mfma_f32_16x16x32_bf16 v[32:35], v[148:151], v[132:135], v[32:35]
    v_mfma_f32_16x16x32_bf16 v[36:39], v[148:151], v[136:139], v[36:39]
    v_mfma_f32_16x16x32_bf16 v[40:43], v[152:155], v[132:135], v[40:43]
    v_mfma_f32_16x16x32_bf16 v[44:47], v[152:155], v[136:139], v[44:47]
    s_nop 1
    v_cvt_pk_bf16_f32 v88, v16, v17
    v_cvt_pk_bf16_f32 v89, v18, v19
    v_cvt_pk_bf16_f32 v90, v20, v21
    v_cvt_pk_bf16_f32 v91, v22, v23
    buffer_store_dwordx4 v[88:91], v13, s[52:55], s15 offen offset:0 sc1
    v_mfma_f32_16x16x32_bf16 v[48:51], v[156:159], v[132:135], v[48:51]
    v_mfma_f32_16x16x32_bf16 v[52:55], v[156:159], v[136:139], v[52:55]
    v_cvt_pk_bf16_f32 v92, v24, v25
    v_cvt_pk_bf16_f32 v93, v26, v27
    v_cvt_pk_bf16_f32 v94, v28, v29
    v_cvt_pk_bf16_f32 v95, v30, v31
    buffer_store_dwordx4 v[92:95], v13, s[52:55], s15 offen offset:1024 sc1
    v_mfma_f32_16x16x32_bf16 v[56:59], v[160:163], v[132:135], v[56:59]
    v_mfma_f32_16x16x32_bf16 v[60:63], v[160:163], v[136:139], v[60:63]
    v_cvt_pk_bf16_f32 v96, v32, v33
    v_cvt_pk_bf16_f32 v97, v34, v35
    v_cvt_pk_bf16_f32 v98, v36, v37
    v_cvt_pk_bf16_f32 v99, v38, v39
    buffer_store_dwordx4 v[96:99], v13, s[52:55], s15 offen offset:2048 sc1
    v_mfma_f32_16x16x32_bf16 v[64:67], v[164:167], v[132:135], v[64:67]
    v_mfma_f32_16x16x32_bf16 v[68:71], v[164:167], v[136:139], v[68:71]
    v_cvt_pk_bf16_f32 v100, v40, v41
    v_cvt_pk_bf16_f32 v101, v42, v43
    v_cvt_pk_bf16_f32 v102, v44, v45
    v_cvt_pk_bf16_f32 v103, v46, v47
    buffer_store_dwordx4 v[100:103], v13, s[52:55], s15 offen offset:3072 sc1
    s_add_u32 s15, s15, 4096
    v_mfma_f32_16x16x32_bf16 v[72:75], v[168:171], v[132:135], v[72:75]
    v_mfma_f32_16x16x32_bf16 v[76:79], v[168:171], v[136:139], v[76:79]
    v_cvt_pk_bf16_f32 v104, v48, v49
    v_cvt_pk_bf16_f32 v105, v50, v51
    v_cvt_pk_bf16_f32 v106, v52, v53
    v_cvt_pk_bf16_f32 v107, v54, v55
    buffer_store_dwordx4 v[104:107], v13, s[52:55], s15 offen offset:0 sc1
    v_mfma_f32_16x16x32_bf16 v[80:83], v[172:175], v[132:135], v[80:83]
    v_mfma_f32_16x16x32_bf16 v[84:87], v[172:175], v[136:139], v[84:87]
    v_cvt_pk_bf16_f32 v108, v56, v57
    v_cvt_pk_bf16_f32 v109, v58, v59
    v_cvt_pk_bf16_f32 v110, v60, v61
    v_cvt_pk_bf16_f32 v111, v62, v63
    buffer_store_dwordx4 v[108:111], v13, s[52:55], s15 offen offset:1024 sc1
    s_nop 3
    v_cvt_pk_bf16_f32 v112, v64, v65
    v_cvt_pk_bf16_f32 v113, v66, v67
    v_cvt_pk_bf16_f32 v114, v68, v69
    v_cvt_pk_bf16_f32 v115, v70, v71
    buffer_store_dwordx4 v[112:115], v13, s[52:55], s15 offen offset:2048 sc1
    s_nop 3
    v_cvt_pk_bf16_f32 v116, v72, v73
    v_cvt_pk_bf16_f32 v117, v74, v75
    v_cvt_pk_bf16_f32 v118, v76, v77
    v_cvt_pk_bf16_f32 v119, v78, v79
    buffer_store_dwordx4 v[116:119], v13, s[52:55], s15 offen offset:3072 sc1
    s_add_u32 s15, s15, 4096
    s_nop 3
    v_cvt_pk_bf16_f32 v120, v80, v81
    v_cvt_pk_bf16_f32 v121, v82, v83
    v_cvt_pk_bf16_f32 v122, v84, v85
    v_cvt_pk_bf16_f32 v123, v86, v87
    buffer_store_dwordx4 v[120:123], v13, s[52:55], s15 offen offset:0 sc1
    v_mov_b32 v8, 0
    v_mov_b32 v9, 1
    s_waitcnt vmcnt(0)
    s_mov_b64 exec, 1
    buffer_store_dword v9, v8, s[56:59], s14 offen sc1
    s_mov_b64 exec, -1
    s_branch parallel_sum__ssm_conv_s5__mixer_token_mlp__prompt_kernel_sent_109
parallel_sum__ssm_conv_s5__mixer_token_mlp__prompt_kernel_own_108:
    v_mfma_f32_16x16x32_bf16 v[16:19], v[140:143], v[132:135], v[16:19]
    v_mfma_f32_16x16x32_bf16 v[20:23], v[140:143], v[136:139], v[20:23]
    v_mfma_f32_16x16x32_bf16 v[24:27], v[144:147], v[132:135], v[24:27]
    v_mfma_f32_16x16x32_bf16 v[28:31], v[144:147], v[136:139], v[28:31]
    v_mfma_f32_16x16x32_bf16 v[32:35], v[148:151], v[132:135], v[32:35]
    v_mfma_f32_16x16x32_bf16 v[36:39], v[148:151], v[136:139], v[36:39]
    v_mfma_f32_16x16x32_bf16 v[40:43], v[152:155], v[132:135], v[40:43]
    v_mfma_f32_16x16x32_bf16 v[44:47], v[152:155], v[136:139], v[44:47]
    s_nop 1
    ds_write_b128 v13, v[16:19] offset:0
    ds_write_b128 v13, v[20:23] offset:1024
    v_mfma_f32_16x16x32_bf16 v[48:51], v[156:159], v[132:135], v[48:51]
    v_mfma_f32_16x16x32_bf16 v[52:55], v[156:159], v[136:139], v[52:55]
    ds_write_b128 v13, v[24:27] offset:2048
    ds_write_b128 v13, v[28:31] offset:3072
    v_mfma_f32_16x16x32_bf16 v[56:59], v[160:163], v[132:135], v[56:59]
    v_mfma_f32_16x16x32_bf16 v[60:63], v[160:163], v[136:139], v[60:63]
    ds_write_b128 v13, v[32:35] offset:4096
    ds_write_b128 v13, v[36:39] offset:5120
    v_mfma_f32_16x16x32_bf16 v[64:67], v[164:167], v[132:135], v[64:67]
    v_mfma_f32_16x16x32_bf16 v[68:71], v[164:167], v[136:139], v[68:71]
    ds_write_b128 v13, v[40:43] offset:6144
    ds_write_b128 v13, v[44:47] offset:7168
    v_mfma_f32_16x16x32_bf16 v[72:75], v[168:171], v[132:135], v[72:75]
    v_mfma_f32_16x16x32_bf16 v[76:79], v[168:171], v[136:139], v[76:79]
    ds_write_b128 v13, v[48:51] offset:8192
    ds_write_b128 v13, v[52:55] offset:9216
    v_mfma_f32_16x16x32_bf16 v[80:83], v[172:175], v[132:135], v[80:83]
    v_mfma_f32_16x16x32_bf16 v[84:87], v[172:175], v[136:139], v[84:87]
    ds_write_b128 v13, v[56:59] offset:10240
    ds_write_b128 v13, v[60:63] offset:11264
    s_nop 3
    ds_write_b128 v13, v[64:67] offset:12288
    ds_write_b128 v13, v[68:71] offset:13312
    s_nop 3
    ds_write_b128 v13, v[72:75] offset:14336
    ds_write_b128 v13, v[76:79] offset:15360
    s_nop 3
    ds_write_b128 v13, v[80:83] offset:16384
    ds_write_b128 v13, v[84:87] offset:17408
    v_mov_b32 v8, 144896
    v_mov_b32 v9, 1
    ds_write_b32 v8, v9 offset:20
parallel_sum__ssm_conv_s5__mixer_token_mlp__prompt_kernel_sent_109:
    s_endpgm
parallel_sum__ssm_conv_s5__mixer_token_mlp__prompt_kernel_hl0_78:
    v_lshlrev_b32 v12, 4, v2
    v_add_u32 v13, 4096, v12
    s_add_u32 s60, s48, 0x280000
    s_addc_u32 s61, s49, 0
    s_mov_b32 s62, 0x480000
    s_mov_b32 s63, 0x00020000
    s_add_u32 s62, s5, 1
    s_mul_i32 s62, s62, 294912
    s_add_u32 s56, s48, 0x700000
    s_addc_u32 s57, s49, 0
    s_mov_b32 s58, 0x654000
    s_mov_b32 s59, 0x00020000
    s_mov_b32 s52, s40
    s_mov_b32 s53, s41
    s_mov_b32 s54, 0x1200000
    s_mov_b32 s55, 0x00020000
    s_mul_i32 s15, s6, 9
    s_add_u32 s81, s80, s8
    s_add_u32 s82, s81, 144
    s_mul_i32 s82, s82, 36
    s_add_u32 s82, s82, s15
    s_lshl_b32 s82, s82, 10
    s_mul_i32 s13, s5, 36
    s_add_u32 s81, s81, s13
    s_lshl_b32 s81, s81, 13
    s_mul_i32 s12, s7, 1152
    s_lshl_b32 s13, s8, 5
    s_add_u32 s12, s12, s13
    s_lshl_b32 s12, s12, 12
    s_lshl_b32 s13, s5, 8
    s_add_u32 s12, s12, s13
    s_mul_i32 s80, s7, 36
    s_add_u32 s14, s80, s8
    s_mul_i32 s14, s14, 36
    s_add_u32 s14, s14, s15
    s_lshl_b32 s14, s14, 10
    s_mul_i32 s83, s6, 3
    s_lshr_b32 s83, s83, 1
    s_mul_i32 s13, s7, 54
    s_add_u32 s83, s83, s13
    s_lshl_b32 s83, s83, 7
    s_add_u32 s83, s83, 51200
    s_mov_b64 s[84:85], 0
    v_lshrrev_b32 v8, 3, v2
    v_mul_u32_u24 v8, 4096, v8
    v_and_b32 v14, 7, v2
    v_lshlrev_b32 v15, 1, v4
    v_xor_b32 v14, v14, v15
    v_lshl_add_u32 v8, v14, 4, v8
    v_add_u32 v9, 31744, v8
    v_add_u32 v10, 63488, v8
    v_add_u32 v11, 95232, v8
    s_mul_i32 s10, s8, 9
    s_mul_i32 s90, s67, 5
    s_add_u32 s10, s10, s90
    s_lshl_b32 s10, s10, 10
    s_add_u32 s10, s10, 65536
    s_lshl_b32 s90, s90, 10
    s_add_u32 s82, s82, s90
    s_lshl_b32 s89, s67, 12
    s_add_u32 s81, s81, s89
    s_add_u32 s14, s14, s90
    s_lshl_b32 s89, s67, 7
    s_add_u32 s12, s12, s89
    v_mov_b32 v26, 0
    v_mov_b32 v27, 0
    s_mov_b32 s88, 0
    s_branch parallel_sum__ssm_conv_s5__mixer_token_mlp__prompt_kernel_pollck_112
parallel_sum__ssm_conv_s5__mixer_token_mlp__prompt_kernel_poll_110:
    buffer_load_dword v22, v19, s[68:71], s86 offen offset:0 sc1
    buffer_load_dword v23, v18, s[68:71], s87 offen offset:0 sc1
    s_waitcnt vmcnt(0)
parallel_sum__ssm_conv_s5__mixer_token_mlp__prompt_kernel_pollck_112:
    s_add_u32 s88, s88, 1
    s_mov_b64 s[78:79], 0
    v_cmp_gt_u32 vcc, 1, v22
    s_and_b64 vcc, vcc, s[72:73]
    s_or_b64 s[78:79], s[78:79], vcc
    v_cmp_gt_u32 vcc, 1, v23
    s_and_b64 vcc, vcc, s[74:75]
    s_or_b64 s[78:79], s[78:79], vcc
    s_cbranch_scc0 parallel_sum__ssm_conv_s5__mixer_token_mlp__prompt_kernel_pollend_111
    s_sleep 6
    s_cmp_lt_u32 s88, 0x8000
    s_cbranch_scc1 parallel_sum__ssm_conv_s5__mixer_token_mlp__prompt_kernel_poll_110
parallel_sum__ssm_conv_s5__mixer_token_mlp__prompt_kernel_pollend_111:
    s_mov_b32 s74, -1
    s_mov_b32 s75, 15
    s_mov_b32 s86, s8
    s_add_u32 m0, s9, 16384
    s_nop 0
    buffer_load_dwordx4 v12, s[60:63], s81 offen offset:0 sc1 lds
    buffer_load_dwordx4 v12, s[60:63], s81 offen offset:1024 sc1 lds
    buffer_load_dwordx4 v12, s[60:63], s81 offen offset:2048 sc1 lds
    buffer_load_dwordx4 v12, s[60:63], s81 offen offset:3072 sc1 lds
    s_add_u32 s81, s81, 16384
    s_cmp_lg_u32 s67, 0
    s_cbranch_scc1 parallel_sum__ssm_conv_s5__mixer_token_mlp__prompt_kernel_x_113
    s_add_u32 m0, s10, 22528
    s_nop 0
    buffer_load_dwordx4 v13, s[56:59], s82 offen sc1 lds
parallel_sum__ssm_conv_s5__mixer_token_mlp__prompt_kernel_x_113:
    s_add_u32 m0, s10, 18432
    s_nop 0
    buffer_load_dwordx4 v12, s[56:59], s82 offen offset:0 sc1 lds
    buffer_load_dwordx4 v12, s[56:59], s82 offen offset:1024 sc1 lds
    buffer_load_dwordx4 v12, s[56:59], s82 offen offset:2048 sc1 lds
    buffer_load_dwordx4 v12, s[56:59], s82 offen offset:3072 sc1 lds
    s_add_u32 s82, s82, 73728
    s_add_u32 m0, s9, 32768
    s_nop 0
    buffer_load_dwordx4 v12, s[60:63], s81 offen offset:0 sc1 lds
    buffer_load_dwordx4 v12, s[60:63], s81 offen offset:1024 sc1 lds
    buffer_load_dwordx4 v12, s[60:63], s81 offen offset:2048 sc1 lds
    buffer_load_dwordx4 v12, s[60:63], s81 offen offset:3072 sc1 lds
    s_add_u32 s81, s81, 16384
    s_cmp_lg_u32 s67, 0
    s_cbranch_scc1 parallel_sum__ssm_conv_s5__mixer_token_mlp__prompt_kernel_x_114
    s_add_u32 m0, s10, 40960
    s_nop 0
    buffer_load_dwordx4 v13, s[56:59], s82 offen sc1 lds
parallel_sum__ssm_conv_s5__mixer_token_mlp__prompt_kernel_x_114:
    s_add_u32 m0, s10, 36864
    s_nop 0
    buffer_load_dwordx4 v12, s[56:59], s82 offen offset:0 sc1 lds
    buffer_load_dwordx4 v12, s[56:59], s82 offen offset:1024 sc1 lds
    buffer_load_dwordx4 v12, s[56:59], s82 offen offset:2048 sc1 lds
    buffer_load_dwordx4 v12, s[56:59], s82 offen offset:3072 sc1 lds
    s_add_u32 s82, s82, 73728
    s_add_u32 m0, s9, 49152
    s_nop 0
    buffer_load_dwordx4 v12, s[60:63], s81 offen offset:0 sc1 lds
    buffer_load_dwordx4 v12, s[60:63], s81 offen offset:1024 sc1 lds
    buffer_load_dwordx4 v12, s[60:63], s81 offen offset:2048 sc1 lds
    buffer_load_dwordx4 v12, s[60:63], s81 offen offset:3072 sc1 lds
    s_add_u32 s81, s81, 16384
    s_cmp_lg_u32 s67, 0
    s_cbranch_scc1 parallel_sum__ssm_conv_s5__mixer_token_mlp__prompt_kernel_x_115
    s_add_u32 m0, s10, 59392
    s_nop 0
    buffer_load_dwordx4 v13, s[56:59], s82 offen sc1 lds
parallel_sum__ssm_conv_s5__mixer_token_mlp__prompt_kernel_x_115:
    s_add_u32 m0, s10, 55296
    s_nop 0
    buffer_load_dwordx4 v12, s[56:59], s82 offen offset:0 sc1 lds
    buffer_load_dwordx4 v12, s[56:59], s82 offen offset:1024 sc1 lds
    buffer_load_dwordx4 v12, s[56:59], s82 offen offset:2048 sc1 lds
    buffer_load_dwordx4 v12, s[56:59], s82 offen offset:3072 sc1 lds
    s_add_u32 s82, s82, 73728
parallel_sum__ssm_conv_s5__mixer_token_mlp__prompt_kernel_hl_9:
    s_waitcnt vmcnt(16)
    s_barrier
    s_add_u32 m0, s9, 0
    s_nop 0
    buffer_load_dwordx4 v12, s[60:63], s81 offen offset:0 sc1 lds
    buffer_load_dwordx4 v12, s[60:63], s81 offen offset:1024 sc1 lds
    buffer_load_dwordx4 v12, s[60:63], s81 offen offset:2048 sc1 lds
    buffer_load_dwordx4 v12, s[60:63], s81 offen offset:3072 sc1 lds
    s_add_u32 s81, s81, 16384
    s_cmp_lg_u32 s67, 0
    s_cbranch_scc1 parallel_sum__ssm_conv_s5__mixer_token_mlp__prompt_kernel_x_116
    s_add_u32 m0, s10, 4096
    s_nop 0
    buffer_load_dwordx4 v13, s[56:59], s82 offen sc1 lds
parallel_sum__ssm_conv_s5__mixer_token_mlp__prompt_kernel_x_116:
    s_add_u32 m0, s10, 0
    s_nop 0
    buffer_load_dwordx4 v12, s[56:59], s82 offen offset:0 sc1 lds
    buffer_load_dwordx4 v12, s[56:59], s82 offen offset:1024 sc1 lds
    buffer_load_dwordx4 v12, s[56:59], s82 offen offset:2048 sc1 lds
    buffer_load_dwordx4 v12, s[56:59], s82 offen offset:3072 sc1 lds
    s_add_u32 s82, s82, 73728
    s_waitcnt vmcnt(16)
    s_barrier
    s_add_u32 m0, s9, 16384
    s_nop 0
    buffer_load_dwordx4 v12, s[60:63], s81 offen offset:0 sc1 lds
    buffer_load_dwordx4 v12, s[60:63], s81 offen offset:1024 sc1 lds
    buffer_load_dwordx4 v12, s[60:63], s81 offen offset:2048 sc1 lds
    buffer_load_dwordx4 v12, s[60:63], s81 offen offset:3072 sc1 lds
    s_add_u32 s81, s81, 16384
    s_cmp_lg_u32 s67, 0
    s_cbranch_scc1 parallel_sum__ssm_conv_s5__mixer_token_mlp__prompt_kernel_x_117
    s_add_u32 m0, s10, 22528
    s_nop 0
    buffer_load_dwordx4 v13, s[56:59], s82 offen sc1 lds
parallel_sum__ssm_conv_s5__mixer_token_mlp__prompt_kernel_x_117:
    s_add_u32 m0, s10, 18432
    s_nop 0
    buffer_load_dwordx4 v12, s[56:59], s82 offen offset:0 sc1 lds
    buffer_load_dwordx4 v12, s[56:59], s82 offen offset:1024 sc1 lds
    buffer_load_dwordx4 v12, s[56:59], s82 offen offset:2048 sc1 lds
    buffer_load_dwordx4 v12, s[56:59], s82 offen offset:3072 sc1 lds
    s_add_u32 s82, s82, 73728
    s_waitcnt vmcnt(16)
    s_barrier
    s_add_u32 m0, s9, 32768
    s_nop 0
    buffer_load_dwordx4 v8, s[52:55], s12 offen offset:0 lds
    buffer_load_dwordx4 v9, s[52:55], s12 offen offset:1024 lds
    buffer_load_dwordx4 v10, s[52:55], s12 offen offset:2048 lds
    buffer_load_dwordx4 v11, s[52:55], s12 offen offset:3072 lds
    s_add_u32 s12, s12, 262144
    s_waitcnt vmcnt(12)
    s_barrier
    buffer_load_dword v26, v20, s[68:71], s83 offen sc1
    buffer_load_dword v27, v20, s[68:71], s83 offen offset:128 sc1
    s_add_u32 m0, s9, 49152
    s_nop 0
    buffer_load_dwordx4 v8, s[52:55], s12 offen offset:0 lds
    buffer_load_dwordx4 v9, s[52:55], s12 offen offset:1024 lds
    buffer_load_dwordx4 v10, s[52:55], s12 offen offset:2048 lds
    buffer_load_dwordx4 v11, s[52:55], s12 offen offset:3072 lds
    s_add_u32 s12, s12, 262144
    s_waitcnt vmcnt(10)
    s_barrier
    s_waitcnt vmcnt(4)
    v_and_b32 v28, v26, v27
    v_cmp_eq_u32 s[76:77], 1, v28
    s_or_b64 s[84:85], s[84:85], s[76:77]
    s_bitcmp1_b64 s[84:85], s86
    s_cbranch_scc1 parallel_sum__ssm_conv_s5__mixer_token_mlp__prompt_kernel_uok_118
    s_mov_b32 s88, 0
parallel_sum__ssm_conv_s5__mixer_token_mlp__prompt_kernel_upl_119:
    buffer_load_dword v22, v20, s[68:71], s83 offen sc1
    buffer_load_dword v23, v20, s[68:71], s83 offen offset:128 sc1
    s_add_u32 s88, s88, 1
    s_waitcnt vmcnt(0)
    v_and_b32 v22, v22, v23
    v_cmp_eq_u32 s[84:85], 1, v22
    s_cmp_ge_u32 s88, 0x8000
    s_cbranch_scc1 parallel_sum__ssm_conv_s5__mixer_token_mlp__prompt_kernel_uok_118
    s_bitcmp1_b64 s[84:85], s86
    s_cbranch_scc1 parallel_sum__ssm_conv_s5__mixer_token_mlp__prompt_kernel_uok_118
    s_sleep 8
    s_branch parallel_sum__ssm_conv_s5__mixer_token_mlp__prompt_kernel_upl_119
parallel_sum__ssm_conv_s5__mixer_token_mlp__prompt_kernel_uok_118:
    s_add_u32 s86, s86, 2
    s_cmp_lg_u32 s67, 0
    s_cbranch_scc1 parallel_sum__ssm_conv_s5__mixer_token_mlp__prompt_kernel_x_120
    s_add_u32 m0, s10, 40960
    s_nop 0
    buffer_load_dwordx4 v13, s[56:59], s14 offen sc1 lds
parallel_sum__ssm_conv_s5__mixer_token_mlp__prompt_kernel_x_120:
    s_add_u32 m0, s10, 36864
    s_nop 0
    buffer_load_dwordx4 v12, s[56:59], s14 offen offset:0 sc1 lds
    buffer_load_dwordx4 v12, s[56:59], s14 offen offset:1024 sc1 lds
    buffer_load_dwordx4 v12, s[56:59], s14 offen offset:2048 sc1 lds
    buffer_load_dwordx4 v12, s[56:59], s14 offen offset:3072 sc1 lds
    s_add_u32 s14, s14, 73728
    s_bitcmp1_b64 s[84:85], s86
    s_cbranch_scc1 parallel_sum__ssm_conv_s5__mixer_token_mlp__prompt_kernel_uok_121
    s_mov_b32 s88, 0
parallel_sum__ssm_conv_s5__mixer_token_mlp__prompt_kernel_upl_122:
    buffer_load_dword v22, v20, s[68:71], s83 offen sc1
    buffer_load_dword v23, v20, s[68:71], s83 offen offset:128 sc1
    s_add_u32 s88, s88, 1
    s_waitcnt vmcnt(0)
    v_and_b32 v22, v22, v23
    v_cmp_eq_u32 s[84:85], 1, v22
    s_cmp_ge_u32 s88, 0x8000
    s_cbranch_scc1 parallel_sum__ssm_conv_s5__mixer_token_mlp__prompt_kernel_uok_121
    s_bitcmp1_b64 s[84:85], s86
    s_cbranch_scc1 parallel_sum__ssm_conv_s5__mixer_token_mlp__prompt_kernel_uok_121
    s_sleep 8
    s_branch parallel_sum__ssm_conv_s5__mixer_token_mlp__prompt_kernel_upl_122
parallel_sum__ssm_conv_s5__mixer_token_mlp__prompt_kernel_uok_121:
    s_add_u32 s86, s86, 2
    s_cmp_lg_u32 s67, 0
    s_cbranch_scc1 parallel_sum__ssm_conv_s5__mixer_token_mlp__prompt_kernel_x_123
    s_add_u32 m0, s10, 59392
    s_nop 0
    buffer_load_dwordx4 v13, s[56:59], s14 offen sc1 lds
parallel_sum__ssm_conv_s5__mixer_token_mlp__prompt_kernel_x_123:
    s_add_u32 m0, s10, 55296
    s_nop 0
    buffer_load_dwordx4 v12, s[56:59], s14 offen offset:0 sc1 lds
    buffer_load_dwordx4 v12, s[56:59], s14 offen offset:1024 sc1 lds
    buffer_load_dwordx4 v12, s[56:59], s14 offen offset:2048 sc1 lds
    buffer_load_dwordx4 v12, s[56:59], s14 offen offset:3072 sc1 lds
    s_add_u32 s14, s14, 73728
    s_add_u32 m0, s9, 0
    s_nop 0
    buffer_load_dwordx4 v8, s[52:55], s12 offen offset:0 lds
    buffer_load_dwordx4 v9, s[52:55], s12 offen offset:1024 lds
    buffer_load_dwordx4 v10, s[52:55], s12 offen offset:2048 lds
    buffer_load_dwordx4 v11, s[52:55], s12 offen offset:3072 lds
    s_add_u32 s12, s12, 262144
    s_bitcmp1_b64 s[84:85], s86
    s_cbranch_scc1 parallel_sum__ssm_conv_s5__mixer_token_mlp__prompt_kernel_uok_124
    s_mov_b32 s88, 0
parallel_sum__ssm_conv_s5__mixer_token_mlp__prompt_kernel_upl_125:
    buffer_load_dword v22, v20, s[68:71], s83 offen sc1
    buffer_load_dword v23, v20, s[68:71], s83 offen offset:128 sc1
    s_add_u32 s88, s88, 1
    s_waitcnt vmcnt(0)
    v_and_b32 v22, v22, v23
    v_cmp_eq_u32 s[84:85], 1, v22
    s_cmp_ge_u32 s88, 0x8000
    s_cbranch_scc1 parallel_sum__ssm_conv_s5__mixer_token_mlp__prompt_kernel_uok_124
    s_bitcmp1_b64 s[84:85], s86
    s_cbranch_scc1 parallel_sum__ssm_conv_s5__mixer_token_mlp__prompt_kernel_uok_124
    s_sleep 8
    s_branch parallel_sum__ssm_conv_s5__mixer_token_mlp__prompt_kernel_upl_125
parallel_sum__ssm_conv_s5__mixer_token_mlp__prompt_kernel_uok_124:
    s_add_u32 s86, s86, 2
    s_cmp_lg_u32 s67, 0
    s_cbranch_scc1 parallel_sum__ssm_conv_s5__mixer_token_mlp__prompt_kernel_x_126
    s_add_u32 m0, s10, 4096
    s_nop 0
    buffer_load_dwordx4 v13, s[56:59], s14 offen sc1 lds
parallel_sum__ssm_conv_s5__mixer_token_mlp__prompt_kernel_x_126:
    s_add_u32 m0, s10, 0
    s_nop 0
    buffer_load_dwordx4 v12, s[56:59], s14 offen offset:0 sc1 lds
    buffer_load_dwordx4 v12, s[56:59], s14 offen offset:1024 sc1 lds
    buffer_load_dwordx4 v12, s[56:59], s14 offen offset:2048 sc1 lds
    buffer_load_dwordx4 v12, s[56:59], s14 offen offset:3072 sc1 lds
    s_add_u32 s14, s14, 73728
    s_waitcnt vmcnt(12)
    s_barrier
    s_and_b64 s[76:77], s[84:85], s[74:75]
    s_cmp_eq_u64 s[76:77], s[74:75]
    s_cbranch_scc1 parallel_sum__ssm_conv_s5__mixer_token_mlp__prompt_kernel_usk_127
    buffer_load_dword v26, v20, s[68:71], s83 offen sc1
    buffer_load_dword v27, v20, s[68:71], s83 offen offset:128 sc1
parallel_sum__ssm_conv_s5__mixer_token_mlp__prompt_kernel_usk_127:
    s_add_u32 m0, s9, 16384
    s_nop 0
    buffer_load_dwordx4 v8, s[52:55], s12 offen offset:0 lds
    buffer_load_dwordx4 v9, s[52:55], s12 offen offset:1024 lds
    buffer_load_dwordx4 v10, s[52:55], s12 offen offset:2048 lds
    buffer_load_dwordx4 v11, s[52:55], s12 offen offset:3072 lds
    s_add_u32 s12, s12, 262144
    s_bitcmp1_b64 s[84:85], s86
    s_cbranch_scc1 parallel_sum__ssm_conv_s5__mixer_token_mlp__prompt_kernel_uok_128
    s_mov_b32 s88, 0
parallel_sum__ssm_conv_s5__mixer_token_mlp__prompt_kernel_upl_129:
    buffer_load_dword v22, v20, s[68:71], s83 offen sc1
    buffer_load_dword v23, v20, s[68:71], s83 offen offset:128 sc1
    s_add_u32 s88, s88, 1
    s_waitcnt vmcnt(0)
    v_and_b32 v22, v22, v23
    v_cmp_eq_u32 s[84:85], 1, v22
    s_cmp_ge_u32 s88, 0x8000
    s_cbranch_scc1 parallel_sum__ssm_conv_s5__mixer_token_mlp__prompt_kernel_uok_128
    s_bitcmp1_b64 s[84:85], s86
    s_cbranch_scc1 parallel_sum__ssm_conv_s5__mixer_token_mlp__prompt_kernel_uok_128
    s_sleep 8
    s_branch parallel_sum__ssm_conv_s5__mixer_token_mlp__prompt_kernel_upl_129
parallel_sum__ssm_conv_s5__mixer_token_mlp__prompt_kernel_uok_128:
    s_add_u32 s86, s86, 2
    s_cmp_lg_u32 s67, 0
    s_cbranch_scc1 parallel_sum__ssm_conv_s5__mixer_token_mlp__prompt_kernel_x_130
    s_add_u32 m0, s10, 22528
    s_nop 0
    buffer_load_dwordx4 v13, s[56:59], s14 offen sc1 lds
parallel_sum__ssm_conv_s5__mixer_token_mlp__prompt_kernel_x_130:
    s_add_u32 m0, s10, 18432
    s_nop 0
    buffer_load_dwordx4 v12, s[56:59], s14 offen offset:0 sc1 lds
    buffer_load_dwordx4 v12, s[56:59], s14 offen offset:1024 sc1 lds
    buffer_load_dwordx4 v12, s[56:59], s14 offen offset:2048 sc1 lds
    buffer_load_dwordx4 v12, s[56:59], s14 offen offset:3072 sc1 lds
    s_add_u32 s14, s14, 73728
    s_lshl_b32 s13, s5, 7
    s_lshl_b32 s15, s7, 5
    s_add_u32 s13, s13, s15
    v_add_u32 v5, s13, v3
    s_mul_i32 s13, s6, 144
    s_and_b32 s15, s3, 3
    s_lshl_b32 s15, s15, 4
    s_add_u32 s13, s13, s15
    s_lshl_b32 s13, s13, 1
    v_mul_u32_u24 v206, 1152, v5
    v_lshlrev_b32 v208, 3, v4
    v_add_u32 v206, v206, v208
    v_add_u32 v207, 18432, v206
    v_lshlrev_b32 v7, 3, v5
    v_lshlrev_b32 v15, 1, v5
    v_lshlrev_b32 v6, 1, v206
    v_lshlrev_b32 v14, 1, v207
    s_add_u32 s60, s48, 0x240000
    s_addc_u32 s61, s49, 0
    s_mov_b32 s62, 0x4000
    s_mov_b32 s63, 0x00020000
    buffer_load_dwordx2 v[194:195], v7, s[60:63], 0 offen offset:0 sc1
    buffer_load_dwordx2 v[196:197], v7, s[60:63], 0 offen offset:128 sc1
    s_mov_b32 s60, s42
    s_mov_b32 s61, s43
    s_mov_b32 s62, 0x1000
    s_mov_b32 s63, 0x00020000
    buffer_load_ushort v198, v15, s[60:63], 0 offen offset:0
    buffer_load_ushort v200, v15, s[60:63], 0 offen offset:32
    s_mov_b32 s60, s32
    s_mov_b32 s61, s33
    s_mov_b32 s62, 0x480
    s_mov_b32 s63, 0x00020000
    buffer_load_dwordx2 v[188:189], v208, s[60:63], s13 offen offset:0
    buffer_load_dwordx2 v[190:191], v208, s[60:63], s13 offen offset:128
    buffer_load_dwordx2 v[192:193], v208, s[60:63], s13 offen offset:256
    s_mov_b32 s60, s16
    s_mov_b32 s61, s17
    s_mov_b32 s62, 0x240000
    s_mov_b32 s63, 0x00020000
    s_lshl_b32 s13, s5, 7
    s_lshl_b32 s15, s7, 5
    s_add_u32 s13, s13, s15
    s_and_b32 s15, s3, 3
    s_lshl_b32 s88, s15, 3
    s_add_u32 s13, s13, s88
    s_mul_i32 s13, s13, 1152
    s_mul_i32 s88, s6, 288
    s_add_u32 s13, s13, s88
    s_mul_i32 s15, s15, 2304
    v_add_u32 v209, 0, v2
    v_mul_u32_u24 v210, 3641, v209
    v_lshrrev_b32 v210, 16, v210
    v_mul_u32_u24 v210, 864, v210
    s_add_u32 m0, s15, 145408
    v_lshl_add_u32 v209, v209, 4, v210
    buffer_load_dwordx4 v209, s[60:63], s13 offen lds
    v_add_u32 v209, 64, v2
    v_mul_u32_u24 v210, 3641, v209
    v_lshrrev_b32 v210, 16, v210
    v_mul_u32_u24 v210, 864, v210
    s_add_u32 m0, s15, 146432
    v_lshl_add_u32 v209, v209, 4, v210
    buffer_load_dwordx4 v209, s[60:63], s13 offen lds
    v_add_u32 v209, 128, v2
    v_mul_u32_u24 v210, 3641, v209
    v_lshrrev_b32 v210, 16, v210
    v_mul_u32_u24 v210, 864, v210
    s_add_u32 m0, s15, 147456
    v_lshl_add_u32 v209, v209, 4, v210
    s_mov_b64 exec, 0xffff
    buffer_load_dwordx4 v209, s[60:63], s13 offen lds
    s_mov_b64 exec, -1
    s_waitcnt vmcnt(26)
    s_barrier
    s_add_u32 m0, s9, 32768
    s_nop 0
    buffer_load_dwordx4 v8, s[52:55], s12 offen offset:0 lds
    buffer_load_dwordx4 v9, s[52:55], s12 offen offset:1024 lds
    buffer_load_dwordx4 v10, s[52:55], s12 offen offset:2048 lds
    buffer_load_dwordx4 v11, s[52:55], s12 offen offset:3072 lds
    s_add_u32 s12, s12, 262144
    s_bitcmp1_b64 s[84:85], s86
    s_cbranch_scc1 parallel_sum__ssm_conv_s5__mixer_token_mlp__prompt_kernel_uok_131
    s_mov_b32 s88, 0
parallel_sum__ssm_conv_s5__mixer_token_mlp__prompt_kernel_upl_132:
    buffer_load_dword v22, v20, s[68:71], s83 offen sc1
    buffer_load_dword v23, v20, s[68:71], s83 offen offset:128 sc1
    s_add_u32 s88, s88, 1
    s_waitcnt vmcnt(0)
    v_and_b32 v22, v22, v23
    v_cmp_eq_u32 s[84:85], 1, v22
    s_cmp_ge_u32 s88, 0x8000
    s_cbranch_scc1 parallel_sum__ssm_conv_s5__mixer_token_mlp__prompt_kernel_uok_131
    s_bitcmp1_b64 s[84:85], s86
    s_cbranch_scc1 parallel_sum__ssm_conv_s5__mixer_token_mlp__prompt_kernel_uok_131
    s_sleep 8
    s_branch parallel_sum__ssm_conv_s5__mixer_token_mlp__prompt_kernel_upl_132
parallel_sum__ssm_conv_s5__mixer_token_mlp__prompt_kernel_uok_131:
    s_add_u32 s86, s86, 2
    s_cmp_lg_u32 s67, 0
    s_cbranch_scc1 parallel_sum__ssm_conv_s5__mixer_token_mlp__prompt_kernel_x_133
    s_add_u32 m0, s10, 40960
    s_nop 0
    buffer_load_dwordx4 v13, s[56:59], s14 offen sc1 lds
parallel_sum__ssm_conv_s5__mixer_token_mlp__prompt_kernel_x_133:
    s_add_u32 m0, s10, 36864
    s_nop 0
    buffer_load_dwordx4 v12, s[56:59], s14 offen offset:0 sc1 lds
    buffer_load_dwordx4 v12, s[56:59], s14 offen offset:1024 sc1 lds
    buffer_load_dwordx4 v12, s[56:59], s14 offen offset:2048 sc1 lds
    buffer_load_dwordx4 v12, s[56:59], s14 offen offset:3072 sc1 lds
    s_add_u32 s14, s14, 73728
    s_cmp_eq_u32 s50, 2
    s_cbranch_scc1 parallel_sum__ssm_conv_s5__mixer_token_mlp__prompt_kernel_tt_134
    s_and_b32 s89, s3, 3
    s_cmp_ge_u32 s89, 4
    s_cbranch_scc1 parallel_sum__ssm_conv_s5__mixer_token_mlp__prompt_kernel_tt_134
    v_lshlrev_b32 v29, 12, v4
    v_lshl_add_u32 v29, v3, 7, v29
    s_mul_i32 s88, s66, 4
    s_add_u32 s88, s88, s89
    s_add_u32 s88, s88, 180
    s_lshl_b32 s88, s88, 14
    s_mul_i32 s89, s7, 4718592
    s_add_u32 s88, s88, s89
    s_and_b32 s89, s2, 1
    s_lshl_b32 s89, s89, 11
    s_add_u32 s88, s88, s89
    buffer_load_dword v1, v29, s[52:55], s88 offen
parallel_sum__ssm_conv_s5__mixer_token_mlp__prompt_kernel_tt_134:
    s_mov_b32 s91, 0
parallel_sum__ssm_conv_s5__mixer_token_mlp__prompt_kernel_lloop_135:
    s_waitcnt vmcnt(26)
    s_barrier
    s_and_b64 s[76:77], s[84:85], s[74:75]
    s_cmp_eq_u64 s[76:77], s[74:75]
    s_cbranch_scc1 parallel_sum__ssm_conv_s5__mixer_token_mlp__prompt_kernel_usk_136
    buffer_load_dword v26, v20, s[68:71], s83 offen sc1
    buffer_load_dword v27, v20, s[68:71], s83 offen offset:128 sc1
parallel_sum__ssm_conv_s5__mixer_token_mlp__prompt_kernel_usk_136:
    s_add_u32 m0, s9, 49152
    s_nop 0
    buffer_load_dwordx4 v8, s[52:55], s12 offen offset:0 lds
    buffer_load_dwordx4 v9, s[52:55], s12 offen offset:1024 lds
    buffer_load_dwordx4 v10, s[52:55], s12 offen offset:2048 lds
    buffer_load_dwordx4 v11, s[52:55], s12 offen offset:3072 lds
    s_add_u32 s12, s12, 262144
    s_bitcmp1_b64 s[84:85], s86
    s_cbranch_scc1 parallel_sum__ssm_conv_s5__mixer_token_mlp__prompt_kernel_uok_137
    s_mov_b32 s88, 0
parallel_sum__ssm_conv_s5__mixer_token_mlp__prompt_kernel_upl_138:
    buffer_load_dword v22, v20, s[68:71], s83 offen sc1
    buffer_load_dword v23, v20, s[68:71], s83 offen offset:128 sc1
    s_add_u32 s88, s88, 1
    s_waitcnt vmcnt(0)
    v_and_b32 v22, v22, v23
    v_cmp_eq_u32 s[84:85], 1, v22
    s_cmp_ge_u32 s88, 0x8000
    s_cbranch_scc1 parallel_sum__ssm_conv_s5__mixer_token_mlp__prompt_kernel_uok_137
    s_bitcmp1_b64 s[84:85], s86
    s_cbranch_scc1 parallel_sum__ssm_conv_s5__mixer_token_mlp__prompt_kernel_uok_137
    s_sleep 8
    s_branch parallel_sum__ssm_conv_s5__mixer_token_mlp__prompt_kernel_upl_138
parallel_sum__ssm_conv_s5__mixer_token_mlp__prompt_kernel_uok_137:
    s_add_u32 s86, s86, 2
    s_cmp_lg_u32 s67, 0
    s_cbranch_scc1 parallel_sum__ssm_conv_s5__mixer_token_mlp__prompt_kernel_x_139
    s_add_u32 m0, s10, 59392
    s_nop 0
    buffer_load_dwordx4 v13, s[56:59], s14 offen sc1 lds
parallel_sum__ssm_conv_s5__mixer_token_mlp__prompt_kernel_x_139:
    s_add_u32 m0, s10, 55296
    s_nop 0
    buffer_load_dwordx4 v12, s[56:59], s14 offen offset:0 sc1 lds
    buffer_load_dwordx4 v12, s[56:59], s14 offen offset:1024 sc1 lds
    buffer_load_dwordx4 v12, s[56:59], s14 offen offset:2048 sc1 lds
    buffer_load_dwordx4 v12, s[56:59], s14 offen offset:3072 sc1 lds
    s_add_u32 s14, s14, 73728
    s_waitcnt vmcnt(26)
    s_barrier
    v_and_b32 v28, v26, v27
    v_cmp_eq_u32 s[76:77], 1, v28
    s_or_b64 s[84:85], s[84:85], s[76:77]
    s_add_u32 m0, s9, 0
    s_nop 0
    buffer_load_dwordx4 v8, s[52:55], s12 offen offset:0 lds
    buffer_load_dwordx4 v9, s[52:55], s12 offen offset:1024 lds
    buffer_load_dwordx4 v10, s[52:55], s12 offen offset:2048 lds
    buffer_load_dwordx4 v11, s[52:55], s12 offen offset:3072 lds
    s_add_u32 s12, s12, 262144
    s_bitcmp1_b64 s[84:85], s86
    s_cbranch_scc1 parallel_sum__ssm_conv_s5__mixer_token_mlp__prompt_kernel_uok_140
    s_mov_b32 s88, 0
parallel_sum__ssm_conv_s5__mixer_token_mlp__prompt_kernel_upl_141:
    buffer_load_dword v22, v20, s[68:71], s83 offen sc1
    buffer_load_dword v23, v20, s[68:71], s83 offen offset:128 sc1
    s_add_u32 s88, s88, 1
    s_waitcnt vmcnt(0)
    v_and_b32 v22, v22, v23
    v_cmp_eq_u32 s[84:85], 1, v22
    s_cmp_ge_u32 s88, 0x8000
    s_cbranch_scc1 parallel_sum__ssm_conv_s5__mixer_token_mlp__prompt_kernel_uok_140
    s_bitcmp1_b64 s[84:85], s86
    s_cbranch_scc1 parallel_sum__ssm_conv_s5__mixer_token_mlp__prompt_kernel_uok_140
    s_sleep 8
    s_branch parallel_sum__ssm_conv_s5__mixer_token_mlp__prompt_kernel_upl_141
parallel_sum__ssm_conv_s5__mixer_token_mlp__prompt_kernel_uok_140:
    s_add_u32 s86, s86, 2
    s_cmp_lg_u32 s67, 0
    s_cbranch_scc1 parallel_sum__ssm_conv_s5__mixer_token_mlp__prompt_kernel_x_142
    s_add_u32 m0, s10, 4096
    s_nop 0
    buffer_load_dwordx4 v13, s[56:59], s14 offen sc1 lds
parallel_sum__ssm_conv_s5__mixer_token_mlp__prompt_kernel_x_142:
    s_add_u32 m0, s10, 0
    s_nop 0
    buffer_load_dwordx4 v12, s[56:59], s14 offen offset:0 sc1 lds
    buffer_load_dwordx4 v12, s[56:59], s14 offen offset:1024 sc1 lds
    buffer_load_dwordx4 v12, s[56:59], s14 offen offset:2048 sc1 lds
    buffer_load_dwordx4 v12, s[56:59], s14 offen offset:3072 sc1 lds
    s_add_u32 s14, s14, 73728
    s_waitcnt vmcnt(16)
    s_barrier
    s_add_u32 m0, s9, 16384
    s_nop 0
    buffer_load_dwordx4 v8, s[52:55], s12 offen offset:0 lds
    buffer_load_dwordx4 v9, s[52:55], s12 offen offset:1024 lds
    buffer_load_dwordx4 v10, s[52:55], s12 offen offset:2048 lds
    buffer_load_dwordx4 v11, s[52:55], s12 offen offset:3072 lds
    s_add_u32 s12, s12, 262144
    s_bitcmp1_b64 s[84:85], s86
    s_cbranch_scc1 parallel_sum__ssm_conv_s5__mixer_token_mlp__prompt_kernel_uok_143
    s_mov_b32 s88, 0
parallel_sum__ssm_conv_s5__mixer_token_mlp__prompt_kernel_upl_144:
    buffer_load_dword v22, v20, s[68:71], s83 offen sc1
    buffer_load_dword v23, v20, s[68:71], s83 offen offset:128 sc1
    s_add_u32 s88, s88, 1
    s_waitcnt vmcnt(0)
    v_and_b32 v22, v22, v23
    v_cmp_eq_u32 s[84:85], 1, v22
    s_cmp_ge_u32 s88, 0x8000
    s_cbranch_scc1 parallel_sum__ssm_conv_s5__mixer_token_mlp__prompt_kernel_uok_143
    s_bitcmp1_b64 s[84:85], s86
    s_cbranch_scc1 parallel_sum__ssm_conv_s5__mixer_token_mlp__prompt_kernel_uok_143
    s_sleep 8
    s_branch parallel_sum__ssm_conv_s5__mixer_token_mlp__prompt_kernel_upl_144
parallel_sum__ssm_conv_s5__mixer_token_mlp__prompt_kernel_uok_143:
    s_add_u32 s86, s86, 2
    s_cmp_lg_u32 s67, 0
    s_cbranch_scc1 parallel_sum__ssm_conv_s5__mixer_token_mlp__prompt_kernel_x_145
    s_add_u32 m0, s10, 22528
    s_nop 0
    buffer_load_dwordx4 v13, s[56:59], s14 offen sc1 lds
parallel_sum__ssm_conv_s5__mixer_token_mlp__prompt_kernel_x_145:
    s_add_u32 m0, s10, 18432
    s_nop 0
    buffer_load_dwordx4 v12, s[56:59], s14 offen offset:0 sc1 lds
    buffer_load_dwordx4 v12, s[56:59], s14 offen offset:1024 sc1 lds
    buffer_load_dwordx4 v12, s[56:59], s14 offen offset:2048 sc1 lds
    buffer_load_dwordx4 v12, s[56:59], s14 offen offset:3072 sc1 lds
    s_add_u32 s14, s14, 73728
    s_waitcnt vmcnt(16)
    s_barrier
    v_and_b32 v28, v26, v27
    v_cmp_eq_u32 s[76:77], 1, v28
    s_or_b64 s[84:85], s[84:85], s[76:77]
    s_add_u32 m0, s9, 32768
    s_nop 0
    buffer_load_dwordx4 v8, s[52:55], s12 offen offset:0 lds
    buffer_load_dwordx4 v9, s[52:55], s12 offen offset:1024 lds
    buffer_load_dwordx4 v10, s[52:55], s12 offen offset:2048 lds
    buffer_load_dwordx4 v11, s[52:55], s12 offen offset:3072 lds
    s_add_u32 s12, s12, 262144
    s_bitcmp1_b64 s[84:85], s86
    s_cbranch_scc1 parallel_sum__ssm_conv_s5__mixer_token_mlp__prompt_kernel_uok_146
    s_mov_b32 s88, 0
parallel_sum__ssm_conv_s5__mixer_token_mlp__prompt_kernel_upl_147:
    buffer_load_dword v22, v20, s[68:71], s83 offen sc1
    buffer_load_dword v23, v20, s[68:71], s83 offen offset:128 sc1
    s_add_u32 s88, s88, 1
    s_waitcnt vmcnt(0)
    v_and_b32 v22, v22, v23
    v_cmp_eq_u32 s[84:85], 1, v22
    s_cmp_ge_u32 s88, 0x8000
    s_cbranch_scc1 parallel_sum__ssm_conv_s5__mixer_token_mlp__prompt_kernel_uok_146
    s_bitcmp1_b64 s[84:85], s86
    s_cbranch_scc1 parallel_sum__ssm_conv_s5__mixer_token_mlp__prompt_kernel_uok_146
    s_sleep 8
    s_branch parallel_sum__ssm_conv_s5__mixer_token_mlp__prompt_kernel_upl_147
parallel_sum__ssm_conv_s5__mixer_token_mlp__prompt_kernel_uok_146:
    s_add_u32 s86, s86, 2
    s_cmp_lg_u32 s67, 0
    s_cbranch_scc1 parallel_sum__ssm_conv_s5__mixer_token_mlp__prompt_kernel_x_148
    s_add_u32 m0, s10, 40960
    s_nop 0
    buffer_load_dwordx4 v13, s[56:59], s14 offen sc1 lds
parallel_sum__ssm_conv_s5__mixer_token_mlp__prompt_kernel_x_148:
    s_add_u32 m0, s10, 36864
    s_nop 0
    buffer_load_dwordx4 v12, s[56:59], s14 offen offset:0 sc1 lds
    buffer_load_dwordx4 v12, s[56:59], s14 offen offset:1024 sc1 lds
    buffer_load_dwordx4 v12, s[56:59], s14 offen offset:2048 sc1 lds
    buffer_load_dwordx4 v12, s[56:59], s14 offen offset:3072 sc1 lds
    s_add_u32 s14, s14, 73728
    s_add_u32 s91, s91, 1
    s_cmp_lt_u32 s91, 3
    s_cbranch_scc1 parallel_sum__ssm_conv_s5__mixer_token_mlp__prompt_kernel_lloop_135
    s_waitcnt vmcnt(16)
    s_barrier
    s_add_u32 m0, s9, 49152
    s_nop 0
    buffer_load_dwordx4 v8, s[52:55], s12 offen offset:0 lds
    buffer_load_dwordx4 v9, s[52:55], s12 offen offset:1024 lds
    buffer_load_dwordx4 v10, s[52:55], s12 offen offset:2048 lds
    buffer_load_dwordx4 v11, s[52:55], s12 offen offset:3072 lds
    s_add_u32 s12, s12, 262144
    s_bitcmp1_b64 s[84:85], s86
    s_cbranch_scc1 parallel_sum__ssm_conv_s5__mixer_token_mlp__prompt_kernel_uok_149
    s_mov_b32 s88, 0
parallel_sum__ssm_conv_s5__mixer_token_mlp__prompt_kernel_upl_150:
    buffer_load_dword v22, v20, s[68:71], s83 offen sc1
    buffer_load_dword v23, v20, s[68:71], s83 offen offset:128 sc1
    s_add_u32 s88, s88, 1
    s_waitcnt vmcnt(0)
    v_and_b32 v22, v22, v23
    v_cmp_eq_u32 s[84:85], 1, v22
    s_cmp_ge_u32 s88, 0x8000
    s_cbranch_scc1 parallel_sum__ssm_conv_s5__mixer_token_mlp__prompt_kernel_uok_149
    s_bitcmp1_b64 s[84:85], s86
    s_cbranch_scc1 parallel_sum__ssm_conv_s5__mixer_token_mlp__prompt_kernel_uok_149
    s_sleep 8
    s_branch parallel_sum__ssm_conv_s5__mixer_token_mlp__prompt_kernel_upl_150
parallel_sum__ssm_conv_s5__mixer_token_mlp__prompt_kernel_uok_149:
    s_add_u32 s86, s86, 2
    s_cmp_lg_u32 s67, 0
    s_cbranch_scc1 parallel_sum__ssm_conv_s5__mixer_token_mlp__prompt_kernel_x_151
    s_add_u32 m0, s10, 59392
    s_nop 0
    buffer_load_dwordx4 v13, s[56:59], s14 offen sc1 lds
parallel_sum__ssm_conv_s5__mixer_token_mlp__prompt_kernel_x_151:
    s_add_u32 m0, s10, 55296
    s_nop 0
    buffer_load_dwordx4 v12, s[56:59], s14 offen offset:0 sc1 lds
    buffer_load_dwordx4 v12, s[56:59], s14 offen offset:1024 sc1 lds
    buffer_load_dwordx4 v12, s[56:59], s14 offen offset:2048 sc1 lds
    buffer_load_dwordx4 v12, s[56:59], s14 offen offset:3072 sc1 lds
    s_add_u32 s14, s14, 73728
    s_waitcnt vmcnt(16)
    s_barrier
    s_waitcnt vmcnt(8)
    s_barrier
    s_waitcnt vmcnt(0)
    s_barrier
    s_add_u32 s52, s48, 0xe00000
    s_addc_u32 s53, s49, 0
    s_mov_b32 s54, 0x6c0000
    s_mov_b32 s55, 0x00020000
    s_mov_b32 s84, s44
    s_mov_b32 s85, s45
    s_mov_b32 s86, 0x480000
    s_mov_b32 s87, 0x00020000
    s_and_b32 s10, s3, 3
    s_mul_i32 s61, s6, 144
    s_lshl_b32 s15, s10, 4
    s_add_u32 s61, s61, s15
    s_lshl_b32 s61, s61, 2
    v_mul_u32_u24 v209, 288, v3
    v_add_u32 v209, v209, v208
    s_lshl_b32 s15, s10, 5
    s_add_u32 s15, s15, 145408
    v_add_u32 v209, s15, v209
    ds_read_b64 v[176:177], v209 offset:0
    ds_read_b64 v[178:179], v209 offset:4608
    ds_read_b64 v[180:181], v209 offset:128
    ds_read_b64 v[182:183], v209 offset:4736
    ds_read_b64 v[184:185], v209 offset:256
    ds_read_b64 v[186:187], v209 offset:4864
    s_waitcnt lgkmcnt(0)
    v_lshlrev_b32 v198, 16, v198
    v_mov_b32 v202, v195
    v_lshlrev_b32 v200, 16, v200
    v_mov_b32 v204, v197
    v_lshlrev_b32 v124, 16, v176
    v_lshlrev_b32 v126, 16, v177
    v_lshlrev_b32 v128, 16, v178
    v_lshlrev_b32 v130, 16, v179
    v_and_b32 v125, s4, v176
    v_and_b32 v127, s4, v177
    v_and_b32 v129, s4, v178
    v_and_b32 v131, s4, v179
    v_pk_add_f32 v[148:149], v[124:125], v[194:195] op_sel_hi:[1,0] neg_lo:[0,1] neg_hi:[0,1]
    v_pk_add_f32 v[152:153], v[126:127], v[194:195] op_sel_hi:[1,0] neg_lo:[0,1] neg_hi:[0,1]
    v_pk_add_f32 v[156:157], v[128:129], v[196:197] op_sel_hi:[1,0] neg_lo:[0,1] neg_hi:[0,1]
    v_pk_add_f32 v[160:161], v[130:131], v[196:197] op_sel_hi:[1,0] neg_lo:[0,1] neg_hi:[0,1]
    v_cvt_pk_bf16_f32 v150, v148, v149
    v_cvt_pk_bf16_f32 v154, v152, v153
    v_cvt_pk_bf16_f32 v158, v156, v157
    v_cvt_pk_bf16_f32 v162, v160, v161
    v_lshlrev_b32 v148, 16, v150
    v_lshlrev_b32 v152, 16, v154
    v_lshlrev_b32 v156, 16, v158
    v_lshlrev_b32 v160, 16, v162
    v_and_b32 v149, s4, v150
    v_and_b32 v153, s4, v154
    v_and_b32 v157, s4, v158
    v_and_b32 v161, s4, v162
    v_pk_mul_f32 v[148:149], v[148:149], v[202:203] op_sel_hi:[1,0]
    v_pk_mul_f32 v[152:153], v[152:153], v[202:203] op_sel_hi:[1,0]
    v_pk_mul_f32 v[156:157], v[156:157], v[204:205] op_sel_hi:[1,0]
    v_pk_mul_f32 v[160:161], v[160:161], v[204:205] op_sel_hi:[1,0]
    v_cvt_pk_bf16_f32 v150, v148, v149
    v_cvt_pk_bf16_f32 v154, v152, v153
    v_cvt_pk_bf16_f32 v158, v156, v157
    v_cvt_pk_bf16_f32 v162, v160, v161
    v_lshlrev_b32 v148, 16, v150
    v_lshlrev_b32 v152, 16, v154
    v_lshlrev_b32 v156, 16, v158
    v_lshlrev_b32 v160, 16, v162
    v_and_b32 v149, s4, v150
    v_and_b32 v153, s4, v154
    v_and_b32 v157, s4, v158
    v_and_b32 v161, s4, v162
    v_lshlrev_b32 v150, 16, v188
    v_lshlrev_b32 v154, 16, v189
    v_lshlrev_b32 v158, 16, v188
    v_lshlrev_b32 v162, 16, v189
    v_and_b32 v151, s4, v188
    v_and_b32 v155, s4, v189
    v_and_b32 v159, s4, v188
    v_and_b32 v163, s4, v189
    v_pk_mul_f32 v[148:149], v[148:149], v[150:151]
    v_pk_mul_f32 v[152:153], v[152:153], v[154:155]
    v_pk_mul_f32 v[156:157], v[156:157], v[158:159]
    v_pk_mul_f32 v[160:161], v[160:161], v[162:163]
    v_cvt_pk_bf16_f32 v150, v148, v149
    v_cvt_pk_bf16_f32 v154, v152, v153
    v_cvt_pk_bf16_f32 v158, v156, v157
    v_cvt_pk_bf16_f32 v162, v160, v161
    v_lshlrev_b32 v148, 16, v150
    v_lshlrev_b32 v152, 16, v154
    v_lshlrev_b32 v156, 16, v158
    v_lshlrev_b32 v160, 16, v162
    v_and_b32 v149, s4, v150
    v_and_b32 v153, s4, v154
    v_and_b32 v157, s4, v158
    v_and_b32 v161, s4, v162
    v_pk_add_f32 v[124:125], v[124:125], v[148:149]
    v_pk_add_f32 v[126:127], v[126:127], v[152:153]
    v_pk_add_f32 v[128:129], v[128:129], v[156:157]
    v_pk_add_f32 v[130:131], v[130:131], v[160:161]
    v_pk_add_f32 v[124:125], v[124:125], v[198:199] op_sel_hi:[1,0]
    v_pk_add_f32 v[126:127], v[126:127], v[198:199] op_sel_hi:[1,0]
    v_pk_add_f32 v[128:129], v[128:129], v[200:201] op_sel_hi:[1,0]
    v_pk_add_f32 v[130:131], v[130:131], v[200:201] op_sel_hi:[1,0]
    v_lshlrev_b32 v132, 16, v180
    v_lshlrev_b32 v134, 16, v181
    v_lshlrev_b32 v136, 16, v182
    v_lshlrev_b32 v138, 16, v183
    v_and_b32 v133, s4, v180
    v_and_b32 v135, s4, v181
    v_and_b32 v137, s4, v182
    v_and_b32 v139, s4, v183
    v_pk_add_f32 v[148:149], v[132:133], v[194:195] op_sel_hi:[1,0] neg_lo:[0,1] neg_hi:[0,1]
    v_pk_add_f32 v[152:153], v[134:135], v[194:195] op_sel_hi:[1,0] neg_lo:[0,1] neg_hi:[0,1]
    v_pk_add_f32 v[156:157], v[136:137], v[196:197] op_sel_hi:[1,0] neg_lo:[0,1] neg_hi:[0,1]
    v_pk_add_f32 v[160:161], v[138:139], v[196:197] op_sel_hi:[1,0] neg_lo:[0,1] neg_hi:[0,1]
    v_cvt_pk_bf16_f32 v150, v148, v149
    v_cvt_pk_bf16_f32 v154, v152, v153
    v_cvt_pk_bf16_f32 v158, v156, v157
    v_cvt_pk_bf16_f32 v162, v160, v161
    v_lshlrev_b32 v148, 16, v150
    v_lshlrev_b32 v152, 16, v154
    v_lshlrev_b32 v156, 16, v158
    v_lshlrev_b32 v160, 16, v162
    v_and_b32 v149, s4, v150
    v_and_b32 v153, s4, v154
    v_and_b32 v157, s4, v158
    v_and_b32 v161, s4, v162
    v_pk_mul_f32 v[148:149], v[148:149], v[202:203] op_sel_hi:[1,0]
    v_pk_mul_f32 v[152:153], v[152:153], v[202:203] op_sel_hi:[1,0]
    v_pk_mul_f32 v[156:157], v[156:157], v[204:205] op_sel_hi:[1,0]
    v_pk_mul_f32 v[160:161], v[160:161], v[204:205] op_sel_hi:[1,0]
    v_cvt_pk_bf16_f32 v150, v148, v149
    v_cvt_pk_bf16_f32 v154, v152, v153
    v_cvt_pk_bf16_f32 v158, v156, v157
    v_cvt_pk_bf16_f32 v162, v160, v161
    v_lshlrev_b32 v148, 16, v150
    v_lshlrev_b32 v152, 16, v154
    v_lshlrev_b32 v156, 16, v158
    v_lshlrev_b32 v160, 16, v162
    v_and_b32 v149, s4, v150
    v_and_b32 v153, s4, v154
    v_and_b32 v157, s4, v158
    v_and_b32 v161, s4, v162
    v_lshlrev_b32 v150, 16, v190
    v_lshlrev_b32 v154, 16, v191
    v_lshlrev_b32 v158, 16, v190
    v_lshlrev_b32 v162, 16, v191
    v_and_b32 v151, s4, v190
    v_and_b32 v155, s4, v191
    v_and_b32 v159, s4, v190
    v_and_b32 v163, s4, v191
    v_pk_mul_f32 v[148:149], v[148:149], v[150:151]
    v_pk_mul_f32 v[152:153], v[152:153], v[154:155]
    v_pk_mul_f32 v[156:157], v[156:157], v[158:159]
    v_pk_mul_f32 v[160:161], v[160:161], v[162:163]
    v_cvt_pk_bf16_f32 v150, v148, v149
    v_cvt_pk_bf16_f32 v154, v152, v153
    v_cvt_pk_bf16_f32 v158, v156, v157
    v_cvt_pk_bf16_f32 v162, v160, v161
    v_lshlrev_b32 v148, 16, v150
    v_lshlrev_b32 v152, 16, v154
    v_lshlrev_b32 v156, 16, v158
    v_lshlrev_b32 v160, 16, v162
    v_and_b32 v149, s4, v150
    v_and_b32 v153, s4, v154
    v_and_b32 v157, s4, v158
    v_and_b32 v161, s4, v162
    v_pk_add_f32 v[132:133], v[132:133], v[148:149]
    v_pk_add_f32 v[134:135], v[134:135], v[152:153]
    v_pk_add_f32 v[136:137], v[136:137], v[156:157]
    v_pk_add_f32 v[138:139], v[138:139], v[160:161]
    v_pk_add_f32 v[132:133], v[132:133], v[198:199] op_sel_hi:[1,0]
    v_pk_add_f32 v[134:135], v[134:135], v[198:199] op_sel_hi:[1,0]
    v_pk_add_f32 v[136:137], v[136:137], v[200:201] op_sel_hi:[1,0]
    v_pk_add_f32 v[138:139], v[138:139], v[200:201] op_sel_hi:[1,0]
    v_lshlrev_b32 v140, 16, v184
    v_lshlrev_b32 v142, 16, v185
    v_lshlrev_b32 v144, 16, v186
    v_lshlrev_b32 v146, 16, v187
    v_and_b32 v141, s4, v184
    v_and_b32 v143, s4, v185
    v_and_b32 v145, s4, v186
    v_and_b32 v147, s4, v187
    v_pk_add_f32 v[148:149], v[140:141], v[194:195] op_sel_hi:[1,0] neg_lo:[0,1] neg_hi:[0,1]
    v_pk_add_f32 v[152:153], v[142:143], v[194:195] op_sel_hi:[1,0] neg_lo:[0,1] neg_hi:[0,1]
    v_pk_add_f32 v[156:157], v[144:145], v[196:197] op_sel_hi:[1,0] neg_lo:[0,1] neg_hi:[0,1]
    v_pk_add_f32 v[160:161], v[146:147], v[196:197] op_sel_hi:[1,0] neg_lo:[0,1] neg_hi:[0,1]
    v_cvt_pk_bf16_f32 v150, v148, v149
    v_cvt_pk_bf16_f32 v154, v152, v153
    v_cvt_pk_bf16_f32 v158, v156, v157
    v_cvt_pk_bf16_f32 v162, v160, v161
    v_lshlrev_b32 v148, 16, v150
    v_lshlrev_b32 v152, 16, v154
    v_lshlrev_b32 v156, 16, v158
    v_lshlrev_b32 v160, 16, v162
    v_and_b32 v149, s4, v150
    v_and_b32 v153, s4, v154
    v_and_b32 v157, s4, v158
    v_and_b32 v161, s4, v162
    v_pk_mul_f32 v[148:149], v[148:149], v[202:203] op_sel_hi:[1,0]
    v_pk_mul_f32 v[152:153], v[152:153], v[202:203] op_sel_hi:[1,0]
    v_pk_mul_f32 v[156:157], v[156:157], v[204:205] op_sel_hi:[1,0]
    v_pk_mul_f32 v[160:161], v[160:161], v[204:205] op_sel_hi:[1,0]
    v_cvt_pk_bf16_f32 v150, v148, v149
    v_cvt_pk_bf16_f32 v154, v152, v153
    v_cvt_pk_bf16_f32 v158, v156, v157
    v_cvt_pk_bf16_f32 v162, v160, v161
    v_lshlrev_b32 v148, 16, v150
    v_lshlrev_b32 v152, 16, v154
    v_lshlrev_b32 v156, 16, v158
    v_lshlrev_b32 v160, 16, v162
    v_and_b32 v149, s4, v150
    v_and_b32 v153, s4, v154
    v_and_b32 v157, s4, v158
    v_and_b32 v161, s4, v162
    v_lshlrev_b32 v150, 16, v192
    v_lshlrev_b32 v154, 16, v193
    v_lshlrev_b32 v158, 16, v192
    v_lshlrev_b32 v162, 16, v193
    v_and_b32 v151, s4, v192
    v_and_b32 v155, s4, v193
    v_and_b32 v159, s4, v192
    v_and_b32 v163, s4, v193
    v_pk_mul_f32 v[148:149], v[148:149], v[150:151]
    v_pk_mul_f32 v[152:153], v[152:153], v[154:155]
    v_pk_mul_f32 v[156:157], v[156:157], v[158:159]
    v_pk_mul_f32 v[160:161], v[160:161], v[162:163]
    v_cvt_pk_bf16_f32 v150, v148, v149
    v_cvt_pk_bf16_f32 v154, v152, v153
    v_cvt_pk_bf16_f32 v158, v156, v157
    v_cvt_pk_bf16_f32 v162, v160, v161
    v_lshlrev_b32 v148, 16, v150
    v_lshlrev_b32 v152, 16, v154
    v_lshlrev_b32 v156, 16, v158
    v_lshlrev_b32 v160, 16, v162
    v_and_b32 v149, s4, v150
    v_and_b32 v153, s4, v154
    v_and_b32 v157, s4, v158
    v_and_b32 v161, s4, v162
    v_pk_add_f32 v[140:141], v[140:141], v[148:149]
    v_pk_add_f32 v[142:143], v[142:143], v[152:153]
    v_pk_add_f32 v[144:145], v[144:145], v[156:157]
    v_pk_add_f32 v[146:147], v[146:147], v[160:161]
    v_pk_add_f32 v[140:141], v[140:141], v[198:199] op_sel_hi:[1,0]
    v_pk_add_f32 v[142:143], v[142:143], v[198:199] op_sel_hi:[1,0]
    v_pk_add_f32 v[144:145], v[144:145], v[200:201] op_sel_hi:[1,0]
    v_pk_add_f32 v[146:147], v[146:147], v[200:201] op_sel_hi:[1,0]
    s_lshl_b32 s14, s11, 2
    s_add_u32 s14, s14, s7
    s_lshl_b32 s13, s14, 7
    s_mul_i32 s14, s14, 27648
    s_lshl_b32 s15, s10, 10
    s_add_u32 s14, s14, s15
    v_add_u32 v9, 8192, v12
    s_lshl_b32 s15, s10, 11
    v_add_u32 v10, s15, v12
    v_min_u32 v20, 2, v2
    v_lshlrev_b32 v20, 2, v20
    s_mov_b64 s[72:73], 7
    s_mov_b32 s88, 0
parallel_sum__ssm_conv_s5__mixer_token_mlp__prompt_kernel_poll_152:
    buffer_load_dword v22, v20, s[68:71], s13 offen offset:0 sc1
parallel_sum__ssm_conv_s5__mixer_token_mlp__prompt_kernel_pollck_154:
    s_waitcnt vmcnt(0)
    s_add_u32 s88, s88, 1
    s_mov_b64 s[78:79], 0
    v_cmp_gt_u32 vcc, 1, v22
    s_and_b64 vcc, vcc, s[72:73]
    s_or_b64 s[78:79], s[78:79], vcc
    s_cbranch_scc0 parallel_sum__ssm_conv_s5__mixer_token_mlp__prompt_kernel_pollend_153
    s_sleep 1
    s_cmp_lt_u32 s88, 0x8000
    s_cbranch_scc1 parallel_sum__ssm_conv_s5__mixer_token_mlp__prompt_kernel_poll_152
parallel_sum__ssm_conv_s5__mixer_token_mlp__prompt_kernel_pollend_153:
    s_cmp_lg_u32 s10, 0
    s_cbranch_scc1 parallel_sum__ssm_conv_s5__mixer_token_mlp__prompt_kernel_skip3_155
    s_add_u32 s13, s14, 0
    buffer_load_dwordx4 v[56:59], v9, s[52:55], s13 offen sc1
    s_add_u32 s13, s14, 9216
    buffer_load_dwordx4 v[60:63], v9, s[52:55], s13 offen sc1
    s_add_u32 s13, s14, 18432
    buffer_load_dwordx4 v[64:67], v9, s[52:55], s13 offen sc1
parallel_sum__ssm_conv_s5__mixer_token_mlp__prompt_kernel_skip3_155:
    s_add_u32 s13, s14, 0
    buffer_load_dwordx4 v[32:35], v12, s[52:55], s13 offen sc1
    s_add_u32 s13, s14, 9216
    buffer_load_dwordx4 v[36:39], v12, s[52:55], s13 offen sc1
    s_add_u32 s13, s14, 18432
    buffer_load_dwordx4 v[40:43], v12, s[52:55], s13 offen sc1
    s_add_u32 s13, s14, 0
    buffer_load_dwordx4 v[44:47], v13, s[52:55], s13 offen sc1
    s_add_u32 s13, s14, 9216
    buffer_load_dwordx4 v[48:51], v13, s[52:55], s13 offen sc1
    s_add_u32 s13, s14, 18432
    buffer_load_dwordx4 v[52:55], v13, s[52:55], s13 offen sc1
    v_mov_b32 v24, 144896
parallel_sum__ssm_conv_s5__mixer_token_mlp__prompt_kernel_ow_156:
    ds_read_b32 v25, v24 offset:20
    s_waitcnt lgkmcnt(0)
    v_readfirstlane_b32 s88, v25
    s_cmp_eq_u32 s88, 1
    s_cbranch_scc0 parallel_sum__ssm_conv_s5__mixer_token_mlp__prompt_kernel_ow_156
    ds_read_b128 v[68:71], v10 offset:0
    ds_read_b128 v[72:75], v10 offset:1024
    ds_read_b128 v[76:79], v10 offset:8192
    ds_read_b128 v[80:83], v10 offset:9216
    ds_read_b128 v[84:87], v10 offset:16384
    ds_read_b128 v[88:91], v10 offset:17408
    s_waitcnt lgkmcnt(0)
    v_pk_add_f32 v[124:125], v[124:125], v[68:69]
    v_pk_add_f32 v[126:127], v[126:127], v[70:71]
    v_pk_add_f32 v[128:129], v[128:129], v[72:73]
    v_pk_add_f32 v[130:131], v[130:131], v[74:75]
    s_waitcnt vmcnt(3)
    v_lshlrev_b32 v148, 16, v32
    v_and_b32 v149, s4, v32
    v_lshlrev_b32 v150, 16, v33
    v_and_b32 v151, s4, v33
    v_lshlrev_b32 v152, 16, v34
    v_and_b32 v153, s4, v34
    v_lshlrev_b32 v154, 16, v35
    v_and_b32 v155, s4, v35
    v_pk_add_f32 v[124:125], v[124:125], v[148:149]
    v_pk_add_f32 v[126:127], v[126:127], v[150:151]
    v_pk_add_f32 v[128:129], v[128:129], v[152:153]
    v_pk_add_f32 v[130:131], v[130:131], v[154:155]
    v_lshlrev_b32 v148, 16, v36
    v_and_b32 v149, s4, v36
    v_lshlrev_b32 v150, 16, v37
    v_and_b32 v151, s4, v37
    v_lshlrev_b32 v152, 16, v38
    v_and_b32 v153, s4, v38
    v_lshlrev_b32 v154, 16, v39
    v_and_b32 v155, s4, v39
    v_pk_add_f32 v[124:125], v[124:125], v[148:149]
    v_pk_add_f32 v[126:127], v[126:127], v[150:151]
    v_pk_add_f32 v[128:129], v[128:129], v[152:153]
    v_pk_add_f32 v[130:131], v[130:131], v[154:155]
    v_lshlrev_b32 v148, 16, v40
    v_and_b32 v149, s4, v40
    v_lshlrev_b32 v150, 16, v41
    v_and_b32 v151, s4, v41
    v_lshlrev_b32 v152, 16, v42
    v_and_b32 v153, s4, v42
    v_lshlrev_b32 v154, 16, v43
    v_and_b32 v155, s4, v43
    v_pk_add_f32 v[124:125], v[124:125], v[148:149]
    v_pk_add_f32 v[126:127], v[126:127], v[150:151]
    v_pk_add_f32 v[128:129], v[128:129], v[152:153]
    v_pk_add_f32 v[130:131], v[130:131], v[154:155]
    buffer_store_dwordx4 v[124:127], v6, s[84:87], s61 offen offset:0
    buffer_store_dwordx4 v[128:131], v14, s[84:87], s61 offen offset:0
    v_pk_add_f32 v[132:133], v[132:133], v[76:77]
    v_pk_add_f32 v[134:135], v[134:135], v[78:79]
    v_pk_add_f32 v[136:137], v[136:137], v[80:81]
    v_pk_add_f32 v[138:139], v[138:139], v[82:83]
    s_waitcnt vmcnt(2)
    v_lshlrev_b32 v148, 16, v44
    v_and_b32 v149, s4, v44
    v_lshlrev_b32 v150, 16, v45
    v_and_b32 v151, s4, v45
    v_lshlrev_b32 v152, 16, v46
    v_and_b32 v153, s4, v46
    v_lshlrev_b32 v154, 16, v47
    v_and_b32 v155, s4, v47
    v_pk_add_f32 v[132:133], v[132:133], v[148:149]
    v_pk_add_f32 v[134:135], v[134:135], v[150:151]
    v_pk_add_f32 v[136:137], v[136:137], v[152:153]
    v_pk_add_f32 v[138:139], v[138:139], v[154:155]
    v_lshlrev_b32 v148, 16, v48
    v_and_b32 v149, s4, v48
    v_lshlrev_b32 v150, 16, v49
    v_and_b32 v151, s4, v49
    v_lshlrev_b32 v152, 16, v50
    v_and_b32 v153, s4, v50
    v_lshlrev_b32 v154, 16, v51
    v_and_b32 v155, s4, v51
    v_pk_add_f32 v[132:133], v[132:133], v[148:149]
    v_pk_add_f32 v[134:135], v[134:135], v[150:151]
    v_pk_add_f32 v[136:137], v[136:137], v[152:153]
    v_pk_add_f32 v[138:139], v[138:139], v[154:155]
    v_lshlrev_b32 v148, 16, v52
    v_and_b32 v149, s4, v52
    v_lshlrev_b32 v150, 16, v53
    v_and_b32 v151, s4, v53
    v_lshlrev_b32 v152, 16, v54
    v_and_b32 v153, s4, v54
    v_lshlrev_b32 v154, 16, v55
    v_and_b32 v155, s4, v55
    v_pk_add_f32 v[132:133], v[132:133], v[148:149]
    v_pk_add_f32 v[134:135], v[134:135], v[150:151]
    v_pk_add_f32 v[136:137], v[136:137], v[152:153]
    v_pk_add_f32 v[138:139], v[138:139], v[154:155]
    buffer_store_dwordx4 v[132:135], v6, s[84:87], s61 offen offset:256
    buffer_store_dwordx4 v[136:139], v14, s[84:87], s61 offen offset:256
    s_cmp_lg_u32 s10, 0
    s_cbranch_scc1 parallel_sum__ssm_conv_s5__mixer_token_mlp__prompt_kernel_fin_157
    v_pk_add_f32 v[140:141], v[140:141], v[84:85]
    v_pk_add_f32 v[142:143], v[142:143], v[86:87]
    v_pk_add_f32 v[144:145], v[144:145], v[88:89]
    v_pk_add_f32 v[146:147], v[146:147], v[90:91]
    s_waitcnt vmcnt(4)
    v_lshlrev_b32 v148, 16, v56
    v_and_b32 v149, s4, v56
    v_lshlrev_b32 v150, 16, v57
    v_and_b32 v151, s4, v57
    v_lshlrev_b32 v152, 16, v58
    v_and_b32 v153, s4, v58
    v_lshlrev_b32 v154, 16, v59
    v_and_b32 v155, s4, v59
    v_pk_add_f32 v[140:141], v[140:141], v[148:149]
    v_pk_add_f32 v[142:143], v[142:143], v[150:151]
    v_pk_add_f32 v[144:145], v[144:145], v[152:153]
    v_pk_add_f32 v[146:147], v[146:147], v[154:155]
    v_lshlrev_b32 v148, 16, v60
    v_and_b32 v149, s4, v60
    v_lshlrev_b32 v150, 16, v61
    v_and_b32 v151, s4, v61
    v_lshlrev_b32 v152, 16, v62
    v_and_b32 v153, s4, v62
    v_lshlrev_b32 v154, 16, v63
    v_and_b32 v155, s4, v63
    v_pk_add_f32 v[140:141], v[140:141], v[148:149]
    v_pk_add_f32 v[142:143], v[142:143], v[150:151]
    v_pk_add_f32 v[144:145], v[144:145], v[152:153]
    v_pk_add_f32 v[146:147], v[146:147], v[154:155]
    v_lshlrev_b32 v148, 16, v64
    v_and_b32 v149, s4, v64
    v_lshlrev_b32 v150, 16, v65
    v_and_b32 v151, s4, v65
    v_lshlrev_b32 v152, 16, v66
    v_and_b32 v153, s4, v66
    v_lshlrev_b32 v154, 16, v67
    v_and_b32 v155, s4, v67
    v_pk_add_f32 v[140:141], v[140:141], v[148:149]
    v_pk_add_f32 v[142:143], v[142:143], v[150:151]
    v_pk_add_f32 v[144:145], v[144:145], v[152:153]
    v_pk_add_f32 v[146:147], v[146:147], v[154:155]
    buffer_store_dwordx4 v[140:143], v6, s[84:87], s61 offen offset:512
    buffer_store_dwordx4 v[144:147], v14, s[84:87], s61 offen offset:512
parallel_sum__ssm_conv_s5__mixer_token_mlp__prompt_kernel_fin_157:
    s_endpgm
parallel_sum__ssm_conv_s5__mixer_token_mlp__prompt_kernel_done_1:
    s_endpgm
code_end:
.section .rodata,"a"
.p2align 6
.amdhsa_kernel parallel_sum__ssm_conv_s5__mixer_token_mlp__prompt_kernel
  .amdhsa_next_free_vgpr 252
  .amdhsa_next_free_sgpr 92
  .amdhsa_accum_offset 252
  .amdhsa_group_segment_fixed_size 0
  .amdhsa_kernarg_size 136
  .amdhsa_user_sgpr_count 2
  .amdhsa_user_sgpr_kernarg_segment_ptr 1
  .amdhsa_system_sgpr_workgroup_id_x 1
  .amdhsa_float_denorm_mode_32 3
  .amdhsa_float_denorm_mode_16_64 3
  .amdhsa_dx10_clamp 1
  .amdhsa_ieee_mode 0
.end_amdhsa_kernel
```
